```python
import torch

def _softmax(x, axis=-1):
    return torch.softmax(x, dim=axis)
def _gelu(x):
    return torch.nn.functional.gelu(x, approximate="tanh")
def _silu(x):
    return torch.nn.functional.silu(x)
def _sigmoid(x):
    return torch.sigmoid(x)
def _layernorm(x, axis=-1, eps=1e-5):
    m = x.mean(dim=axis, keepdim=True)
    v = x.var(dim=axis, keepdim=True, unbiased=False)
    return (x - m) / torch.sqrt(v + eps)
def _scatter_add(tgt, idx, src, axis=0):
    return tgt.clone().index_add_(axis, idx, src)
def _segment_sum(src, seg, n):
    out = torch.zeros((n,) + src.shape[1:], dtype=src.dtype)
    return out.index_add_(0, seg, src)
def _pad(x, pw):
    flat = tuple(v for pair in reversed(pw) for v in pair)
    return torch.nn.functional.pad(x, flat)

kernel_name = 'parallel_sum__linear_kernel_hedgehog__dense_activation_mish__prompt'

def setup_inputs():

    _w = (lambda a: (lambda t: t.to(torch.bfloat16) if t.is_floating_point() else t)(torch.as_tensor(a)))
    def _A_setup():
        B, S, D, H = 1, 2048, 640, 32
        Dh = D // H
        return {
            "x": _w((lambda *s: torch.randn(*s, dtype=torch.bfloat16) * 0.05)(B, S, D)),
            "wqkv": _w((lambda *s: torch.randn(*s, dtype=torch.bfloat16) * 0.2)(D, 3 * D)),
            "w_phi": _w((lambda *s: torch.randn(*s, dtype=torch.bfloat16) * 0.2)(H, Dh, Dh) * (Dh ** -0.5)),
            "wo": _w((lambda *s: torch.randn(*s, dtype=torch.bfloat16) * 0.05)(D, D)),
        }
    _A_in = _A_setup()

    def _B_setup():
        B, S, D, F = 1, 2048, 640, 1728
        return {
            "x": _w((lambda *s: torch.randn(*s, dtype=torch.bfloat16) * 0.05)(B, S, D)),
            "w1": _w((lambda *s: torch.randn(*s, dtype=torch.bfloat16) * 0.8)(D, F) * (D ** -0.5)),
            "b1": _w((lambda *s: torch.randn(*s, dtype=torch.bfloat16) * 0.4)(F)),
            "w2": _w((lambda *s: torch.randn(*s, dtype=torch.bfloat16) * 0.1)(F, D) * (F ** -0.5)),
        }
    _B_in = _B_setup()

    return {
        "A_x": _A_in["x"],
        "A_wqkv": _A_in["wqkv"],
        "A_w_phi": _A_in["w_phi"],
        "A_wo": _A_in["wo"],
        "B_x": _B_in["x"],
        "B_w1": _B_in["w1"],
        "B_b1": _B_in["b1"],
        "B_w2": _B_in["w2"],
    }

def reference(A_x, A_wqkv, A_w_phi, A_wo, B_x, B_w1, B_b1, B_w2):
    def _A_ref(x, wqkv, w_phi, wo):
        B, S, D = x.shape
        H = 32; Dh = D // H
        qkv = (lambda x, *d: x.permute(*d))((x @ wqkv).reshape(B, S, 3, H, Dh), 2, 0, 3, 1, 4)
        q, k, v = qkv[0], qkv[1], qkv[2]
        pq = torch.einsum("bhsd,hdf->bhsf", q, w_phi)
        pk = torch.einsum("bhsd,hdf->bhsf", k, w_phi)
        phi_q = torch.concatenate([_softmax(pq, axis=-1), _softmax(-pq, axis=-1)], axis=-1)
        phi_k = torch.concatenate([_softmax(pk, axis=-1), _softmax(-pk, axis=-1)], axis=-1)
        kv = torch.einsum("bhsf,bhsd->bhfd", phi_k, v)
        z  = torch.einsum("bhsf->bhf", phi_k)
        num = torch.einsum("bhqf,bhfd->bhqd", phi_q, kv)
        den = torch.einsum("bhqf,bhf->bhq", phi_q, z)[..., None] + 1e-6
        o = num / den
        return (lambda x, *d: x.permute(*d))(o, 0, 2, 1, 3).reshape(B, S, D) @ wo

    def _B_ref(x, w1, b1, w2):
        h = torch.einsum("bsd,df->bsf", x, w1) + b1
        sp = torch.log1p(torch.exp(-torch.abs(h))) + torch.where(h > 0, h, torch.zeros_like(h))
        act = h * torch.tanh(sp)
        return torch.einsum("bsf,fd->bsd", act, w2)

    x = A_x
    xn = _layernorm(x, axis=-1)
    return x + _A_ref(xn, A_wqkv, A_w_phi, A_wo) + _B_ref(xn, B_w1, B_b1, B_w2)
```

```asm
; @launch grid=(256,1,1) block=(256,1,1) lds=163840
.amdgcn_target "amdgcn-amd-amdhsa--gfx950"
.text
.globl parallel_sum__linear_kernel_hedgehog__dense_activation_mish__prompt_kernel
.p2align 8
.type parallel_sum__linear_kernel_hedgehog__dense_activation_mish__prompt_kernel,@function
parallel_sum__linear_kernel_hedgehog__dense_activation_mish__prompt_kernel:
    s_cmp_ge_u32 s2, 256
    s_cbranch_scc1 Lend
    s_load_dwordx16 s[4:19], s[0:1], 0
    s_load_dwordx4 s[20:23], s[0:1], 64
    s_load_dwordx2 s[24:25], s[0:1], 80
    s_mov_b32 s74, 0xfb61a540
    s_mov_b32 s75, 0xce937d82
    s_bitcmp1_b32 s2, 0
    s_cmov_b32 s74, 0xea73d962
    s_cmov_b32 s75, 0xfc51b840
    s_cselect_b32 s97, 128, 0
    s_and_b32 s73, s2, 6
    s_lshl_b32 s73, s73, 3
    s_lshr_b32 s76, s2, 6
    s_lshl_b32 s76, s76, 2
    s_add_u32 s73, s73, s76
    s_lshr_b64 s[74:75], s[74:75], s73
    s_and_b32 s74, s74, 15
    s_lshl_b32 s74, s74, 3
    s_bfe_u32 s75, s2, 0x30003
    s_add_u32 s97, s97, s74
    s_add_u32 s97, s97, s75
    v_lshrrev_b32 v2, 6, v0
    v_and_b32 v1, 63, v0
    v_readfirstlane_b32 s68, v2
    s_and_b32 s26, s2, 7
    s_lshr_b32 s27, s2, 3
    s_and_b32 s73, s26, 1
    s_lshl_b32 s73, s73, 3
    s_and_b32 s74, s27, 7
    s_add_u32 s69, s73, s74
    s_and_b32 s73, s26, 6
    s_bfe_u32 s74, s27, 0x10003
    s_add_u32 s70, s73, s74
    s_lshl_b32 s71, s68, 12
    v_mov_b32 v208, 0
    v_lshrrev_b32 v209, 5, v0
    s_lshl_b32 s73, s97, 3
    v_add_u32 v209, s73, v209
    v_mul_u32_u24 v130, 1280, v209
    v_and_b32 v211, 31, v0
    v_lshl_add_u32 v130, v211, 4, v130
    v_cmp_gt_u32 vcc, 16, v211
    v_mov_b32 v132, 0x80000000
    v_lshrrev_b32 v133, 3, v1
    v_cndmask_b32 v132, v132, v130, vcc
    s_lshr_b32 s81, s97, 2
    s_cmp_lt_u32 s81, 30
    s_mov_b32 s82, 3456
    s_cselect_b32 s82, 3840, s82
    s_cselect_b32 s79, 0, 30
    s_sub_u32 s79, s81, s79
    s_lshl_b32 s79, s79, 7
    s_and_b32 s76, s97, 3
    s_mul_i32 s76, s76, 160
    s_mul_i32 s77, s68, 40
    s_add_u32 s76, s76, s77
    v_bfe_u32 v134, v1, 4, 1
    v_lshlrev_b32 v134, 2, v134
    v_and_b32 v135, 7, v1
    v_xor_b32 v134, v134, v135
    v_lshlrev_b32 v134, 4, v134
    v_add_u32 v135, s76, v133
    v_mul_lo_u32 v135, v135, s82
    v_add_u32 v135, v135, v134
    s_lshl_b32 s82, s82, 3
    s_lshl_b32 s73, s69, 7
    s_lshl_b32 s74, s68, 5
    s_add_u32 s73, s73, s74
    v_add_u32 v148, s73, v133
    v_mul_u32_u24 v148, 1280, v148
    v_lshrrev_b32 v149, 4, v1
    v_and_b32 v150, 7, v1
    v_xor_b32 v149, v149, v150
    v_xor_b32 v150, 4, v149
    v_lshl_add_u32 v2, v149, 4, v148
    v_lshl_add_u32 v3, v150, 4, v148
    v_add_u32 v4, 18432, v2
    v_add_u32 v5, 27648, v3
    v_add_u32 v3, 9216, v3
    s_mov_b32 s92, 0x3f803f80
    s_lshl_b32 s73, s26, 2
    s_and_b32 s74, s27, 3
    s_add_u32 s93, s73, s74
    s_lshr_b32 s94, s27, 2
    s_mov_b32 s95, s93
    s_mov_b32 s96, s94
    s_cmp_lt_u32 s27, 16
    s_cbranch_scc1 LroleKV
LroleM:
    s_lshl_b32 s73, s68, 5
    v_add_u32 v151, s73, v133
    v_mul_u32_u24 v151, 3840, v151
    v_add_u32 v18, v151, v134
    v_add_u32 v19, 29696, v18
    v_add_u32 v20, 59392, v18
    v_add_u32 v21, 89088, v18
    s_lshl_b32 s80, s70, 7
    s_mul_i32 s76, s68, 5120
    s_mov_b32 s91, 0x20000
    s_add_u32 s76, s76, s91
    s_waitcnt lgkmcnt(0)
    s_mov_b32 s28, s4
    s_and_b32 s29, s5, 0xffff
    s_mov_b32 s30, 0x280000
    s_mov_b32 s31, 0x20000
    buffer_load_dwordx4 v[216:219], v130, s[28:31], 0 offen
    buffer_load_dwordx4 v[220:223], v130, s[28:31], 0 offen offset:512
    buffer_load_dwordx4 v[224:227], v132, s[28:31], 0 offen offset:1024
    s_mov_b32 s40, s24
    s_and_b32 s41, s25, 0xffff
    s_mov_b32 s42, 0x1200000
    s_mov_b32 s43, 0x20000
    buffer_load_dword v208, v208, s[40:43], 0 offen sc1
    s_cmp_lt_u32 s81, 30
    s_cselect_b32 s64, s6, s14
    s_cselect_b32 s65, s7, s15
    s_mov_b32 s66, 2211840
    s_cselect_b32 s66, 2457600, s66
    s_and_b32 s65, s65, 0xffff
    s_mov_b32 s67, 0x20000
    s_cmp_lt_u32 s97, 228
    s_cselect_b32 s66, s66, 0
    s_add_u32 m0, s76, 0
    s_nop 0
    buffer_load_dwordx4 v135, s[64:67], s79 offen lds
    s_add_u32 m0, s76, 1024
    s_add_u32 s79, s79, s82
    buffer_load_dwordx4 v135, s[64:67], s79 offen lds
    s_add_u32 m0, s76, 2048
    s_add_u32 s79, s79, s82
    buffer_load_dwordx4 v135, s[64:67], s79 offen lds
    s_add_u32 m0, s76, 3072
    s_add_u32 s79, s79, s82
    buffer_load_dwordx4 v135, s[64:67], s79 offen lds
    s_add_u32 m0, s76, 4096
    s_add_u32 s79, s79, s82
    buffer_load_dwordx4 v135, s[64:67], s79 offen lds
    s_mov_b32 s32, s6
    s_and_b32 s33, s7, 0xffff
    s_mov_b32 s34, 0x258000
    s_mov_b32 s35, 0x20000
    s_add_u32 m0, s71, 0x14000
    s_mov_b32 s26, 0x0
    buffer_load_dwordx4 v2, s[28:31], s26 offen lds
    buffer_load_dwordx4 v3, s[28:31], s26 offen offset:1024 lds
    buffer_load_dwordx4 v4, s[28:31], s26 offen offset:2048 lds
    buffer_load_dwordx4 v5, s[28:31], s26 offen offset:3072 lds
    s_mov_b32 s36, s14
    s_and_b32 s37, s15, 0xffff
    s_mov_b32 s38, 0x21c000
    s_mov_b32 s39, 0x20000
    s_mov_b32 s44, s20
    s_and_b32 s45, s21, 0xffff
    s_mov_b32 s46, 0x280000
    s_mov_b32 s47, 0x20000
    s_mov_b32 s56, s16
    s_and_b32 s57, s17, 0xffff
    s_mov_b32 s58, 0xd80
    s_mov_b32 s59, 0x20000
    s_mov_b32 s60, s8
    s_and_b32 s61, s9, 0xffff
    s_mov_b32 s62, 0x6400
    s_mov_b32 s63, 0x20000
    s_lshl_b32 s73, s68, 5
    v_add_u32 v151, s73, v133
    s_add_u32 m0, s71, 0x4000
    s_add_u32 s26, s80, 0
    buffer_load_dwordx4 v18, s[32:35], s26 offen lds
    v_mul_u32_u24 v151, 3456, v151
    v_add_u32 v14, v151, v134
    v_add_u32 v15, 26624, v14
    v_add_u32 v16, 53248, v14
    v_add_u32 v17, 79872, v14
    v_and_b32 v148, 31, v1
    v_bfe_u32 v149, v1, 1, 3
    v_lshrrev_b32 v150, 5, v1
    v_xor_b32 v149, v149, v150
    v_lshlrev_b32 v151, 7, v148
    v_add_u32 v151, s71, v151
    v_xor_b32 v152, 0, v149
    v_lshl_add_u32 v6, v152, 4, v151
    v_add_u32 v10, 0x10000, v6
    v_xor_b32 v152, 2, v149
    v_lshl_add_u32 v7, v152, 4, v151
    v_add_u32 v11, 0x10000, v7
    buffer_load_dwordx4 v19, s[32:35], s26 offen offset:1024 lds
    v_xor_b32 v152, 4, v149
    v_lshl_add_u32 v8, v152, 4, v151
    v_add_u32 v12, 0x10000, v8
    v_xor_b32 v152, 6, v149
    v_lshl_add_u32 v9, v152, 4, v151
    v_add_u32 v13, 0x10000, v9
    v_bfe_u32 v152, v1, 4, 1
    v_bfe_u32 v153, v1, 1, 1
    v_lshl_add_u32 v152, v152, 1, v153
    v_and_b32 v153, 1, v1
    v_lshrrev_b32 v154, 1, v152
    v_lshl_add_u32 v154, v153, 1, v154
    v_bfe_u32 v155, v1, 3, 1
    v_lshlrev_b32 v155, 2, v155
    v_xor_b32 v154, v154, v155
    v_and_b32 v152, 1, v152
    v_lshlrev_b32 v152, 3, v152
    v_bfe_u32 v155, v1, 2, 2
    buffer_load_dwordx4 v20, s[32:35], s26 offen offset:2048 lds
    v_lshl_add_u32 v155, v150, 3, v155
    v_lshl_add_u32 v152, v155, 7, v152
    v_lshl_add_u32 v26, v154, 4, v152
    v_xor_b32 v28, 64, v26
    v_add_u32 v27, 0x10000, v26
    v_add_u32 v29, 0x10000, v28
    v_bfe_u32 v152, v1, 2, 1
    v_bfe_u32 v153, v1, 3, 2
    v_and_b32 v154, 3, v1
    v_lshl_add_u32 v154, v153, 2, v154
    v_lshl_add_u32 v154, v152, 4, v154
    v_lshlrev_b32 v154, 4, v154
    v_add_u32 v30, 0x27000, v154
    s_lshl_b32 s73, s69, 3
    s_lshl_b32 s74, s68, 1
    s_add_u32 s73, s73, s74
    v_bfe_u32 v152, v1, 4, 1
    buffer_load_dwordx4 v21, s[32:35], s26 offen offset:3072 lds
    v_add_u32 v152, s73, v152
    s_mov_b32 s73, 98304
    v_mul_lo_u32 v152, v152, s73
    v_and_b32 v153, 15, v1
    v_lshlrev_b32 v153, 4, v153
    v_lshl_add_u32 v153, v150, 9, v153
    v_add_u32 v152, v152, v153
    v_add_u32 v31, 0x500000, v152
    v_cmp_gt_u32 vcc, 32, v0
    v_mov_b32 v152, 0x80000000
    v_lshlrev_b32 v153, 2, v0
    v_cndmask_b32 v32, v152, v153, vcc
    s_lshl_b32 s1, s97, 7
    s_add_u32 s1, s1, 0x10000
    s_lshl_b32 s73, s70, 11
    s_add_u32 s83, s73, 77824
    s_cmp_lt_u32 s70, 2
    s_cselect_b32 s48, s6, s14
    s_cselect_b32 s49, s7, s15
    s_mov_b32 s50, 2211840
    s_cselect_b32 s50, 2457600, s50
    s_mov_b32 s78, 3456
    s_cselect_b32 s78, 3840, s78
    s_cselect_b32 s74, 8, -2
    s_cselect_b32 s75, 77824, 0
    s_cselect_b32 s77, 0xff800000, 0xbf800000
    s_mov_b32 s88, 384
    s_cselect_b32 s88, 896, s88
    s_cselect_b32 s76, 4, 5
    s_add_u32 m0, s71, 0x18000
    s_mov_b32 s26, 0x80
    buffer_load_dwordx4 v2, s[28:31], s26 offen lds
    s_and_b32 s49, s49, 0xffff
    s_mov_b32 s51, 0x20000
    s_add_u32 s74, s74, s70
    s_lshl_b32 s79, s74, 7
    s_lshl_b32 s84, s74, 11
    s_add_u32 s84, s84, s75
    buffer_load_dwordx4 v3, s[28:31], s26 offen offset:1024 lds
    s_lshl_b32 s75, s69, s76
    s_add_u32 s88, s88, s75
    s_add_u32 s88, s88, s74
    s_lshl_b32 s88, s88, 7
    s_add_u32 s88, s88, 0x10000
    s_lshl_b32 s73, s68, 5
    v_add_u32 v151, s73, v133
    v_mul_lo_u32 v151, v151, s78
    s_lshl_b32 s73, s78, 3
    s_sub_u32 s73, s73, 1024
    v_add_u32 v204, v151, v134
    v_add_u32 v205, s73, v204
    v_add_u32 v206, s73, v205
    v_add_u32 v207, s73, v206
    s_lshl_b32 s78, s78, 7
    s_add_u32 s73, s70, 6
    s_lshl_b32 s81, s73, 7
    s_lshl_b32 s85, s73, 11
    buffer_load_dwordx4 v4, s[28:31], s26 offen offset:2048 lds
    s_lshl_b32 s74, s69, 5
    s_add_u32 s74, s74, 384
    s_add_u32 s89, s74, s73
    s_lshl_b32 s89, s89, 7
    s_add_u32 s89, s89, 0x10000
    s_add_u32 s90, s89, 1024
    s_add_u32 s82, s81, 1024
    s_add_u32 s86, s85, 16384
    s_lshl_b32 s74, s69, 4
    s_add_u32 s74, s74, s70
    s_add_u32 s74, s74, 896
    s_lshl_b32 s87, s74, 7
    s_add_u32 s87, s87, 0x10000
    s_mov_b32 s52, s14
    s_and_b32 s53, s15, 0xffff
    s_cmp_lt_u32 s70, 5
    s_cselect_b32 s54, 2211840, 0
    s_cselect_b32 s86, s86, s85
    buffer_load_dwordx4 v5, s[28:31], s26 offen offset:3072 lds
    s_mov_b32 s55, 0x20000
    s_cmp_eq_u32 s68, 1
    s_cselect_b32 s73, s79, s80
    s_cselect_b32 s74, s84, s83
    s_cmp_eq_u32 s68, 2
    s_cselect_b32 s74, s85, s74
    s_cmp_eq_u32 s68, 3
    s_cselect_b32 s74, s86, s74
    s_lshr_b32 s74, s74, 11
    s_sub_u32 s75, s74, 38
    s_add_u32 s76, s74, 30
    s_cmp_ge_u32 s74, 38
    s_cselect_b32 s73, s75, s76
    v_mov_b32 v112, s73
    v_lshlrev_b32 v114, 6, v112
    v_add_u32 v114, v114, v1
    v_and_b32 v113, 3, v1
    s_add_u32 m0, s71, 0x8000
    s_mov_b32 s26, 0x100
    buffer_load_dwordx4 v2, s[28:31], s26 offen lds
    v_lshl_add_u32 v112, v112, 2, v113
    s_lshl_b32 s73, s69, 4
    s_lshl_b32 s74, s68, 2
    s_add_u32 s73, s73, s74
    v_add_u32 v113, s73, v113
    v_cmp_gt_u32 vcc, 4, v1
    s_nop 1
    v_cndmask_b32 v112, v112, v113, vcc
    v_lshlrev_b32 v112, 7, v112
    v_add_u32 v125, 0x10000, v112
    v_mov_b32 v228, 0
    v_mov_b32 v229, 0
    s_waitcnt vmcnt(21)
    v_dot2_f32_bf16 v228, v216, s92, v228
    v_dot2_f32_bf16 v229, v216, v216, v229
    v_dot2_f32_bf16 v228, v217, s92, v228
    v_dot2_f32_bf16 v229, v217, v217, v229
    v_dot2_f32_bf16 v228, v218, s92, v228
    buffer_load_dwordx4 v3, s[28:31], s26 offen offset:1024 lds
    v_dot2_f32_bf16 v229, v218, v218, v229
    v_dot2_f32_bf16 v228, v219, s92, v228
    v_dot2_f32_bf16 v229, v219, v219, v229
    s_waitcnt vmcnt(21)
    v_dot2_f32_bf16 v228, v220, s92, v228
    v_dot2_f32_bf16 v229, v220, v220, v229
    v_dot2_f32_bf16 v228, v221, s92, v228
    v_dot2_f32_bf16 v229, v221, v221, v229
    v_dot2_f32_bf16 v228, v222, s92, v228
    v_dot2_f32_bf16 v229, v222, v222, v229
    v_dot2_f32_bf16 v228, v223, s92, v228
    v_dot2_f32_bf16 v229, v223, v223, v229
    s_waitcnt vmcnt(20)
    v_dot2_f32_bf16 v228, v224, s92, v228
    v_dot2_f32_bf16 v229, v224, v224, v229
    v_dot2_f32_bf16 v228, v225, s92, v228
    v_dot2_f32_bf16 v229, v225, v225, v229
    v_dot2_f32_bf16 v228, v226, s92, v228
    v_dot2_f32_bf16 v229, v226, v226, v229
    v_dot2_f32_bf16 v228, v227, s92, v228
    buffer_load_dwordx4 v4, s[28:31], s26 offen offset:2048 lds
    v_dot2_f32_bf16 v229, v227, v227, v229
    s_waitcnt vmcnt(20)
    v_readfirstlane_b32 s72, v208
    s_nop 3
    s_add_u32 s72, s72, 0x9e3779b1
    v_add_f32_dpp v228, v228, v228 quad_perm:[1,0,3,2] row_mask:0xf bank_mask:0xf
    v_add_f32_dpp v229, v229, v229 quad_perm:[1,0,3,2] row_mask:0xf bank_mask:0xf
    s_nop 0
    v_add_f32_dpp v228, v228, v228 quad_perm:[2,3,0,1] row_mask:0xf bank_mask:0xf
    v_add_f32_dpp v229, v229, v229 quad_perm:[2,3,0,1] row_mask:0xf bank_mask:0xf
    s_nop 0
    v_add_f32_dpp v228, v228, v228 row_half_mirror row_mask:0xf bank_mask:0xf
    v_add_f32_dpp v229, v229, v229 row_half_mirror row_mask:0xf bank_mask:0xf
    s_nop 0
    v_add_f32_dpp v228, v228, v228 row_mirror row_mask:0xf bank_mask:0xf
    v_add_f32_dpp v229, v229, v229 row_mirror row_mask:0xf bank_mask:0xf
    v_mov_b32 v230, v228
    v_mov_b32 v231, v229
    s_nop 0
    v_permlane16_swap_b32 v228, v230
    v_permlane16_swap_b32 v229, v231
    v_add_f32 v228, v228, v230
    v_add_f32 v229, v229, v231
    buffer_load_dwordx4 v5, s[28:31], s26 offen offset:3072 lds
    v_mul_f32 v228, 0xbacccccd, v228
    v_mul_f32 v229, 0x3acccccd, v229
    v_fma_f32 v229, -v228, v228, v229
    v_max_f32 v229, 0, v229
    v_add_f32 v229, 0x3727c5ac, v229
    v_rsq_f32 v221, v229
    v_cvt_pk_bf16_f32 v216, v228, v228
    v_mul_f32 v229, v229, v221
    v_lshlrev_b32 v230, 16, v216
    v_sub_f32 v230, v228, v230
    v_cvt_pk_bf16_f32 v217, v230, v229
    v_and_b32 v231, 0xffff0000, v217
    v_sub_f32 v231, v229, v231
    v_cvt_pk_bf16_f32 v218, v231, 0
    v_mov_b32 v219, 0
    v_mul_f32 v220, 0x3fb8aa3b, v221
    v_mov_b32 v222, 0
    s_add_u32 m0, s71, 0x1c000
    s_add_u32 s26, s80, 491520
    buffer_load_dwordx4 v18, s[32:35], s26 offen lds
    v_mov_b32 v223, 0
    v_and_b32 v230, 1, v211
    v_cmp_eq_u32 vcc, 1, v230
    v_lshlrev_b32 v209, 6, v209
    v_lshl_add_u32 v209, v211, 4, v209
    v_cndmask_b32 v216, v216, v220, vcc
    v_cndmask_b32 v217, v217, v221, vcc
    v_cndmask_b32 v218, v218, v222, vcc
    v_cndmask_b32 v219, v219, v223, vcc
    v_cmp_gt_u32 vcc, 4, v211
    v_add_u32 v209, 0x40000, v209
    v_mov_b32 v230, 0x80000000
    v_cndmask_b32 v209, v230, v209, vcc
    buffer_store_dwordx4 v[216:219], v209, s[40:43], 0 offen sc1
    s_waitcnt vmcnt(18)
    s_barrier
    s_and_b32 s73, s68, 1
    buffer_load_dwordx4 v19, s[32:35], s26 offen offset:1024 lds
    s_lshr_b32 s74, s68, 1
    s_mul_i32 s75, s74, 10240
    s_add_u32 s75, s75, s91
    s_lshl_b32 s76, s73, 2
    v_bfe_u32 v232, v1, 4, 1
    v_bfe_u32 v233, v1, 1, 1
    v_lshl_add_u32 v232, v232, 1, v233
    v_bfe_u32 v233, v1, 3, 1
    v_lshlrev_b32 v233, 2, v233
    v_xor_b32 v232, v232, v233
    v_xor_b32 v232, s76, v232
    v_and_b32 v233, 1, v1
    v_lshlrev_b32 v233, 3, v233
    v_lshl_add_u32 v232, v232, 4, v233
    v_bfe_u32 v233, v1, 2, 2
    v_lshrrev_b32 v234, 5, v1
    v_lshl_add_u32 v233, v234, 3, v233
    v_lshl_add_u32 v232, v233, 7, v232
    buffer_load_dwordx4 v20, s[32:35], s26 offen offset:2048 lds
    v_add_u32 v232, s75, v232
    ds_read_b64_tr_b16 v[80:81], v232 offset:0
    ds_read_b64_tr_b16 v[82:83], v232 offset:512
    ds_read_b64_tr_b16 v[84:85], v232 offset:2048
    ds_read_b64_tr_b16 v[86:87], v232 offset:2560
    ds_read_b64_tr_b16 v[88:89], v232 offset:4096
    ds_read_b64_tr_b16 v[90:91], v232 offset:4608
    ds_read_b64_tr_b16 v[92:93], v232 offset:6144
    ds_read_b64_tr_b16 v[94:95], v232 offset:6656
    ds_read_b64_tr_b16 v[96:97], v232 offset:8192
    ds_read_b64_tr_b16 v[98:99], v232 offset:8704
    v_mov_b32 v236, s92
    v_mov_b32 v237, s92
    v_mov_b32 v238, s92
    buffer_load_dwordx4 v21, s[32:35], s26 offen offset:3072 lds
    v_mov_b32 v239, s92
    s_and_b32 s75, s97, 3
    s_lshl_b32 s75, s75, 1
    s_add_u32 s75, s75, s74
    s_lshl_b32 s75, s75, 14
    s_lshr_b32 s76, s97, 2
    s_lshl_b32 s76, s76, 8
    s_add_u32 s75, s75, s76
    s_lshl_b32 s73, s73, 7
    s_add_u32 s75, s75, s73
    s_add_u32 s75, s75, 0x60000
    s_cmp_lt_u32 s97, 228
    s_cselect_b32 s76, 32, 0
    v_cmp_gt_u32 vcc, s76, v1
    v_lshlrev_b32 v233, 2, v1
    v_mov_b32 v234, 0x80000000
    v_cndmask_b32 v233, v234, v233, vcc
    s_add_u32 m0, s71, 0xc000
    s_mov_b32 s26, 0x180
    buffer_load_dwordx4 v2, s[28:31], s26 offen lds
    s_waitcnt lgkmcnt(8)
    v_mfma_f32_32x32x16_bf16 v[240:255], v[236:239], v[80:83], 0
    s_waitcnt lgkmcnt(6)
    v_mfma_f32_32x32x16_bf16 v[240:255], v[236:239], v[84:87], v[240:255]
    s_waitcnt lgkmcnt(4)
    v_mfma_f32_32x32x16_bf16 v[240:255], v[236:239], v[88:91], v[240:255]
    s_waitcnt lgkmcnt(2)
    v_mfma_f32_32x32x16_bf16 v[240:255], v[236:239], v[92:95], v[240:255]
    s_waitcnt lgkmcnt(0)
    v_mfma_f32_32x32x16_bf16 v[240:255], v[236:239], v[96:99], v[240:255]
    s_nop 11
    buffer_store_dword v240, v233, s[40:43], s75 offen sc1
    buffer_load_dwordx4 v3, s[28:31], s26 offen offset:1024 lds
    buffer_load_dwordx4 v4, s[28:31], s26 offen offset:2048 lds
    buffer_load_dwordx4 v5, s[28:31], s26 offen offset:3072 lds
    s_add_u32 m0, s71, 0x0
    s_mov_b32 s26, 0x200
    buffer_load_dwordx4 v2, s[28:31], s26 offen lds
    buffer_load_dwordx4 v3, s[28:31], s26 offen offset:1024 lds
    buffer_load_dwordx4 v4, s[28:31], s26 offen offset:2048 lds
    buffer_load_dwordx4 v5, s[28:31], s26 offen offset:3072 lds
    s_add_u32 m0, s71, 0x10000
    s_add_u32 s26, s80, 983040
    buffer_load_dwordx4 v18, s[32:35], s26 offen lds
    buffer_load_dwordx4 v19, s[32:35], s26 offen offset:1024 lds
    buffer_load_dwordx4 v20, s[32:35], s26 offen offset:2048 lds
    buffer_load_dwordx4 v21, s[32:35], s26 offen offset:3072 lds
    s_waitcnt vmcnt(30)
    ds_read_b128 a[0:3], v10 offset:16384
    ds_read_b128 a[4:7], v11 offset:16384
    ds_read_b128 a[8:11], v12 offset:16384
    ds_read_b128 a[12:15], v13 offset:16384
    s_waitcnt vmcnt(22)
    ds_read_b128 a[16:19], v10 offset:32768
    ds_read_b128 a[20:23], v11 offset:32768
    ds_read_b128 a[24:27], v12 offset:32768
    ds_read_b128 a[28:31], v13 offset:32768
    s_barrier
    ds_read_b64_tr_b16 v[40:41], v26 offset:16384
    ds_read_b64_tr_b16 v[42:43], v26 offset:16896
    ds_read_b64_tr_b16 v[44:45], v28 offset:16384
    ds_read_b64_tr_b16 v[46:47], v28 offset:16896
    ds_read_b64_tr_b16 v[48:49], v26 offset:18432
    ds_read_b64_tr_b16 v[50:51], v26 offset:18944
    ds_read_b64_tr_b16 v[52:53], v28 offset:18432
    ds_read_b64_tr_b16 v[54:55], v28 offset:18944
    s_waitcnt lgkmcnt(4)
    v_mfma_f32_32x32x16_bf16 v[64:79], v[40:43], a[0:3], 0
    ds_read_b64_tr_b16 v[56:57], v26 offset:20480
    ds_read_b64_tr_b16 v[58:59], v26 offset:20992
    s_add_u32 m0, s71, 0x14000
    s_mov_b32 s26, 0x280
    buffer_load_dwordx4 v2, s[28:31], s26 offen lds
    buffer_load_dwordx4 v3, s[28:31], s26 offen offset:1024 lds
    s_sub_u32 s73, s70, 5
    s_lshl_b32 s73, s73, 4
    s_add_u32 s73, s73, s69
    v_mfma_f32_32x32x16_bf16 v[80:95], v[44:47], a[0:3], 0
    ds_read_b64_tr_b16 v[60:61], v28 offset:20480
    ds_read_b64_tr_b16 v[62:63], v28 offset:20992
    buffer_load_dwordx4 v4, s[28:31], s26 offen offset:2048 lds
    s_and_b32 s73, s73, 127
    s_lshl_b32 s91, s73, 2
    s_lshl_b32 s0, s73, 7
    s_waitcnt lgkmcnt(4)
    v_mfma_f32_32x32x16_bf16 v[64:79], v[48:51], a[4:7], v[64:79]
    ds_read_b64_tr_b16 v[40:41], v26 offset:22528
    ds_read_b64_tr_b16 v[42:43], v26 offset:23040
    buffer_load_dwordx4 v5, s[28:31], s26 offen offset:3072 lds
    s_add_u32 s0, s0, 0x8000
    s_add_u32 s73, s91, s68
    s_add_u32 s73, s73, 0
    s_add_u32 m0, s71, 0x18000
    s_mov_b32 s26, 0x300
    v_mfma_f32_32x32x16_bf16 v[80:95], v[52:55], a[4:7], v[80:95]
    ds_read_b64_tr_b16 v[44:45], v28 offset:22528
    ds_read_b64_tr_b16 v[46:47], v28 offset:23040
    buffer_load_dwordx4 v2, s[28:31], s26 offen lds
    buffer_load_dwordx4 v3, s[28:31], s26 offen offset:1024 lds
    s_mul_i32 s75, s73, 886
    s_lshr_b32 s75, s75, 16
    s_mul_i32 s74, s75, 74
    s_sub_u32 s74, s73, s74
    s_waitcnt lgkmcnt(4)
    v_mfma_f32_32x32x16_bf16 v[64:79], v[56:59], a[8:11], v[64:79]
    ds_read_b64_tr_b16 v[48:49], v26 offset:24576
    ds_read_b64_tr_b16 v[50:51], v26 offset:25088
    buffer_load_dwordx4 v4, s[28:31], s26 offen offset:2048 lds
    v_mfma_f32_32x32x16_bf16 v[80:95], v[60:63], a[8:11], v[80:95]
    ds_read_b64_tr_b16 v[52:53], v28 offset:24576
    ds_read_b64_tr_b16 v[54:55], v28 offset:25088
    buffer_load_dwordx4 v5, s[28:31], s26 offen offset:3072 lds
    s_cmp_lt_u32 s74, 54
    s_cselect_b32 s64, s18, s10
    s_cselect_b32 s65, s19, s11
    s_mov_b32 s66, 819200
    s_cselect_b32 s66, 2211840, s66
    s_cselect_b32 s3, 0, 2
    s_waitcnt lgkmcnt(4)
    v_mfma_f32_32x32x16_bf16 v[64:79], v[40:43], a[12:15], v[64:79]
    ds_read_b64_tr_b16 v[56:57], v26 offset:26624
    ds_read_b64_tr_b16 v[58:59], v26 offset:27136
    s_and_b32 s65, s65, 0xffff
    s_cmp_lt_u32 s73, 740
    s_cselect_b32 s66, s66, 0
    s_cselect_b32 s99, 0, 0x80000000
    v_mfma_f32_32x32x16_bf16 v[80:95], v[44:47], a[12:15], v[80:95]
    ds_read_b64_tr_b16 v[60:61], v28 offset:26624
    ds_read_b64_tr_b16 v[62:63], v28 offset:27136
    s_add_u32 s3, s3, s74
    s_mul_i32 s3, s3, 5120
    s_waitcnt lgkmcnt(4)
    v_mfma_f32_32x32x16_bf16 v[64:79], v[48:51], a[16:19], v[64:79]
    ds_read_b64_tr_b16 v[40:41], v26 offset:28672
    ds_read_b64_tr_b16 v[42:43], v26 offset:29184
    s_add_u32 s3, s3, 0x200000
    s_lshl_b32 s73, s75, 2
    s_add_u32 s73, s73, 0
    v_mfma_f32_32x32x16_bf16 v[80:95], v[52:55], a[16:19], v[80:95]
    ds_read_b64_tr_b16 v[44:45], v28 offset:28672
    ds_read_b64_tr_b16 v[46:47], v28 offset:29184
    s_mul_i32 s76, s73, 205
    s_lshr_b32 s76, s76, 10
    s_mul_i32 s20, s76, 384000
    s_waitcnt lgkmcnt(4)
    v_mfma_f32_32x32x16_bf16 v[64:79], v[56:59], a[20:23], v[64:79]
    ds_read_b64_tr_b16 v[48:49], v26 offset:30720
    ds_read_b64_tr_b16 v[50:51], v26 offset:31232
    s_lshl_b32 s73, s73, 10
    s_add_u32 s20, s20, s73
    s_add_u32 s20, s20, s3
    s_lshl_b32 s73, s75, 2
    v_mfma_f32_32x32x16_bf16 v[80:95], v[60:63], a[20:23], v[80:95]
    ds_read_b64_tr_b16 v[52:53], v28 offset:30720
    ds_read_b64_tr_b16 v[54:55], v28 offset:31232
    s_add_u32 s73, s73, 1
    s_mul_i32 s76, s73, 205
    s_lshr_b32 s76, s76, 10
    s_waitcnt lgkmcnt(4)
    v_mfma_f32_32x32x16_bf16 v[64:79], v[40:43], a[24:27], v[64:79]
    s_waitcnt vmcnt(26)
    s_waitcnt lgkmcnt(0)
    ds_read_b128 a[32:35], v6 offset:32768
    ds_read_b128 a[36:39], v7 offset:32768
    ds_read_b128 a[40:43], v8 offset:32768
    ds_read_b128 a[44:47], v9 offset:32768
    s_waitcnt vmcnt(16)
    ds_read_b128 a[48:51], v6 offset:49152
    ds_read_b128 a[52:55], v7 offset:49152
    ds_read_b128 a[56:59], v8 offset:49152
    ds_read_b128 a[60:63], v9 offset:49152
    s_barrier
    v_mov_b32 v35, s72
    buffer_store_dword v35, v32, s[40:43], s1 offen sc1
    ds_read_b64_tr_b16 v[56:57], v27 offset:49152
    ds_read_b64_tr_b16 v[58:59], v27 offset:49664
    s_add_u32 m0, s71, 0x4000
    s_add_u32 s26, s80, 1474560
    buffer_load_dwordx4 v18, s[32:35], s26 offen lds
    buffer_load_dwordx4 v19, s[32:35], s26 offen offset:1024 lds
    s_mul_i32 s21, s76, 384000
    s_lshl_b32 s73, s73, 10
    s_add_u32 s21, s21, s73
    v_mfma_f32_32x32x16_bf16 v[80:95], v[44:47], a[24:27], v[80:95]
    ds_read_b64_tr_b16 v[60:61], v29 offset:49152
    ds_read_b64_tr_b16 v[62:63], v29 offset:49664
    buffer_load_dwordx4 v20, s[32:35], s26 offen offset:2048 lds
    s_add_u32 s21, s21, s3
    s_lshl_b32 s73, s75, 2
    s_add_u32 s73, s73, 2
    v_mfma_f32_32x32x16_bf16 v[64:79], v[48:51], a[28:31], v[64:79]
    ds_read_b64_tr_b16 v[40:41], v27 offset:51200
    ds_read_b64_tr_b16 v[42:43], v27 offset:51712
    buffer_load_dwordx4 v21, s[32:35], s26 offen offset:3072 lds
    s_mul_i32 s76, s73, 205
    s_lshr_b32 s76, s76, 10
    s_mul_i32 s22, s76, 384000
    s_add_u32 m0, s71, 0x8000
    s_mov_b32 s26, 0x380
    v_mfma_f32_32x32x16_bf16 v[80:95], v[52:55], a[28:31], v[80:95]
    ds_read_b64_tr_b16 v[44:45], v29 offset:51200
    ds_read_b64_tr_b16 v[46:47], v29 offset:51712
    s_waitcnt lgkmcnt(12)
    buffer_load_dwordx4 v2, s[28:31], s26 offen lds
    buffer_load_dwordx4 v3, s[28:31], s26 offen offset:1024 lds
    s_lshl_b32 s73, s73, 10
    s_add_u32 s22, s22, s73
    s_add_u32 s22, s22, s3
    s_waitcnt lgkmcnt(4)
    v_mfma_f32_32x32x16_bf16 v[64:79], v[56:59], a[32:35], v[64:79]
    ds_read_b64_tr_b16 v[48:49], v27 offset:53248
    ds_read_b64_tr_b16 v[50:51], v27 offset:53760
    buffer_load_dwordx4 v4, s[28:31], s26 offen offset:2048 lds
    s_lshl_b32 s73, s75, 2
    s_add_u32 s73, s73, 3
    s_mul_i32 s76, s73, 205
    v_mfma_f32_32x32x16_bf16 v[80:95], v[60:63], a[32:35], v[80:95]
    ds_read_b64_tr_b16 v[52:53], v29 offset:53248
    ds_read_b64_tr_b16 v[54:55], v29 offset:53760
    buffer_load_dwordx4 v5, s[28:31], s26 offen offset:3072 lds
    s_lshr_b32 s76, s76, 10
    s_mul_i32 s23, s76, 384000
    s_lshl_b32 s73, s73, 10
    s_add_u32 s23, s23, s73
    s_add_u32 m0, s71, 0xc000
    s_mov_b32 s26, 0x400
    s_waitcnt lgkmcnt(4)
    v_mfma_f32_32x32x16_bf16 v[64:79], v[40:43], a[36:39], v[64:79]
    ds_read_b64_tr_b16 v[56:57], v27 offset:55296
    ds_read_b64_tr_b16 v[58:59], v27 offset:55808
    buffer_load_dwordx4 v2, s[28:31], s26 offen lds
    s_add_u32 s23, s23, s3
    v_lshrrev_b32 v248, 3, v1
    v_lshrrev_b32 v249, 5, v1
    v_mfma_f32_32x32x16_bf16 v[80:95], v[44:47], a[36:39], v[80:95]
    ds_read_b64_tr_b16 v[60:61], v29 offset:55296
    ds_read_b64_tr_b16 v[62:63], v29 offset:55808
    buffer_load_dwordx4 v3, s[28:31], s26 offen offset:1024 lds
    s_cmp_ge_u32 s74, 70
    s_cselect_b32 s73, 16, 0
    v_mul_u32_u24 v249, s73, v249
    s_waitcnt lgkmcnt(4)
    v_mfma_f32_32x32x16_bf16 v[64:79], v[48:51], a[40:43], v[64:79]
    ds_read_b64_tr_b16 v[40:41], v27 offset:57344
    ds_read_b64_tr_b16 v[42:43], v27 offset:57856
    buffer_load_dwordx4 v4, s[28:31], s26 offen offset:2048 lds
    v_add_u32 v248, v248, v249
    v_mul_u32_u24 v248, 1280, v248
    v_and_b32 v249, 7, v1
    v_mfma_f32_32x32x16_bf16 v[80:95], v[52:55], a[40:43], v[80:95]
    ds_read_b64_tr_b16 v[44:45], v29 offset:57344
    ds_read_b64_tr_b16 v[46:47], v29 offset:57856
    buffer_load_dwordx4 v5, s[28:31], s26 offen offset:3072 lds
    v_lshl_add_u32 v248, v249, 4, v248
    s_lshl_b32 s73, s74, 5
    s_sub_u32 s76, s74, 54
    s_waitcnt lgkmcnt(4)
    v_mfma_f32_32x32x16_bf16 v[64:79], v[56:59], a[44:47], v[64:79]
    ds_read_b64_tr_b16 v[48:49], v27 offset:59392
    ds_read_b64_tr_b16 v[50:51], v27 offset:59904
    s_mul_i32 s76, s76, 40
    s_cmp_ge_u32 s74, 54
    s_cselect_b32 s73, s76, s73
    s_mov_b32 s12, 20480
    s_cselect_b32 s12, 25600, s12
    v_mfma_f32_32x32x16_bf16 v[80:95], v[60:63], a[44:47], v[80:95]
    ds_read_b64_tr_b16 v[52:53], v29 offset:59392
    ds_read_b64_tr_b16 v[54:55], v29 offset:59904
    s_sub_u32 s76, s74, 70
    s_waitcnt lgkmcnt(4)
    v_mfma_f32_32x32x16_bf16 v[64:79], v[40:43], a[48:51], v[64:79]
    ds_read_b64_tr_b16 v[56:57], v27 offset:61440
    ds_read_b64_tr_b16 v[58:59], v27 offset:61952
    s_mul_i32 s76, s76, 160
    s_add_u32 s76, s76, 16
    v_mfma_f32_32x32x16_bf16 v[80:95], v[44:47], a[48:51], v[80:95]
    ds_read_b64_tr_b16 v[60:61], v29 offset:61440
    ds_read_b64_tr_b16 v[62:63], v29 offset:61952
    s_cmp_ge_u32 s74, 70
    s_cselect_b32 s73, s76, s73
    s_cselect_b32 s12, 102400, s12
    s_mov_b32 s74, 10240
    s_cselect_b32 s74, 51200, s74
    s_waitcnt lgkmcnt(4)
    v_mfma_f32_32x32x16_bf16 v[64:79], v[48:51], a[52:55], v[64:79]
    ds_read_b64_tr_b16 v[40:41], v27 offset:63488
    ds_read_b64_tr_b16 v[42:43], v27 offset:64000
    s_mul_i32 s73, s73, 1280
    s_lshl_b32 s75, s75, 7
    s_add_u32 s3, s73, s75
    v_mfma_f32_32x32x16_bf16 v[80:95], v[52:55], a[52:55], v[80:95]
    ds_read_b64_tr_b16 v[44:45], v29 offset:63488
    ds_read_b64_tr_b16 v[46:47], v29 offset:64000
    s_add_u32 s24, s3, s74
    s_add_u32 s13, s24, s12
    s_add_u32 s12, s3, s12
    s_waitcnt lgkmcnt(4)
    v_mfma_f32_32x32x16_bf16 v[64:79], v[56:59], a[56:59], v[64:79]
    s_waitcnt vmcnt(25)
    s_waitcnt lgkmcnt(0)
    ds_read_b128 a[64:67], v6 offset:0
    ds_read_b128 a[68:71], v7 offset:0
    ds_read_b128 a[72:75], v8 offset:0
    ds_read_b128 a[76:79], v9 offset:0
    s_waitcnt vmcnt(17)
    ds_read_b128 a[80:83], v10 offset:16384
    ds_read_b128 a[84:87], v11 offset:16384
    ds_read_b128 a[88:91], v12 offset:16384
    ds_read_b128 a[92:95], v13 offset:16384
    s_barrier
    ds_read_b64_tr_b16 v[48:49], v27 offset:0
    ds_read_b64_tr_b16 v[50:51], v27 offset:512
    s_waitcnt lgkmcnt(2)
    s_add_u32 m0, s71, 0x14000
    s_add_u32 s26, s80, 1966080
    buffer_load_dwordx4 v18, s[32:35], s26 offen lds
    buffer_load_dwordx4 v19, s[32:35], s26 offen offset:1024 lds
    v_mfma_f32_32x32x16_bf16 v[80:95], v[60:63], a[56:59], v[80:95]
    ds_read_b64_tr_b16 v[52:53], v29 offset:0
    ds_read_b64_tr_b16 v[54:55], v29 offset:512
    buffer_load_dwordx4 v20, s[32:35], s26 offen offset:2048 lds
    v_mfma_f32_32x32x16_bf16 v[64:79], v[40:43], a[60:63], v[64:79]
    ds_read_b64_tr_b16 v[56:57], v27 offset:2048
    ds_read_b64_tr_b16 v[58:59], v27 offset:2560
    buffer_load_dwordx4 v21, s[32:35], s26 offen offset:3072 lds
    s_add_u32 m0, s71, 0x0
    s_mov_b32 s26, 0x480
    v_mfma_f32_32x32x16_bf16 v[80:95], v[44:47], a[60:63], v[80:95]
    ds_read_b64_tr_b16 v[60:61], v29 offset:2048
    ds_read_b64_tr_b16 v[62:63], v29 offset:2560
    buffer_load_dwordx4 v2, s[28:31], s26 offen lds
    buffer_load_dwordx4 v3, s[28:31], s26 offen offset:1024 lds
    s_waitcnt lgkmcnt(4)
    v_mfma_f32_32x32x16_bf16 v[64:79], v[48:51], a[64:67], v[64:79]
    ds_read_b64_tr_b16 v[40:41], v27 offset:4096
    ds_read_b64_tr_b16 v[42:43], v27 offset:4608
    buffer_load_dwordx4 v4, s[28:31], s26 offen offset:2048 lds
    s_mul_i32 s76, s93, 5
    s_lshr_b32 s76, s76, 1
    s_lshr_b32 s73, s76, 3
    s_add_u32 s74, s76, 2
    s_lshr_b32 s74, s74, 3
    s_sub_u32 s74, s74, s73
    s_lshl_b32 s75, s94, 5
    s_add_u32 s73, s73, s75
    s_add_u32 s73, s73, 896
    v_mfma_f32_32x32x16_bf16 v[80:95], v[52:55], a[64:67], v[80:95]
    ds_read_b64_tr_b16 v[44:45], v29 offset:4096
    ds_read_b64_tr_b16 v[46:47], v29 offset:4608
    buffer_load_dwordx4 v5, s[28:31], s26 offen offset:3072 lds
    v_and_b32 v164, 1, v1
    v_mul_u32_u24 v164, s74, v164
    v_bfe_u32 v165, v1, 1, 1
    v_lshl_add_u32 v164, v165, 4, v164
    v_add_u32 v164, s73, v164
    v_lshlrev_b32 v164, 7, v164
    v_add_u32 v20, 0x10000, v164
    s_lshr_b32 s73, s93, 2
    s_lshl_b32 s73, s73, 4
    s_add_u32 m0, s71, 0x1c000
    s_mov_b32 s26, s79
    s_waitcnt lgkmcnt(4)
    v_mfma_f32_32x32x16_bf16 v[64:79], v[56:59], a[68:71], v[64:79]
    ds_read_b64_tr_b16 v[48:49], v27 offset:6144
    ds_read_b64_tr_b16 v[50:51], v27 offset:6656
    buffer_load_dwordx4 v204, s[48:51], s26 offen lds
    s_add_u32 s73, s73, 1152
    v_and_b32 v164, 15, v1
    v_add_u32 v164, s73, v164
    v_lshlrev_b32 v164, 7, v164
    v_add_u32 v21, 0x10000, v164
    s_lshl_b32 s73, s94, 4
    s_lshl_b32 s74, s68, 2
    s_add_u32 s73, s73, s74
    v_lshrrev_b32 v164, 4, v1
    v_mfma_f32_32x32x16_bf16 v[80:95], v[60:63], a[68:71], v[80:95]
    ds_read_b64_tr_b16 v[52:53], v29 offset:6144
    ds_read_b64_tr_b16 v[54:55], v29 offset:6656
    buffer_load_dwordx4 v205, s[48:51], s26 offen offset:1024 lds
    v_add_u32 v164, s73, v164
    s_mov_b32 s73, 98304
    v_mul_lo_u32 v164, v164, s73
    v_add_u32 v164, 0x500000, v164
    v_and_b32 v165, 15, v1
    v_lshl_add_u32 v252, v165, 4, v164
    v_lshl_add_u32 v253, v165, 3, v164
    s_and_b32 s73, s93, 1
    s_mul_i32 s73, s73, 160
    s_waitcnt lgkmcnt(4)
    v_mfma_f32_32x32x16_bf16 v[64:79], v[40:43], a[72:75], v[64:79]
    ds_read_b64_tr_b16 v[56:57], v27 offset:8192
    ds_read_b64_tr_b16 v[58:59], v27 offset:8704
    buffer_load_dwordx4 v206, s[48:51], s26 offen offset:2048 lds
    s_sub_u32 s73, 0x260a0, s73
    v_bfe_u32 v164, v1, 2, 2
    v_mul_u32_u24 v164, 40, v164
    v_bfe_u32 v165, v1, 4, 1
    v_bfe_u32 v166, v1, 1, 1
    v_lshl_add_u32 v165, v165, 1, v166
    v_lshl_add_u32 v164, v165, 3, v164
    v_add_u32 v164, s73, v164
    v_lshrrev_b32 v166, 5, v1
    v_mfma_f32_32x32x16_bf16 v[80:95], v[44:47], a[72:75], v[80:95]
    ds_read_b64_tr_b16 v[60:61], v29 offset:8192
    ds_read_b64_tr_b16 v[62:63], v29 offset:8704
    buffer_load_dwordx4 v207, s[48:51], s26 offen offset:3072 lds
    s_mov_b32 s79, s26
    v_and_b32 v23, 1, v1
    v_xor_b32 v166, v166, v23
    v_cmp_eq_u32 vcc, 0, v166
    v_mov_b32 v23, 0x26400
    v_or_b32 v166, v166, v165
    v_cndmask_b32 v22, v23, v164, vcc
    v_cmp_eq_u32 vcc, 0, v166
    v_add_u32 v164, 32, v164
    s_nop 0
    v_cndmask_b32 v23, v23, v164, vcc
    s_add_u32 m0, s71, 0x20000
    s_waitcnt lgkmcnt(4)
    v_mfma_f32_32x32x16_bf16 v[64:79], v[48:51], a[76:79], v[64:79]
    ds_read_b64_tr_b16 v[40:41], v27 offset:10240
    ds_read_b64_tr_b16 v[42:43], v27 offset:10752
    buffer_load_dwordx4 v248, s[64:67], s3 offen lds
    s_lshl_b32 s73, s68, 5
    v_and_b32 v164, 31, v1
    v_add_u32 v164, s73, v164
    v_lshrrev_b32 v165, 5, v1
    v_lshlrev_b32 v25, 4, v164
    v_lshl_add_u32 v25, v165, 14, v25
    s_lshl_b32 s74, s93, 15
    s_add_u32 s74, s74, 0x100000
    s_add_u32 m0, s71, 0x20400
    v_mfma_f32_32x32x16_bf16 v[80:95], v[52:55], a[76:79], v[80:95]
    ds_read_b64_tr_b16 v[44:45], v29 offset:10240
    ds_read_b64_tr_b16 v[46:47], v29 offset:10752
    buffer_load_dwordx4 v248, s[64:67], s24 offen lds
    v_add_u32 v25, s74, v25
    v_and_b32 v166, 15, v164
    v_lshrrev_b32 v167, 4, v164
    v_mul_u32_u24 v166, 80, v166
    v_lshl_add_u32 v166, v167, 4, v166
    v_lshl_add_u32 v254, v165, 3, v166
    v_and_b32 v166, 7, v164
    v_bfe_u32 v167, v164, 3, 2
    v_mul_u32_u24 v166, 80, v166
    s_add_u32 m0, s71, 0x20800
    s_waitcnt lgkmcnt(4)
    v_mfma_f32_32x32x16_bf16 v[64:79], v[56:59], a[80:83], v[64:79]
    ds_read_b64_tr_b16 v[48:49], v27 offset:12288
    ds_read_b64_tr_b16 v[50:51], v27 offset:12800
    buffer_load_dwordx4 v248, s[64:67], s12 offen lds
    v_lshl_add_u32 v166, v167, 4, v166
    v_lshl_add_u32 v166, v165, 3, v166
    v_add_u32 v166, 1280, v166
    v_cmp_le_u32 vcc, 64, v164
    v_and_b32 v167, 15, v164
    v_lshl_add_u32 v167, v167, 1, v165
    v_cndmask_b32 v254, v254, v166, vcc
    v_and_b32 v168, 15, v167
    v_mul_u32_u24 v168, 80, v168
    s_add_u32 m0, s71, 0x20c00
    v_mfma_f32_32x32x16_bf16 v[80:95], v[60:63], a[80:83], v[80:95]
    ds_read_b64_tr_b16 v[52:53], v29 offset:12288
    ds_read_b64_tr_b16 v[54:55], v29 offset:12800
    buffer_load_dwordx4 v248, s[64:67], s13 offen lds
    v_lshrrev_b32 v169, 4, v167
    v_lshl_add_u32 v168, v169, 3, v168
    v_add_u32 v168, 64, v168
    v_cmp_le_u32 vcc, 96, v164
    v_and_b32 v169, 7, v167
    v_mul_u32_u24 v169, 80, v169
    v_cndmask_b32 v254, v254, v168, vcc
    v_bfe_u32 v168, v167, 3, 1
    v_lshl_add_u32 v169, v168, 3, v169
    s_waitcnt lgkmcnt(4)
    v_mfma_f32_32x32x16_bf16 v[64:79], v[40:43], a[84:87], v[64:79]
    ds_read_b64_tr_b16 v[56:57], v27 offset:14336
    ds_read_b64_tr_b16 v[58:59], v27 offset:14848
    v_add_u32 v169, 1344, v169
    v_cmp_le_u32 vcc, 112, v164
    v_mov_b32 v168, 2560
    s_nop 0
    v_cndmask_b32 v254, v254, v169, vcc
    v_cmp_le_u32 vcc, 120, v164
    s_nop 1
    v_cndmask_b32 v254, v254, v168, vcc
    v_add_u32 v254, 0x24000, v254
    v_mfma_f32_32x32x16_bf16 v[80:95], v[44:47], a[84:87], v[80:95]
    ds_read_b64_tr_b16 v[60:61], v29 offset:14336
    ds_read_b64_tr_b16 v[62:63], v29 offset:14848
    s_add_u32 s73, s91, s68
    s_add_u32 s73, s73, 512
    s_mul_i32 s75, s73, 886
    s_lshr_b32 s75, s75, 16
    s_mul_i32 s74, s75, 74
    s_sub_u32 s74, s73, s74
    s_waitcnt lgkmcnt(4)
    v_mfma_f32_32x32x16_bf16 v[64:79], v[48:51], a[88:91], v[64:79]
    s_waitcnt vmcnt(29)
    s_waitcnt lgkmcnt(0)
    ds_read_b128 a[96:99], v10 offset:32768
    ds_read_b128 a[100:103], v11 offset:32768
    ds_read_b128 a[104:107], v12 offset:32768
    ds_read_b128 a[108:111], v13 offset:32768
    s_waitcnt vmcnt(20)
    ds_read_b128 a[112:115], v6 offset:32768
    ds_read_b128 a[116:119], v7 offset:32768
    ds_read_b128 a[120:123], v8 offset:32768
    ds_read_b128 a[124:127], v9 offset:32768
    s_barrier
    ds_read_b64_tr_b16 v[40:41], v26 offset:16384
    ds_read_b64_tr_b16 v[42:43], v26 offset:16896
    s_cmp_lt_u32 s74, 54
    s_cselect_b32 s64, s18, s10
    s_cselect_b32 s65, s19, s11
    s_mov_b32 s66, 819200
    s_cselect_b32 s66, 2211840, s66
    s_cselect_b32 s3, 0, 2
    v_mfma_f32_32x32x16_bf16 v[80:95], v[52:55], a[88:91], v[80:95]
    ds_read_b64_tr_b16 v[44:45], v28 offset:16384
    ds_read_b64_tr_b16 v[46:47], v28 offset:16896
    s_and_b32 s65, s65, 0xffff
    s_cmp_lt_u32 s73, 740
    s_cselect_b32 s66, s66, 0
    s_cselect_b32 s9, 0, 0x80000000
    s_add_u32 s3, s3, s74
    s_mul_i32 s3, s3, 5120
    s_add_u32 s3, s3, 0x200000
    v_mfma_f32_32x32x16_bf16 v[64:79], v[56:59], a[92:95], v[64:79]
    ds_read_b64_tr_b16 v[48:49], v26 offset:18432
    ds_read_b64_tr_b16 v[50:51], v26 offset:18944
    buffer_load_dword v115, v125, s[40:43], 0 offen sc1
    s_lshl_b32 s73, s75, 2
    s_add_u32 s73, s73, 0
    s_mul_i32 s76, s73, 205
    s_lshr_b32 s76, s76, 10
    s_mul_i32 s4, s76, 384000
    s_lshl_b32 s73, s73, 10
    v_mfma_f32_32x32x16_bf16 v[80:95], v[60:63], a[92:95], v[80:95]
    ds_read_b64_tr_b16 v[52:53], v28 offset:18432
    ds_read_b64_tr_b16 v[54:55], v28 offset:18944
    s_add_u32 s4, s4, s73
    s_add_u32 s4, s4, s3
    s_lshl_b32 s73, s75, 2
    s_add_u32 s73, s73, 1
    s_mul_i32 s76, s73, 205
    s_lshr_b32 s76, s76, 10
    s_add_u32 m0, s71, 0x18000
    s_add_u32 s26, s79, s78
    s_waitcnt lgkmcnt(4)
    v_mfma_f32_32x32x16_bf16 v[64:79], v[40:43], a[96:99], v[64:79]
    ds_read_b64_tr_b16 v[56:57], v26 offset:20480
    ds_read_b64_tr_b16 v[58:59], v26 offset:20992
    buffer_load_dwordx4 v204, s[48:51], s26 offen lds
    s_mul_i32 s5, s76, 384000
    s_lshl_b32 s73, s73, 10
    s_add_u32 s5, s5, s73
    s_add_u32 s5, s5, s3
    s_lshl_b32 s73, s75, 2
    s_add_u32 s73, s73, 2
    v_mfma_f32_32x32x16_bf16 v[80:95], v[44:47], a[96:99], v[80:95]
    ds_read_b64_tr_b16 v[60:61], v28 offset:20480
    ds_read_b64_tr_b16 v[62:63], v28 offset:20992
    s_mul_i32 s76, s73, 205
    s_lshr_b32 s76, s76, 10
    s_mul_i32 s16, s76, 384000
    s_lshl_b32 s73, s73, 10
    s_add_u32 s16, s16, s73
    s_add_u32 s16, s16, s3
    s_lshl_b32 s73, s75, 2
    s_waitcnt lgkmcnt(4)
    v_mfma_f32_32x32x16_bf16 v[64:79], v[48:51], a[100:103], v[64:79]
    ds_read_b64_tr_b16 v[40:41], v26 offset:22528
    ds_read_b64_tr_b16 v[42:43], v26 offset:23040
    buffer_load_dwordx4 v205, s[48:51], s26 offen offset:1024 lds
    s_add_u32 s73, s73, 3
    s_mul_i32 s76, s73, 205
    s_lshr_b32 s76, s76, 10
    s_mul_i32 s17, s76, 384000
    s_lshl_b32 s73, s73, 10
    s_add_u32 s17, s17, s73
    v_mfma_f32_32x32x16_bf16 v[80:95], v[52:55], a[100:103], v[80:95]
    ds_read_b64_tr_b16 v[44:45], v28 offset:22528
    ds_read_b64_tr_b16 v[46:47], v28 offset:23040
    s_add_u32 s17, s17, s3
    v_lshrrev_b32 v248, 3, v1
    v_lshrrev_b32 v249, 5, v1
    s_cmp_ge_u32 s74, 70
    s_cselect_b32 s73, 16, 0
    v_mul_u32_u24 v249, s73, v249
    s_waitcnt lgkmcnt(4)
    v_mfma_f32_32x32x16_bf16 v[64:79], v[56:59], a[104:107], v[64:79]
    ds_read_b64_tr_b16 v[48:49], v26 offset:24576
    ds_read_b64_tr_b16 v[50:51], v26 offset:25088
    buffer_load_dwordx4 v206, s[48:51], s26 offen offset:2048 lds
    v_add_u32 v248, v248, v249
    v_mul_u32_u24 v248, 1280, v248
    v_and_b32 v249, 7, v1
    v_lshl_add_u32 v248, v249, 4, v248
    s_lshl_b32 s73, s74, 5
    s_sub_u32 s76, s74, 54
    v_mfma_f32_32x32x16_bf16 v[80:95], v[60:63], a[104:107], v[80:95]
    ds_read_b64_tr_b16 v[52:53], v28 offset:24576
    ds_read_b64_tr_b16 v[54:55], v28 offset:25088
    s_mul_i32 s76, s76, 40
    s_cmp_ge_u32 s74, 54
    s_cselect_b32 s73, s76, s73
    s_mov_b32 s12, 20480
    s_cselect_b32 s12, 25600, s12
    s_sub_u32 s76, s74, 70
    s_mul_i32 s76, s76, 160
    s_waitcnt lgkmcnt(4)
    v_mfma_f32_32x32x16_bf16 v[64:79], v[40:43], a[108:111], v[64:79]
    ds_read_b64_tr_b16 v[56:57], v26 offset:26624
    ds_read_b64_tr_b16 v[58:59], v26 offset:27136
    buffer_load_dwordx4 v207, s[48:51], s26 offen offset:3072 lds
    s_mov_b32 s79, s26
    s_add_u32 s76, s76, 16
    s_cmp_ge_u32 s74, 70
    s_cselect_b32 s73, s76, s73
    s_cselect_b32 s12, 102400, s12
    s_mov_b32 s74, 10240
    s_cselect_b32 s74, 51200, s74
    v_mfma_f32_32x32x16_bf16 v[80:95], v[44:47], a[108:111], v[80:95]
    ds_read_b64_tr_b16 v[60:61], v28 offset:26624
    ds_read_b64_tr_b16 v[62:63], v28 offset:27136
    s_mul_i32 s73, s73, 1280
    s_lshl_b32 s75, s75, 7
    s_add_u32 s3, s73, s75
    s_add_u32 s24, s3, s74
    s_add_u32 s13, s24, s12
    s_add_u32 s12, s3, s12
    s_waitcnt lgkmcnt(4)
    v_mfma_f32_32x32x16_bf16 v[64:79], v[48:51], a[112:115], v[64:79]
    ds_read_b64_tr_b16 v[40:41], v26 offset:28672
    ds_read_b64_tr_b16 v[42:43], v26 offset:29184
    v_lshrrev_b32 v250, 4, v1
    v_bfe_u32 v251, v1, 2, 2
    v_lshl_add_u32 v250, v250, 3, v251
    v_and_b32 v251, 3, v1
    v_lshlrev_b32 v251, 3, v251
    v_lshl_add_u32 v250, v250, 7, v251
    v_add_u32 v250, s71, v250
    v_mfma_f32_32x32x16_bf16 v[80:95], v[52:55], a[112:115], v[80:95]
    ds_read_b64_tr_b16 v[44:45], v28 offset:28672
    ds_read_b64_tr_b16 v[46:47], v28 offset:29184
    v_add_u32 v250, 0x20000, v250
    v_lshlrev_b32 v251, 4, v1
    v_or_b32 v251, s99, v251
    s_waitcnt vmcnt(5)
    ds_read_b64_tr_b16 v[128:129], v250 offset:0
    ds_read_b64_tr_b16 v[130:131], v250 offset:512
    ds_read_b64_tr_b16 v[132:133], v250 offset:32
    s_waitcnt lgkmcnt(7)
    v_mfma_f32_32x32x16_bf16 v[64:79], v[56:59], a[116:119], v[64:79]
    ds_read_b64_tr_b16 v[48:49], v26 offset:30720
    ds_read_b64_tr_b16 v[50:51], v26 offset:31232
    ds_read_b64_tr_b16 v[134:135], v250 offset:544
    ds_read_b64_tr_b16 v[136:137], v250 offset:64
    ds_read_b64_tr_b16 v[138:139], v250 offset:576
    ds_read_b64_tr_b16 v[140:141], v250 offset:96
    ds_read_b64_tr_b16 v[142:143], v250 offset:608
    v_mfma_f32_32x32x16_bf16 v[80:95], v[60:63], a[116:119], v[80:95]
    ds_read_b64_tr_b16 v[52:53], v28 offset:30720
    ds_read_b64_tr_b16 v[54:55], v28 offset:31232
    s_waitcnt lgkmcnt(12)
    v_mfma_f32_32x32x16_bf16 v[64:79], v[40:43], a[120:123], v[64:79]
    s_waitcnt lgkmcnt(0)
    ds_read_b128 a[128:131], v6 offset:49152
    ds_read_b128 a[132:135], v7 offset:49152
    ds_read_b128 a[136:139], v8 offset:49152
    ds_read_b128 a[140:143], v9 offset:49152
    ds_read_b128 a[144:147], v6 offset:0
    ds_read_b128 a[148:151], v7 offset:0
    ds_read_b128 a[152:155], v8 offset:0
    ds_read_b128 a[156:159], v9 offset:0
    s_barrier
    ds_read_b64_tr_b16 v[56:57], v27 offset:16384
    ds_read_b64_tr_b16 v[58:59], v27 offset:16896
    buffer_store_dwordx4 v[128:131], v251, s[40:43], s20 offen sc1
    v_mfma_f32_32x32x16_bf16 v[80:95], v[44:47], a[120:123], v[80:95]
    ds_read_b64_tr_b16 v[60:61], v29 offset:16384
    ds_read_b64_tr_b16 v[62:63], v29 offset:16896
    buffer_store_dwordx4 v[132:135], v251, s[40:43], s21 offen sc1
    s_add_u32 m0, s71, 0x20000
    v_mfma_f32_32x32x16_bf16 v[64:79], v[48:51], a[124:127], v[64:79]
    ds_read_b64_tr_b16 v[40:41], v27 offset:18432
    ds_read_b64_tr_b16 v[42:43], v27 offset:18944
    buffer_load_dwordx4 v248, s[64:67], s3 offen lds
    buffer_store_dwordx4 v[136:139], v251, s[40:43], s22 offen sc1
    s_waitcnt vmcnt(8)
    v_cmp_ne_u32 vcc, s72, v115
    s_nop 4
    s_cbranch_vccnz Lslow2
Lback2:
    v_lshlrev_b32 v112, 2, v114
    v_subrev_u32 v113, 1920, v114
    s_add_u32 m0, s71, 0x20400
    v_mfma_f32_32x32x16_bf16 v[80:95], v[52:55], a[124:127], v[80:95]
    ds_read_b64_tr_b16 v[44:45], v29 offset:18432
    ds_read_b64_tr_b16 v[46:47], v29 offset:18944
    buffer_load_dwordx4 v248, s[64:67], s24 offen lds
    buffer_store_dwordx4 v[140:143], v251, s[40:43], s23 offen sc1
    v_cmp_le_u32 vcc, 1920, v114
    v_lshlrev_b32 v113, 1, v113
    v_mov_b32 v115, 0x80000000
    v_cndmask_b32 v113, v115, v113, vcc
    s_add_u32 m0, s71, 0x20800
    s_waitcnt lgkmcnt(4)
    v_mfma_f32_32x32x16_bf16 v[64:79], v[56:59], a[128:131], v[64:79]
    ds_read_b64_tr_b16 v[48:49], v27 offset:20480
    ds_read_b64_tr_b16 v[50:51], v27 offset:20992
    buffer_load_dwordx4 v248, s[64:67], s12 offen lds
    s_mov_b32 s73, 0x60000
    buffer_load_dword v116, v112, s[40:43], s73 offen sc1
    s_mov_b32 s73, 0x64000
    s_add_u32 m0, s71, 0x20c00
    v_mfma_f32_32x32x16_bf16 v[80:95], v[60:63], a[128:131], v[80:95]
    ds_read_b64_tr_b16 v[52:53], v29 offset:20480
    ds_read_b64_tr_b16 v[54:55], v29 offset:20992
    buffer_load_dwordx4 v248, s[64:67], s13 offen lds
    buffer_load_dword v117, v112, s[40:43], s73 offen sc1
    s_mov_b32 s73, 0x68000
    s_waitcnt lgkmcnt(4)
    v_mfma_f32_32x32x16_bf16 v[64:79], v[40:43], a[132:135], v[64:79]
    ds_read_b64_tr_b16 v[56:57], v27 offset:22528
    ds_read_b64_tr_b16 v[58:59], v27 offset:23040
    buffer_load_dword v118, v112, s[40:43], s73 offen sc1
    s_mov_b32 s73, 0x6c000
    buffer_load_dword v119, v112, s[40:43], s73 offen sc1
    v_mfma_f32_32x32x16_bf16 v[80:95], v[44:47], a[132:135], v[80:95]
    ds_read_b64_tr_b16 v[60:61], v29 offset:22528
    ds_read_b64_tr_b16 v[62:63], v29 offset:23040
    s_mov_b32 s73, 0x70000
    buffer_load_dword v120, v112, s[40:43], s73 offen sc1
    s_add_u32 m0, s71, 0x8000
    s_add_u32 s26, s79, s78
    s_waitcnt lgkmcnt(4)
    v_mfma_f32_32x32x16_bf16 v[64:79], v[48:51], a[136:139], v[64:79]
    ds_read_b64_tr_b16 v[40:41], v27 offset:24576
    ds_read_b64_tr_b16 v[42:43], v27 offset:25088
    buffer_load_dwordx4 v204, s[48:51], s26 offen lds
    s_mov_b32 s73, 0x74000
    buffer_load_dword v121, v112, s[40:43], s73 offen sc1
    s_mov_b32 s73, 0x78000
    v_mfma_f32_32x32x16_bf16 v[80:95], v[52:55], a[136:139], v[80:95]
    ds_read_b64_tr_b16 v[44:45], v29 offset:24576
    ds_read_b64_tr_b16 v[46:47], v29 offset:25088
    buffer_load_dword v122, v112, s[40:43], s73 offen sc1
    s_mov_b32 s73, 0x7c000
    buffer_load_dword v123, v112, s[40:43], s73 offen sc1
    s_waitcnt lgkmcnt(4)
    v_mfma_f32_32x32x16_bf16 v[64:79], v[56:59], a[140:143], v[64:79]
    ds_read_b64_tr_b16 v[48:49], v27 offset:26624
    ds_read_b64_tr_b16 v[50:51], v27 offset:27136
    buffer_load_dwordx4 v205, s[48:51], s26 offen offset:1024 lds
    s_lshl_b32 s73, s69, 7
    v_mfma_f32_32x32x16_bf16 v[80:95], v[60:63], a[140:143], v[80:95]
    ds_read_b64_tr_b16 v[52:53], v29 offset:26624
    ds_read_b64_tr_b16 v[54:55], v29 offset:27136
    buffer_load_ushort v124, v113, s[56:59], 0 offen
    s_lshl_b32 s74, s68, 5
    s_add_u32 s73, s73, s74
    s_lshl_b32 s73, s73, 6
    s_add_u32 s73, s73, 0x40000
    s_waitcnt lgkmcnt(4)
    v_mfma_f32_32x32x16_bf16 v[64:79], v[40:43], a[144:147], v[64:79]
    ds_read_b64_tr_b16 v[56:57], v27 offset:28672
    ds_read_b64_tr_b16 v[58:59], v27 offset:29184
    buffer_load_dwordx4 v206, s[48:51], s26 offen offset:2048 lds
    v_and_b32 v112, 31, v1
    v_lshlrev_b32 v112, 6, v112
    v_cmp_gt_u32 vcc, 32, v1
    buffer_load_dwordx2 v[126:127], v112, s[40:43], s73 offen offset:16 sc1
    s_nop 0
    v_cndmask_b32 v113, v115, v112, vcc
    v_mfma_f32_32x32x16_bf16 v[80:95], v[44:47], a[144:147], v[80:95]
    ds_read_b64_tr_b16 v[60:61], v29 offset:28672
    ds_read_b64_tr_b16 v[62:63], v29 offset:29184
    buffer_load_dwordx4 v[36:39], v113, s[40:43], s73 offen sc1
    s_waitcnt lgkmcnt(4)
    v_mfma_f32_32x32x16_bf16 v[64:79], v[48:51], a[148:151], v[64:79]
    ds_read_b64_tr_b16 v[40:41], v27 offset:30720
    ds_read_b64_tr_b16 v[42:43], v27 offset:31232
    buffer_load_dwordx4 v207, s[48:51], s26 offen offset:3072 lds
    s_mov_b32 s79, s26
    v_mfma_f32_32x32x16_bf16 v[80:95], v[52:55], a[148:151], v[80:95]
    ds_read_b64_tr_b16 v[44:45], v29 offset:30720
    ds_read_b64_tr_b16 v[46:47], v29 offset:31232
    s_waitcnt lgkmcnt(4)
    v_mfma_f32_32x32x16_bf16 v[64:79], v[56:59], a[152:155], v[64:79]
    s_waitcnt lgkmcnt(0)
    s_barrier
    ds_read_b64_tr_b16 v[48:49], v27 offset:49152
    ds_read_b64_tr_b16 v[50:51], v27 offset:49664
    s_add_u32 m0, s71, 0x10000
    s_add_u32 s26, s79, s78
    v_mfma_f32_32x32x16_bf16 v[80:95], v[60:63], a[152:155], v[80:95]
    ds_read_b64_tr_b16 v[52:53], v27 offset:51200
    ds_read_b64_tr_b16 v[54:55], v27 offset:51712
    buffer_load_dwordx4 v204, s[48:51], s26 offen lds
    v_mfma_f32_32x32x16_bf16 v[64:79], v[40:43], a[156:159], v[64:79]
    ds_read_b64_tr_b16 v[56:57], v27 offset:53248
    ds_read_b64_tr_b16 v[58:59], v27 offset:53760
    buffer_load_dwordx4 v205, s[48:51], s26 offen offset:1024 lds
    v_mfma_f32_32x32x16_bf16 v[80:95], v[44:47], a[156:159], v[80:95]
    ds_read_b64_tr_b16 v[60:61], v27 offset:55296
    ds_read_b64_tr_b16 v[62:63], v27 offset:55808
    s_waitcnt lgkmcnt(4)
    v_mfma_f32_32x32x16_bf16 v[96:111], v[48:51], a[0:3], 0
    ds_read_b64_tr_b16 v[40:41], v27 offset:57344
    ds_read_b64_tr_b16 v[42:43], v27 offset:57856
    buffer_load_dwordx4 v206, s[48:51], s26 offen offset:2048 lds
    v_mfma_f32_32x32x16_bf16 v[96:111], v[52:55], a[4:7], v[96:111]
    ds_read_b64_tr_b16 v[44:45], v27 offset:59392
    ds_read_b64_tr_b16 v[46:47], v27 offset:59904
    s_waitcnt lgkmcnt(4)
    v_mfma_f32_32x32x16_bf16 v[96:111], v[56:59], a[8:11], v[96:111]
    ds_read_b64_tr_b16 v[48:49], v27 offset:61440
    ds_read_b64_tr_b16 v[50:51], v27 offset:61952
    buffer_load_dwordx4 v207, s[48:51], s26 offen offset:3072 lds
    s_mov_b32 s79, s26
    v_lshlrev_b32 v251, 4, v1
    v_or_b32 v251, s9, v251
    s_waitcnt vmcnt(18)
    ds_read_b64_tr_b16 v[144:145], v250 offset:0
    ds_read_b64_tr_b16 v[146:147], v250 offset:512
    v_mfma_f32_32x32x16_bf16 v[96:111], v[60:63], a[12:15], v[96:111]
    ds_read_b64_tr_b16 v[52:53], v27 offset:63488
    ds_read_b64_tr_b16 v[54:55], v27 offset:64000
    ds_read_b64_tr_b16 v[148:149], v250 offset:32
    ds_read_b64_tr_b16 v[150:151], v250 offset:544
    ds_read_b64_tr_b16 v[152:153], v250 offset:64
    s_waitcnt lgkmcnt(9)
    v_mfma_f32_32x32x16_bf16 v[96:111], v[40:43], a[16:19], v[96:111]
    s_barrier
    ds_read_b64_tr_b16 v[56:57], v27 offset:32768
    ds_read_b64_tr_b16 v[58:59], v27 offset:33280
    ds_read_b64_tr_b16 v[154:155], v250 offset:576
    ds_read_b64_tr_b16 v[156:157], v250 offset:96
    ds_read_b64_tr_b16 v[158:159], v250 offset:608
    v_mfma_f32_32x32x16_bf16 v[96:111], v[44:47], a[20:23], v[96:111]
    ds_read_b64_tr_b16 v[60:61], v27 offset:34816
    ds_read_b64_tr_b16 v[62:63], v27 offset:35328
    s_add_u32 m0, s71, 0xc000
    s_add_u32 s26, s79, s78
    s_waitcnt lgkmcnt(10)
    v_mfma_f32_32x32x16_bf16 v[96:111], v[48:51], a[24:27], v[96:111]
    ds_read_b64_tr_b16 v[40:41], v27 offset:36864
    ds_read_b64_tr_b16 v[42:43], v27 offset:37376
    buffer_load_dwordx4 v204, s[48:51], s26 offen lds
    buffer_store_dwordx4 v[144:147], v251, s[40:43], s4 offen sc1
    v_mfma_f32_32x32x16_bf16 v[96:111], v[52:55], a[28:31], v[96:111]
    ds_read_b64_tr_b16 v[44:45], v27 offset:38912
    ds_read_b64_tr_b16 v[46:47], v27 offset:39424
    s_waitcnt lgkmcnt(12)
    buffer_store_dwordx4 v[148:151], v251, s[40:43], s5 offen sc1
    s_waitcnt lgkmcnt(4)
    v_mfma_f32_32x32x16_bf16 v[96:111], v[56:59], a[32:35], v[96:111]
    ds_read_b64_tr_b16 v[48:49], v27 offset:40960
    ds_read_b64_tr_b16 v[50:51], v27 offset:41472
    buffer_load_dwordx4 v205, s[48:51], s26 offen offset:1024 lds
    buffer_store_dwordx4 v[152:155], v251, s[40:43], s16 offen sc1
    v_mfma_f32_32x32x16_bf16 v[96:111], v[60:63], a[36:39], v[96:111]
    ds_read_b64_tr_b16 v[52:53], v27 offset:43008
    ds_read_b64_tr_b16 v[54:55], v27 offset:43520
    buffer_store_dwordx4 v[156:159], v251, s[40:43], s17 offen sc1
    s_waitcnt lgkmcnt(4)
    v_mfma_f32_32x32x16_bf16 v[96:111], v[40:43], a[40:43], v[96:111]
    ds_read_b64_tr_b16 v[56:57], v27 offset:45056
    ds_read_b64_tr_b16 v[58:59], v27 offset:45568
    buffer_load_dwordx4 v206, s[48:51], s26 offen offset:2048 lds
    v_subrev_u32 v12, 10, v1
    v_mfma_f32_32x32x16_bf16 v[96:111], v[44:47], a[44:47], v[96:111]
    ds_read_b64_tr_b16 v[60:61], v27 offset:47104
    ds_read_b64_tr_b16 v[62:63], v27 offset:47616
    s_waitcnt lgkmcnt(4)
    v_mfma_f32_32x32x16_bf16 v[96:111], v[48:51], a[48:51], v[96:111]
    s_waitcnt vmcnt(11)
    s_barrier
    ds_read_b64_tr_b16 v[40:41], v26 offset:32768
    ds_read_b64_tr_b16 v[42:43], v26 offset:33280
    buffer_load_dwordx4 v207, s[48:51], s26 offen offset:3072 lds
    s_mov_b32 s79, s26
    v_add_f32 v116, v116, v117
    v_add_f32 v118, v118, v119
    v_add_f32 v120, v120, v121
    v_mfma_f32_32x32x16_bf16 v[96:111], v[52:55], a[52:55], v[96:111]
    ds_read_b64_tr_b16 v[44:45], v26 offset:34816
    ds_read_b64_tr_b16 v[46:47], v26 offset:35328
    v_cmp_gt_u32 vcc, 50, v12
    v_lshlrev_b32 v12, 4, v12
    v_mov_b32 v13, 0x80000000
    v_cndmask_b32 v12, v13, v12, vcc
    v_add_f32 v122, v122, v123
    v_add_f32 v116, v116, v118
    v_add_f32 v120, v120, v122
    s_waitcnt lgkmcnt(4)
    v_mfma_f32_32x32x16_bf16 v[96:111], v[56:59], a[56:59], v[96:111]
    ds_read_b64_tr_b16 v[48:49], v26 offset:36864
    ds_read_b64_tr_b16 v[50:51], v26 offset:37376
    v_lshlrev_b32 v112, 4, v0
    v_add_f32 v116, v116, v120
    v_add_u32 v112, 0x27000, v112
    v_mfma_f32_32x32x16_bf16 v[96:111], v[60:63], a[60:63], v[96:111]
    ds_read_b64_tr_b16 v[52:53], v26 offset:38912
    ds_read_b64_tr_b16 v[54:55], v26 offset:39424
    v_cvt_pk_bf16_f32 v117, v116, v116
    v_mov_b32 v123, 0
    v_lshlrev_b32 v118, 16, v117
    s_mov_b32 m0, 0x26000
    s_mul_i32 s26, s93, 800
    s_waitcnt lgkmcnt(4)
    v_mfma_f32_32x32x16_bf16 v[96:111], v[40:43], a[64:67], v[96:111]
    ds_read_b64_tr_b16 v[56:57], v26 offset:40960
    ds_read_b64_tr_b16 v[58:59], v26 offset:41472
    buffer_load_dwordx4 v12, s[60:63], s26 offen lds
    v_and_b32 v117, 0xffff, v117
    v_sub_f32 v118, v116, v118
    v_lshl_or_b32 v121, v124, 16, v117
    s_mov_b32 m0, 0x26400
    v_mfma_f32_32x32x16_bf16 v[96:111], v[44:47], a[68:71], v[96:111]
    ds_read_b64_tr_b16 v[60:61], v26 offset:43008
    ds_read_b64_tr_b16 v[62:63], v26 offset:43520
    buffer_load_dwordx4 v13, s[60:63], 0 offen lds
    v_cvt_pk_bf16_f32 v120, v116, v118
    v_mov_b32 v122, v124
    s_waitcnt lgkmcnt(4)
    v_mfma_f32_32x32x16_bf16 v[96:111], v[48:51], a[72:75], v[96:111]
    ds_read_b64_tr_b16 v[40:41], v26 offset:45056
    ds_read_b64_tr_b16 v[42:43], v26 offset:45568
    v_mov_b32 v33, v126
    v_mov_b32 v34, v127
    ds_write_b128 v112, v[120:123]
    v_mfma_f32_32x32x16_bf16 v[96:111], v[52:55], a[76:79], v[96:111]
    ds_read_b64_tr_b16 v[44:45], v26 offset:47104
    ds_read_b64_tr_b16 v[46:47], v26 offset:47616
    s_waitcnt lgkmcnt(5)
    v_mfma_f32_32x32x16_bf16 v[96:111], v[56:59], a[80:83], v[96:111]
    s_waitcnt lgkmcnt(2)
    s_waitcnt vmcnt(10)
    s_barrier
    ds_read_b128 v[48:51], v30 offset:0
    v_mfma_f32_32x32x16_bf16 v[96:111], v[60:63], a[84:87], v[96:111]
    ds_read_b128 v[52:55], v30 offset:512
    s_waitcnt lgkmcnt(2)
    v_mfma_f32_32x32x16_bf16 v[96:111], v[40:43], a[88:91], v[96:111]
    ds_read_b64_tr_b16 v[56:57], v27 offset:0
    ds_read_b64_tr_b16 v[58:59], v27 offset:512
    v_mfma_f32_32x32x16_bf16 v[96:111], v[44:47], a[92:95], v[96:111]
    ds_read_b64_tr_b16 v[60:61], v27 offset:2048
    ds_read_b64_tr_b16 v[62:63], v27 offset:2560
    s_waitcnt lgkmcnt(4)
    v_mfma_f32_32x32x16_bf16 v[64:79], v[48:51], v[36:39], v[64:79]
    ds_read_b64_tr_b16 v[40:41], v27 offset:4096
    ds_read_b64_tr_b16 v[42:43], v27 offset:4608
    v_mfma_f32_32x32x16_bf16 v[80:95], v[52:55], v[36:39], v[80:95]
    ds_read_b64_tr_b16 v[44:45], v27 offset:6144
    ds_read_b64_tr_b16 v[46:47], v27 offset:6656
    s_waitcnt lgkmcnt(4)
    v_mfma_f32_32x32x16_bf16 v[96:111], v[56:59], a[96:99], v[96:111]
    ds_read_b64_tr_b16 v[48:49], v27 offset:8192
    ds_read_b64_tr_b16 v[50:51], v27 offset:8704
    v_mfma_f32_32x32x16_bf16 v[96:111], v[60:63], a[100:103], v[96:111]
    ds_read_b64_tr_b16 v[52:53], v27 offset:10240
    ds_read_b64_tr_b16 v[54:55], v27 offset:10752
    v_mul_f32 v64, v64, v33
    v_mul_f32 v65, v65, v33
    s_waitcnt lgkmcnt(4)
    v_mfma_f32_32x32x16_bf16 v[96:111], v[40:43], a[104:107], v[96:111]
    ds_read_b64_tr_b16 v[56:57], v27 offset:12288
    ds_read_b64_tr_b16 v[58:59], v27 offset:12800
    v_mul_f32 v66, v66, v33
    v_mul_f32 v67, v67, v33
    v_mfma_f32_32x32x16_bf16 v[96:111], v[44:47], a[108:111], v[96:111]
    ds_read_b64_tr_b16 v[60:61], v27 offset:14336
    ds_read_b64_tr_b16 v[62:63], v27 offset:14848
    v_mul_f32 v68, v68, v33
    v_mul_f32 v69, v69, v33
    s_waitcnt lgkmcnt(4)
    v_mfma_f32_32x32x16_bf16 v[96:111], v[48:51], a[112:115], v[96:111]
    s_waitcnt vmcnt(2)
    s_barrier
    v_mov_b32 v35, s72
    buffer_store_dword v35, v32, s[40:43], s0 offen sc1
    ds_read_b64_tr_b16 v[40:41], v26 offset:49152
    ds_read_b64_tr_b16 v[42:43], v26 offset:49664
    s_add_u32 m0, s71, 0x0
    s_add_u32 s26, s81, 0
    v_mul_f32 v70, v70, v33
    v_mfma_f32_32x32x16_bf16 v[96:111], v[52:55], a[116:119], v[96:111]
    ds_read_b64_tr_b16 v[44:45], v26 offset:51200
    ds_read_b64_tr_b16 v[46:47], v26 offset:51712
    buffer_load_dwordx4 v14, s[36:39], s26 offen lds
    v_mul_f32 v71, v71, v33
    v_cvt_pk_bf16_f32 v120, v64, v65
    s_waitcnt lgkmcnt(4)
    v_mfma_f32_32x32x16_bf16 v[96:111], v[56:59], a[120:123], v[96:111]
    ds_read_b64_tr_b16 v[48:49], v26 offset:53248
    ds_read_b64_tr_b16 v[50:51], v26 offset:53760
    buffer_load_dwordx4 v15, s[36:39], s26 offen offset:1024 lds
    v_cvt_pk_bf16_f32 v121, v66, v67
    v_cvt_pk_bf16_f32 v122, v68, v69
    v_mfma_f32_32x32x16_bf16 v[96:111], v[60:63], a[124:127], v[96:111]
    ds_read_b64_tr_b16 v[52:53], v26 offset:55296
    ds_read_b64_tr_b16 v[54:55], v26 offset:55808
    v_cvt_pk_bf16_f32 v123, v70, v71
    s_waitcnt lgkmcnt(4)
    v_mfma_f32_32x32x16_bf16 v[96:111], v[40:43], a[128:131], v[96:111]
    ds_read_b64_tr_b16 v[56:57], v26 offset:57344
    ds_read_b64_tr_b16 v[58:59], v26 offset:57856
    buffer_store_dwordx4 v[120:123], v31, s[40:43], s83 offen offset:0 sc1
    v_mul_f32 v72, v72, v33
    v_mfma_f32_32x32x16_bf16 v[96:111], v[44:47], a[132:135], v[96:111]
    ds_read_b64_tr_b16 v[60:61], v26 offset:59392
    ds_read_b64_tr_b16 v[62:63], v26 offset:59904
    buffer_load_dwordx4 v16, s[36:39], s26 offen offset:2048 lds
    v_mul_f32 v73, v73, v33
    v_mul_f32 v74, v74, v33
    s_waitcnt lgkmcnt(4)
    v_mfma_f32_32x32x16_bf16 v[96:111], v[48:51], a[136:139], v[96:111]
    ds_read_b64_tr_b16 v[40:41], v26 offset:61440
    ds_read_b64_tr_b16 v[42:43], v26 offset:61952
    v_mul_f32 v75, v75, v33
    v_mul_f32 v76, v76, v33
    v_mfma_f32_32x32x16_bf16 v[96:111], v[52:55], a[140:143], v[96:111]
    ds_read_b64_tr_b16 v[44:45], v26 offset:63488
    ds_read_b64_tr_b16 v[46:47], v26 offset:64000
    buffer_load_dwordx4 v17, s[36:39], s26 offen offset:3072 lds
    v_mul_f32 v77, v77, v33
    v_mul_f32 v78, v78, v33
    s_waitcnt lgkmcnt(4)
    v_mfma_f32_32x32x16_bf16 v[96:111], v[56:59], a[144:147], v[96:111]
    ds_read_b128 v[48:51], v30 offset:1024
    v_mul_f32 v79, v79, v33
    v_mfma_f32_32x32x16_bf16 v[96:111], v[60:63], a[148:151], v[96:111]
    ds_read_b64_tr_b16 v[52:53], v29 offset:49152
    ds_read_b64_tr_b16 v[54:55], v29 offset:49664
    v_cvt_pk_bf16_f32 v124, v72, v73
    v_cvt_pk_bf16_f32 v125, v74, v75
    s_waitcnt lgkmcnt(3)
    v_mfma_f32_32x32x16_bf16 v[96:111], v[40:43], a[152:155], v[96:111]
    ds_read_b64_tr_b16 v[56:57], v29 offset:51200
    ds_read_b64_tr_b16 v[58:59], v29 offset:51712
    v_cvt_pk_bf16_f32 v126, v76, v77
    v_cvt_pk_bf16_f32 v127, v78, v79
    v_mfma_f32_32x32x16_bf16 v[96:111], v[44:47], a[156:159], v[96:111]
    ds_read_b64_tr_b16 v[60:61], v29 offset:53248
    ds_read_b64_tr_b16 v[62:63], v29 offset:53760
    buffer_store_dwordx4 v[124:127], v31, s[40:43], s83 offen offset:256 sc1
    s_waitcnt lgkmcnt(4)
    v_mfma_f32_32x32x16_bf16 v[96:111], v[48:51], v[36:39], v[96:111]
    ds_read_b64_tr_b16 v[40:41], v29 offset:55296
    ds_read_b64_tr_b16 v[42:43], v29 offset:55808
    v_mul_f32 v80, v80, v33
    v_mul_f32 v81, v81, v33
    s_add_u32 m0, s71, 0x4000
    s_add_u32 s26, s81, 442368
    v_mfma_f32_32x32x16_bf16 v[64:79], v[52:55], a[0:3], 0
    ds_read_b64_tr_b16 v[44:45], v29 offset:57344
    ds_read_b64_tr_b16 v[46:47], v29 offset:57856
    buffer_load_dwordx4 v14, s[36:39], s26 offen lds
    v_mul_f32 v82, v82, v33
    v_mul_f32 v83, v83, v33
    s_waitcnt lgkmcnt(4)
    v_mfma_f32_32x32x16_bf16 v[64:79], v[56:59], a[4:7], v[64:79]
    ds_read_b64_tr_b16 v[48:49], v29 offset:59392
    ds_read_b64_tr_b16 v[50:51], v29 offset:59904
    buffer_load_dwordx4 v15, s[36:39], s26 offen offset:1024 lds
    v_mul_f32 v84, v84, v33
    v_mul_f32 v85, v85, v33
    v_mul_f32 v96, v96, v33
    v_mul_f32 v97, v97, v33
    v_mul_f32 v98, v98, v33
    v_mul_f32 v99, v99, v33
    v_mfma_f32_32x32x16_bf16 v[64:79], v[60:63], a[8:11], v[64:79]
    ds_read_b64_tr_b16 v[52:53], v29 offset:61440
    ds_read_b64_tr_b16 v[54:55], v29 offset:61952
    v_mul_f32 v86, v86, v33
    v_exp_f32 v112, v96
    v_exp_f32 v113, v97
    s_waitcnt lgkmcnt(4)
    v_mfma_f32_32x32x16_bf16 v[64:79], v[40:43], a[12:15], v[64:79]
    ds_read_b64_tr_b16 v[56:57], v29 offset:63488
    ds_read_b64_tr_b16 v[58:59], v29 offset:64000
    buffer_load_dwordx4 v16, s[36:39], s26 offen offset:2048 lds
    v_mul_f32 v87, v87, v33
    v_cvt_pk_bf16_f32 v80, v80, v81
    v_exp_f32 v114, v98
    v_mfma_f32_32x32x16_bf16 v[64:79], v[44:47], a[16:19], v[64:79]
    ds_read_b64_tr_b16 v[60:61], v29 offset:32768
    ds_read_b64_tr_b16 v[62:63], v29 offset:33280
    v_cvt_pk_bf16_f32 v81, v82, v83
    v_cvt_pk_bf16_f32 v82, v84, v85
    v_exp_f32 v115, v99
    v_fma_f32 v116, v112, -0.5, -1.0
    v_fma_f32 v117, v113, -0.5, -1.0
    s_waitcnt lgkmcnt(4)
    v_mfma_f32_32x32x16_bf16 v[64:79], v[48:51], a[20:23], v[64:79]
    ds_read_b64_tr_b16 v[40:41], v29 offset:34816
    ds_read_b64_tr_b16 v[42:43], v29 offset:35328
    buffer_load_dwordx4 v17, s[36:39], s26 offen offset:3072 lds
    v_cvt_pk_bf16_f32 v83, v86, v87
    v_fma_f32 v118, v114, -0.5, -1.0
    v_fma_f32 v119, v115, -0.5, -1.0
    v_fma_f32 v116, v112, v116, s77
    v_fma_f32 v117, v113, v117, s77
    v_mfma_f32_32x32x16_bf16 v[64:79], v[52:55], a[24:27], v[64:79]
    ds_read_b64_tr_b16 v[44:45], v29 offset:36864
    ds_read_b64_tr_b16 v[46:47], v29 offset:37376
    buffer_store_dwordx4 v[80:83], v31, s[40:43], s83 offen offset:1024 sc1
    v_mul_f32 v88, v88, v33
    v_fma_f32 v118, v114, v118, s77
    v_fma_f32 v119, v115, v119, s77
    v_rcp_f32 v116, v116
    s_add_u32 m0, s71, 0x14000
    s_add_u32 s26, s81, 884736
    s_waitcnt lgkmcnt(4)
    v_mfma_f32_32x32x16_bf16 v[64:79], v[56:59], a[28:31], v[64:79]
    ds_read_b64_tr_b16 v[48:49], v29 offset:38912
    ds_read_b64_tr_b16 v[50:51], v29 offset:39424
    buffer_load_dwordx4 v14, s[36:39], s26 offen lds
    v_mul_f32 v89, v89, v33
    v_mul_f32 v90, v90, v33
    v_rcp_f32 v117, v117
    v_rcp_f32 v118, v118
    v_mfma_f32_32x32x16_bf16 v[64:79], v[60:63], a[32:35], v[64:79]
    ds_read_b64_tr_b16 v[52:53], v29 offset:40960
    ds_read_b64_tr_b16 v[54:55], v29 offset:41472
    buffer_load_dwordx4 v15, s[36:39], s26 offen offset:1024 lds
    v_mul_f32 v91, v91, v33
    v_mul_f32 v92, v92, v33
    v_rcp_f32 v119, v119
    v_fma_f32 v96, v96, v116, v96
    s_waitcnt lgkmcnt(4)
    v_mfma_f32_32x32x16_bf16 v[64:79], v[40:43], a[36:39], v[64:79]
    ds_read_b64_tr_b16 v[56:57], v29 offset:43008
    ds_read_b64_tr_b16 v[58:59], v29 offset:43520
    v_mul_f32 v93, v93, v33
    v_mul_f32 v94, v94, v33
    v_fma_f32 v97, v97, v117, v97
    v_fma_f32 v98, v98, v118, v98
    v_fma_f32 v99, v99, v119, v99
    v_mfma_f32_32x32x16_bf16 v[64:79], v[44:47], a[40:43], v[64:79]
    ds_read_b64_tr_b16 v[60:61], v29 offset:45056
    ds_read_b64_tr_b16 v[62:63], v29 offset:45568
    buffer_load_dwordx4 v16, s[36:39], s26 offen offset:2048 lds
    v_mul_f32 v95, v95, v33
    v_cvt_pk_bf16_f32 v120, v96, v97
    v_cvt_pk_bf16_f32 v121, v98, v99
    v_mul_f32 v100, v100, v33
    v_mul_f32 v101, v101, v33
    s_waitcnt lgkmcnt(4)
    v_mfma_f32_32x32x16_bf16 v[64:79], v[48:51], a[44:47], v[64:79]
    ds_read_b64_tr_b16 v[40:41], v29 offset:47104
    ds_read_b64_tr_b16 v[42:43], v29 offset:47616
    v_cvt_pk_bf16_f32 v88, v88, v89
    v_cvt_pk_bf16_f32 v89, v90, v91
    v_mul_f32 v102, v102, v33
    v_mul_f32 v103, v103, v33
    v_exp_f32 v112, v100
    v_mfma_f32_32x32x16_bf16 v[64:79], v[52:55], a[48:51], v[64:79]
    ds_read_b64_tr_b16 v[44:45], v28 offset:32768
    ds_read_b64_tr_b16 v[46:47], v28 offset:33280
    buffer_load_dwordx4 v17, s[36:39], s26 offen offset:3072 lds
    v_cvt_pk_bf16_f32 v90, v92, v93
    v_cvt_pk_bf16_f32 v91, v94, v95
    s_mul_i32 s73, s96, 5
    s_lshr_b32 s73, s73, 2
    v_exp_f32 v113, v101
    v_exp_f32 v114, v102
    s_waitcnt lgkmcnt(4)
    v_mfma_f32_32x32x16_bf16 v[64:79], v[56:59], a[52:55], v[64:79]
    ds_read_b64_tr_b16 v[48:49], v28 offset:34816
    ds_read_b64_tr_b16 v[50:51], v28 offset:35328
    buffer_store_dwordx4 v[88:91], v31, s[40:43], s83 offen offset:1280 sc1
    s_mul_i32 s73, s73, 74
    s_mul_i32 s74, s68, 40
    v_exp_f32 v115, v103
    v_fma_f32 v116, v112, -0.5, -1.0
    v_mfma_f32_32x32x16_bf16 v[64:79], v[60:63], a[56:59], v[64:79]
    ds_read_b64_tr_b16 v[52:53], v28 offset:36864
    ds_read_b64_tr_b16 v[54:55], v28 offset:37376
    v_min_u32 v2, 9, v1
    v_lshl_add_u32 v2, v2, 2, s74
    v_fma_f32 v117, v113, -0.5, -1.0
    v_fma_f32 v118, v114, -0.5, -1.0
    v_fma_f32 v119, v115, -0.5, -1.0
    s_waitcnt lgkmcnt(4)
    v_mfma_f32_32x32x16_bf16 v[64:79], v[40:43], a[60:63], v[64:79]
    ds_read_b64_tr_b16 v[56:57], v28 offset:38912
    ds_read_b64_tr_b16 v[58:59], v28 offset:39424
    v_min_u32 v2, 147, v2
    v_add_u32 v2, s73, v2
    v_bfe_u32 v2, v2, 2, 7
    v_fma_f32 v116, v112, v116, s77
    v_fma_f32 v117, v113, v117, s77
    v_fma_f32 v118, v114, v118, s77
    v_fma_f32 v119, v115, v119, s77
    v_mfma_f32_32x32x16_bf16 v[64:79], v[44:47], a[64:67], v[64:79]
    s_barrier
    ds_read_b64_tr_b16 v[60:61], v28 offset:40960
    ds_read_b64_tr_b16 v[62:63], v28 offset:41472
    v_lshlrev_b32 v2, 7, v2
    v_add_u32 v2, 0x8000, v2
    v_rcp_f32 v116, v116
    v_rcp_f32 v117, v117
    s_add_u32 m0, s71, 0x1c000
    s_add_u32 s26, s81, 1327104
    s_waitcnt lgkmcnt(4)
    v_mfma_f32_32x32x16_bf16 v[64:79], v[48:51], a[68:71], v[64:79]
    ds_read_b64_tr_b16 v[40:41], v28 offset:43008
    ds_read_b64_tr_b16 v[42:43], v28 offset:43520
    buffer_load_dwordx4 v14, s[36:39], s26 offen lds
    buffer_load_dword v3, v2, s[40:43], 0 offen sc1
    v_rcp_f32 v118, v118
    v_rcp_f32 v119, v119
    v_mfma_f32_32x32x16_bf16 v[64:79], v[52:55], a[72:75], v[64:79]
    ds_read_b64_tr_b16 v[44:45], v28 offset:45056
    ds_read_b64_tr_b16 v[46:47], v28 offset:45568
    buffer_load_dwordx4 v15, s[36:39], s26 offen offset:1024 lds
    v_fma_f32 v100, v100, v116, v100
    v_fma_f32 v101, v101, v117, v101
    v_fma_f32 v102, v102, v118, v102
    s_waitcnt lgkmcnt(4)
    v_mfma_f32_32x32x16_bf16 v[64:79], v[56:59], a[76:79], v[64:79]
    ds_read_b64_tr_b16 v[48:49], v28 offset:47104
    ds_read_b64_tr_b16 v[50:51], v28 offset:47616
    v_fma_f32 v103, v103, v119, v103
    v_cvt_pk_bf16_f32 v122, v100, v101
    v_cvt_pk_bf16_f32 v123, v102, v103
    v_mfma_f32_32x32x16_bf16 v[64:79], v[60:63], a[80:83], v[64:79]
    ds_read_b64_tr_b16 v[52:53], v29 offset:0
    ds_read_b64_tr_b16 v[54:55], v29 offset:512
    buffer_load_dwordx4 v16, s[36:39], s26 offen offset:2048 lds
    v_mul_f32 v104, v104, v33
    v_mul_f32 v105, v105, v33
    s_waitcnt lgkmcnt(4)
    v_mfma_f32_32x32x16_bf16 v[64:79], v[40:43], a[84:87], v[64:79]
    ds_read_b64_tr_b16 v[56:57], v29 offset:2048
    ds_read_b64_tr_b16 v[58:59], v29 offset:2560
    buffer_store_dwordx4 v[120:123], v31, s[40:43], s84 offen offset:0 sc1
    v_mul_f32 v106, v106, v33
    v_mul_f32 v107, v107, v33
    v_exp_f32 v112, v104
    v_mfma_f32_32x32x16_bf16 v[64:79], v[44:47], a[88:91], v[64:79]
    ds_read_b64_tr_b16 v[60:61], v29 offset:4096
    ds_read_b64_tr_b16 v[62:63], v29 offset:4608
    buffer_load_dwordx4 v17, s[36:39], s26 offen offset:3072 lds
    v_exp_f32 v113, v105
    s_waitcnt lgkmcnt(4)
    v_mfma_f32_32x32x16_bf16 v[64:79], v[48:51], a[92:95], v[64:79]
    ds_read_b64_tr_b16 v[40:41], v29 offset:6144
    ds_read_b64_tr_b16 v[42:43], v29 offset:6656
    v_exp_f32 v114, v106
    v_exp_f32 v115, v107
    v_fma_f32 v116, v112, -0.5, -1.0
    s_add_u32 m0, s71, 0x18000
    s_add_u32 s26, s81, 1769472
    v_mfma_f32_32x32x16_bf16 v[64:79], v[52:55], a[96:99], v[64:79]
    ds_read_b64_tr_b16 v[44:45], v29 offset:8192
    ds_read_b64_tr_b16 v[46:47], v29 offset:8704
    buffer_load_dwordx4 v14, s[36:39], s26 offen lds
    v_fma_f32 v117, v113, -0.5, -1.0
    v_fma_f32 v118, v114, -0.5, -1.0
    v_fma_f32 v119, v115, -0.5, -1.0
    s_waitcnt lgkmcnt(4)
    v_mfma_f32_32x32x16_bf16 v[64:79], v[56:59], a[100:103], v[64:79]
    ds_read_b64_tr_b16 v[48:49], v29 offset:10240
    ds_read_b64_tr_b16 v[50:51], v29 offset:10752
    buffer_load_dwordx4 v15, s[36:39], s26 offen offset:1024 lds
    v_fma_f32 v116, v112, v116, s77
    v_fma_f32 v117, v113, v117, s77
    v_fma_f32 v118, v114, v118, s77
    v_fma_f32 v119, v115, v119, s77
    v_mfma_f32_32x32x16_bf16 v[64:79], v[60:63], a[104:107], v[64:79]
    ds_read_b64_tr_b16 v[52:53], v29 offset:12288
    ds_read_b64_tr_b16 v[54:55], v29 offset:12800
    v_rcp_f32 v116, v116
    v_rcp_f32 v117, v117
    s_waitcnt lgkmcnt(4)
    v_mfma_f32_32x32x16_bf16 v[64:79], v[40:43], a[108:111], v[64:79]
    ds_read_b64_tr_b16 v[56:57], v29 offset:14336
    ds_read_b64_tr_b16 v[58:59], v29 offset:14848
    buffer_load_dwordx4 v16, s[36:39], s26 offen offset:2048 lds
    v_rcp_f32 v118, v118
    v_mfma_f32_32x32x16_bf16 v[64:79], v[44:47], a[112:115], v[64:79]
    ds_read_b64_tr_b16 v[60:61], v28 offset:49152
    ds_read_b64_tr_b16 v[62:63], v28 offset:49664
    v_rcp_f32 v119, v119
    v_fma_f32 v104, v104, v116, v104
    v_fma_f32 v105, v105, v117, v105
    v_fma_f32 v106, v106, v118, v106
    s_waitcnt lgkmcnt(4)
    v_mfma_f32_32x32x16_bf16 v[64:79], v[48:51], a[116:119], v[64:79]
    ds_read_b64_tr_b16 v[40:41], v28 offset:51200
    ds_read_b64_tr_b16 v[42:43], v28 offset:51712
    buffer_load_dwordx4 v17, s[36:39], s26 offen offset:3072 lds
    v_fma_f32 v107, v107, v119, v107
    v_cvt_pk_bf16_f32 v124, v104, v105
    v_cvt_pk_bf16_f32 v125, v106, v107
    v_mfma_f32_32x32x16_bf16 v[64:79], v[52:55], a[120:123], v[64:79]
    ds_read_b64_tr_b16 v[44:45], v28 offset:53248
    ds_read_b64_tr_b16 v[46:47], v28 offset:53760
    v_mul_f32 v108, v108, v33
    v_mul_f32 v109, v109, v33
    v_mul_f32 v110, v110, v33
    v_mul_f32 v111, v111, v33
    s_waitcnt lgkmcnt(4)
    v_mfma_f32_32x32x16_bf16 v[64:79], v[56:59], a[124:127], v[64:79]
    ds_read_b64_tr_b16 v[48:49], v28 offset:55296
    ds_read_b64_tr_b16 v[50:51], v28 offset:55808
    s_mul_i32 s73, s96, 389120
    s_mul_i32 s74, s68, 5120
    v_exp_f32 v112, v108
    v_exp_f32 v113, v109
    v_mfma_f32_32x32x16_bf16 v[64:79], v[60:63], a[128:131], v[64:79]
    ds_read_b64_tr_b16 v[52:53], v28 offset:57344
    ds_read_b64_tr_b16 v[54:55], v28 offset:57856
    s_add_u32 s73, s73, s74
    v_exp_f32 v114, v110
    s_waitcnt lgkmcnt(4)
    v_mfma_f32_32x32x16_bf16 v[64:79], v[40:43], a[132:135], v[64:79]
    ds_read_b64_tr_b16 v[56:57], v28 offset:59392
    ds_read_b64_tr_b16 v[58:59], v28 offset:59904
    s_add_u32 s73, s73, 0x200000
    v_lshlrev_b32 v6, 4, v1
    v_exp_f32 v115, v111
    v_fma_f32 v116, v112, -0.5, -1.0
    v_fma_f32 v117, v113, -0.5, -1.0
    v_mfma_f32_32x32x16_bf16 v[64:79], v[44:47], a[136:139], v[64:79]
    ds_read_b64_tr_b16 v[60:61], v28 offset:61440
    ds_read_b64_tr_b16 v[62:63], v28 offset:61952
    v_add_u32 v6, s73, v6
    s_mul_i32 s91, s68, 15360
    v_fma_f32 v118, v114, -0.5, -1.0
    v_fma_f32 v119, v115, -0.5, -1.0
    v_fma_f32 v116, v112, v116, s77
    v_fma_f32 v117, v113, v117, s77
    s_waitcnt lgkmcnt(4)
    v_mfma_f32_32x32x16_bf16 v[64:79], v[48:51], a[140:143], v[64:79]
    ds_read_b64_tr_b16 v[40:41], v28 offset:63488
    ds_read_b64_tr_b16 v[42:43], v28 offset:64000
    s_add_u32 s91, s91, 0x14000
    v_fma_f32 v118, v114, v118, s77
    v_fma_f32 v119, v115, v119, s77
    v_rcp_f32 v116, v116
    v_mfma_f32_32x32x16_bf16 v[64:79], v[52:55], a[144:147], v[64:79]
    ds_read_b128 v[44:47], v30 offset:1536
    s_waitcnt vmcnt(8)
    v_cmp_ne_u32 vcc, s72, v3
    s_nop 4
    s_cbranch_vccnz Lslow3
Lback3:
    v_rcp_f32 v117, v117
    v_rcp_f32 v118, v118
    s_waitcnt lgkmcnt(3)
    v_mfma_f32_32x32x16_bf16 v[64:79], v[56:59], a[148:151], v[64:79]
    s_barrier
    ds_read_b64_tr_b16 v[48:49], v26 offset:0
    ds_read_b64_tr_b16 v[50:51], v26 offset:512
    v_rcp_f32 v119, v119
    v_fma_f32 v108, v108, v116, v108
    v_mfma_f32_32x32x16_bf16 v[64:79], v[60:63], a[152:155], v[64:79]
    ds_read_b64_tr_b16 v[52:53], v26 offset:2048
    ds_read_b64_tr_b16 v[54:55], v26 offset:2560
    v_fma_f32 v109, v109, v117, v109
    v_fma_f32 v110, v110, v118, v110
    v_fma_f32 v111, v111, v119, v111
    s_waitcnt lgkmcnt(4)
    v_mfma_f32_32x32x16_bf16 v[64:79], v[40:43], a[156:159], v[64:79]
    ds_read_b64_tr_b16 v[56:57], v26 offset:4096
    ds_read_b64_tr_b16 v[58:59], v26 offset:4608
    v_cvt_pk_bf16_f32 v126, v108, v109
    v_cvt_pk_bf16_f32 v127, v110, v111
    v_mfma_f32_32x32x16_bf16 v[64:79], v[44:47], v[36:39], v[64:79]
    ds_read_b64_tr_b16 v[60:61], v26 offset:6144
    ds_read_b64_tr_b16 v[62:63], v26 offset:6656
    buffer_store_dwordx4 v[124:127], v31, s[40:43], s84 offen offset:256 sc1
    s_add_u32 m0, s71, 0x8000
    s_add_u32 s26, s82, 0
    s_waitcnt lgkmcnt(4)
    v_mfma_f32_32x32x16_bf16 v[96:111], v[48:51], a[0:3], 0
    ds_read_b64_tr_b16 v[40:41], v26 offset:8192
    ds_read_b64_tr_b16 v[42:43], v26 offset:8704
    buffer_load_dwordx4 v14, s[52:55], s26 offen lds
    v_mfma_f32_32x32x16_bf16 v[96:111], v[52:55], a[4:7], v[96:111]
    ds_read_b64_tr_b16 v[44:45], v26 offset:10240
    ds_read_b64_tr_b16 v[46:47], v26 offset:10752
    buffer_load_dwordx4 v15, s[52:55], s26 offen offset:1024 lds
    v_mul_f32 v64, v64, v33
    v_mul_f32 v65, v65, v33
    v_mul_f32 v66, v66, v33
    v_mul_f32 v67, v67, v33
    s_waitcnt lgkmcnt(4)
    v_mfma_f32_32x32x16_bf16 v[96:111], v[56:59], a[8:11], v[96:111]
    ds_read_b64_tr_b16 v[48:49], v26 offset:12288
    ds_read_b64_tr_b16 v[50:51], v26 offset:12800
    v_exp_f32 v112, v64
    v_exp_f32 v113, v65
    v_mfma_f32_32x32x16_bf16 v[96:111], v[60:63], a[12:15], v[96:111]
    ds_read_b64_tr_b16 v[52:53], v26 offset:14336
    ds_read_b64_tr_b16 v[54:55], v26 offset:14848
    buffer_load_dwordx4 v16, s[52:55], s26 offen offset:2048 lds
    v_exp_f32 v114, v66
    s_waitcnt lgkmcnt(4)
    v_mfma_f32_32x32x16_bf16 v[96:111], v[40:43], a[16:19], v[96:111]
    ds_read_b64_tr_b16 v[56:57], v26 offset:16384
    ds_read_b64_tr_b16 v[58:59], v26 offset:16896
    buffer_load_dwordx4 v17, s[52:55], s26 offen offset:3072 lds
    v_exp_f32 v115, v67
    v_fma_f32 v116, v112, -0.5, -1.0
    v_fma_f32 v117, v113, -0.5, -1.0
    v_mfma_f32_32x32x16_bf16 v[96:111], v[44:47], a[20:23], v[96:111]
    ds_read_b64_tr_b16 v[60:61], v26 offset:18432
    ds_read_b64_tr_b16 v[62:63], v26 offset:18944
    v_fma_f32 v118, v114, -0.5, -1.0
    v_fma_f32 v119, v115, -0.5, -1.0
    v_fma_f32 v116, v112, v116, s77
    v_fma_f32 v117, v113, v117, s77
    s_add_u32 m0, s71, 0x10000
    s_add_u32 s26, s82, 442368
    s_waitcnt lgkmcnt(4)
    v_mfma_f32_32x32x16_bf16 v[96:111], v[48:51], a[24:27], v[96:111]
    ds_read_b64_tr_b16 v[40:41], v26 offset:20480
    ds_read_b64_tr_b16 v[42:43], v26 offset:20992
    buffer_load_dwordx4 v14, s[52:55], s26 offen lds
    v_fma_f32 v118, v114, v118, s77
    v_fma_f32 v119, v115, v119, s77
    v_rcp_f32 v116, v116
    v_mfma_f32_32x32x16_bf16 v[96:111], v[52:55], a[28:31], v[96:111]
    ds_read_b64_tr_b16 v[44:45], v26 offset:22528
    ds_read_b64_tr_b16 v[46:47], v26 offset:23040
    buffer_load_dwordx4 v15, s[52:55], s26 offen offset:1024 lds
    v_rcp_f32 v117, v117
    v_rcp_f32 v118, v118
    s_waitcnt lgkmcnt(4)
    v_mfma_f32_32x32x16_bf16 v[96:111], v[56:59], a[32:35], v[96:111]
    ds_read_b64_tr_b16 v[48:49], v26 offset:24576
    ds_read_b64_tr_b16 v[50:51], v26 offset:25088
    v_rcp_f32 v119, v119
    v_fma_f32 v64, v64, v116, v64
    v_mfma_f32_32x32x16_bf16 v[96:111], v[60:63], a[36:39], v[96:111]
    ds_read_b64_tr_b16 v[52:53], v26 offset:26624
    ds_read_b64_tr_b16 v[54:55], v26 offset:27136
    buffer_load_dwordx4 v16, s[52:55], s26 offen offset:2048 lds
    v_fma_f32 v65, v65, v117, v65
    v_fma_f32 v66, v66, v118, v66
    v_fma_f32 v67, v67, v119, v67
    s_waitcnt lgkmcnt(4)
    v_mfma_f32_32x32x16_bf16 v[96:111], v[40:43], a[40:43], v[96:111]
    ds_read_b64_tr_b16 v[56:57], v26 offset:28672
    ds_read_b64_tr_b16 v[58:59], v26 offset:29184
    buffer_load_dwordx4 v17, s[52:55], s26 offen offset:3072 lds
    v_cvt_pk_bf16_f32 v120, v64, v65
    v_cvt_pk_bf16_f32 v121, v66, v67
    v_mul_f32 v68, v68, v33
    v_mul_f32 v69, v69, v33
    v_mfma_f32_32x32x16_bf16 v[96:111], v[44:47], a[44:47], v[96:111]
    ds_read_b64_tr_b16 v[60:61], v26 offset:30720
    ds_read_b64_tr_b16 v[62:63], v26 offset:31232
    v_mul_f32 v70, v70, v33
    v_mul_f32 v71, v71, v33
    v_exp_f32 v112, v68
    v_add_u32 v7, 2048, v6
    s_waitcnt lgkmcnt(4)
    v_mfma_f32_32x32x16_bf16 v[96:111], v[48:51], a[48:51], v[96:111]
    ds_read_b64_tr_b16 v[40:41], v27 offset:16384
    ds_read_b64_tr_b16 v[42:43], v27 offset:16896
    global_load_dwordx4 a[160:163], v7, s[40:41] offset:-2048 sc1
    v_exp_f32 v113, v69
    v_exp_f32 v114, v70
    v_mfma_f32_32x32x16_bf16 v[96:111], v[52:55], a[52:55], v[96:111]
    ds_read_b64_tr_b16 v[44:45], v27 offset:18432
    ds_read_b64_tr_b16 v[46:47], v27 offset:18944
    global_load_dwordx4 a[164:167], v7, s[40:41] offset:-1024 sc1
    v_exp_f32 v115, v71
    v_fma_f32 v116, v112, -0.5, -1.0
    s_waitcnt lgkmcnt(4)
    v_mfma_f32_32x32x16_bf16 v[96:111], v[56:59], a[56:59], v[96:111]
    ds_read_b64_tr_b16 v[48:49], v27 offset:20480
    ds_read_b64_tr_b16 v[50:51], v27 offset:20992
    v_fma_f32 v117, v113, -0.5, -1.0
    v_fma_f32 v118, v114, -0.5, -1.0
    v_fma_f32 v119, v115, -0.5, -1.0
    v_mfma_f32_32x32x16_bf16 v[96:111], v[60:63], a[60:63], v[96:111]
    ds_read_b64_tr_b16 v[52:53], v27 offset:22528
    ds_read_b64_tr_b16 v[54:55], v27 offset:23040
    global_load_dwordx4 a[168:171], v7, s[40:41] offset:0 sc1
    v_fma_f32 v116, v112, v116, s77
    v_fma_f32 v117, v113, v117, s77
    v_fma_f32 v118, v114, v118, s77
    v_fma_f32 v119, v115, v119, s77
    s_waitcnt lgkmcnt(4)
    v_mfma_f32_32x32x16_bf16 v[96:111], v[40:43], a[64:67], v[96:111]
    ds_read_b64_tr_b16 v[56:57], v27 offset:24576
    ds_read_b64_tr_b16 v[58:59], v27 offset:25088
    v_rcp_f32 v116, v116
    v_rcp_f32 v117, v117
    v_mfma_f32_32x32x16_bf16 v[96:111], v[44:47], a[68:71], v[96:111]
    ds_read_b64_tr_b16 v[60:61], v27 offset:26624
    ds_read_b64_tr_b16 v[62:63], v27 offset:27136
    global_load_dwordx4 a[172:175], v7, s[40:41] offset:1024 sc1
    v_rcp_f32 v118, v118
    v_rcp_f32 v119, v119
    s_waitcnt lgkmcnt(4)
    v_mfma_f32_32x32x16_bf16 v[96:111], v[48:51], a[72:75], v[96:111]
    ds_read_b64_tr_b16 v[40:41], v27 offset:28672
    ds_read_b64_tr_b16 v[42:43], v27 offset:29184
    v_fma_f32 v68, v68, v116, v68
    v_fma_f32 v69, v69, v117, v69
    v_fma_f32 v70, v70, v118, v70
    v_mfma_f32_32x32x16_bf16 v[96:111], v[52:55], a[76:79], v[96:111]
    ds_read_b64_tr_b16 v[44:45], v27 offset:30720
    ds_read_b64_tr_b16 v[46:47], v27 offset:31232
    global_load_dwordx4 a[176:179], v7, s[40:41] offset:2048 sc1
    v_fma_f32 v71, v71, v119, v71
    v_cvt_pk_bf16_f32 v122, v68, v69
    v_cvt_pk_bf16_f32 v123, v70, v71
    s_waitcnt lgkmcnt(4)
    v_mfma_f32_32x32x16_bf16 v[96:111], v[56:59], a[80:83], v[96:111]
    s_waitcnt vmcnt(14)
    s_barrier
    v_mov_b32 v35, s72
    buffer_store_dword v35, v32, s[40:43], s87 offen sc1
    ds_read_b64_tr_b16 v[48:49], v27 offset:49152
    ds_read_b64_tr_b16 v[50:51], v27 offset:49664
    buffer_store_dwordx4 v[120:123], v31, s[40:43], s84 offen offset:1024 sc1
    v_mul_f32 v72, v72, v33
    v_mul_f32 v73, v73, v33
    s_add_u32 m0, s71, 0xc000
    s_add_u32 s26, s82, 884736
    v_mfma_f32_32x32x16_bf16 v[96:111], v[60:63], a[84:87], v[96:111]
    ds_read_b64_tr_b16 v[52:53], v27 offset:51200
    ds_read_b64_tr_b16 v[54:55], v27 offset:51712
    buffer_load_dwordx4 v14, s[52:55], s26 offen lds
    v_mul_f32 v74, v74, v33
    v_mul_f32 v75, v75, v33
    v_exp_f32 v112, v72
    s_waitcnt lgkmcnt(4)
    v_mfma_f32_32x32x16_bf16 v[96:111], v[40:43], a[88:91], v[96:111]
    ds_read_b64_tr_b16 v[56:57], v27 offset:53248
    ds_read_b64_tr_b16 v[58:59], v27 offset:53760
    buffer_load_dwordx4 v15, s[52:55], s26 offen offset:1024 lds
    v_exp_f32 v113, v73
    v_mfma_f32_32x32x16_bf16 v[96:111], v[44:47], a[92:95], v[96:111]
    ds_read_b64_tr_b16 v[60:61], v27 offset:55296
    ds_read_b64_tr_b16 v[62:63], v27 offset:55808
    v_exp_f32 v114, v74
    v_exp_f32 v115, v75
    v_fma_f32 v116, v112, -0.5, -1.0
    s_waitcnt lgkmcnt(4)
    v_mfma_f32_32x32x16_bf16 v[96:111], v[48:51], a[96:99], v[96:111]
    ds_read_b64_tr_b16 v[40:41], v27 offset:57344
    ds_read_b64_tr_b16 v[42:43], v27 offset:57856
    buffer_load_dwordx4 v16, s[52:55], s26 offen offset:2048 lds
    v_fma_f32 v117, v113, -0.5, -1.0
    v_fma_f32 v118, v114, -0.5, -1.0
    v_fma_f32 v119, v115, -0.5, -1.0
    v_mfma_f32_32x32x16_bf16 v[96:111], v[52:55], a[100:103], v[96:111]
    ds_read_b64_tr_b16 v[44:45], v27 offset:59392
    ds_read_b64_tr_b16 v[46:47], v27 offset:59904
    buffer_load_dwordx4 v17, s[52:55], s26 offen offset:3072 lds
    v_fma_f32 v116, v112, v116, s77
    v_fma_f32 v117, v113, v117, s77
    v_fma_f32 v118, v114, v118, s77
    v_fma_f32 v119, v115, v119, s77
    s_waitcnt lgkmcnt(4)
    v_mfma_f32_32x32x16_bf16 v[96:111], v[56:59], a[104:107], v[96:111]
    ds_read_b64_tr_b16 v[48:49], v27 offset:61440
    ds_read_b64_tr_b16 v[50:51], v27 offset:61952
    v_rcp_f32 v116, v116
    v_rcp_f32 v117, v117
    v_add_u32 v7, 22528, v6
    v_mfma_f32_32x32x16_bf16 v[96:111], v[60:63], a[108:111], v[96:111]
    ds_read_b64_tr_b16 v[52:53], v27 offset:63488
    ds_read_b64_tr_b16 v[54:55], v27 offset:64000
    global_load_dwordx4 a[180:183], v7, s[40:41] offset:-2048 sc1
    v_rcp_f32 v118, v118
    s_waitcnt lgkmcnt(4)
    v_mfma_f32_32x32x16_bf16 v[96:111], v[40:43], a[112:115], v[96:111]
    ds_read_b64_tr_b16 v[56:57], v27 offset:32768
    ds_read_b64_tr_b16 v[58:59], v27 offset:33280
    global_load_dwordx4 a[184:187], v7, s[40:41] offset:-1024 sc1
    v_rcp_f32 v119, v119
    v_fma_f32 v72, v72, v116, v72
    v_fma_f32 v73, v73, v117, v73
    v_fma_f32 v74, v74, v118, v74
    v_mfma_f32_32x32x16_bf16 v[96:111], v[44:47], a[116:119], v[96:111]
    ds_read_b64_tr_b16 v[60:61], v27 offset:34816
    ds_read_b64_tr_b16 v[62:63], v27 offset:35328
    global_load_dwordx4 a[188:191], v7, s[40:41] offset:0 sc1
    v_fma_f32 v75, v75, v119, v75
    v_cvt_pk_bf16_f32 v124, v72, v73
    v_cvt_pk_bf16_f32 v125, v74, v75
    s_waitcnt lgkmcnt(4)
    v_mfma_f32_32x32x16_bf16 v[96:111], v[48:51], a[120:123], v[96:111]
    ds_read_b64_tr_b16 v[40:41], v27 offset:36864
    ds_read_b64_tr_b16 v[42:43], v27 offset:37376
    v_mul_f32 v76, v76, v33
    v_mul_f32 v77, v77, v33
    v_mul_f32 v78, v78, v33
    v_mul_f32 v79, v79, v33
    v_mfma_f32_32x32x16_bf16 v[96:111], v[52:55], a[124:127], v[96:111]
    ds_read_b64_tr_b16 v[44:45], v27 offset:38912
    ds_read_b64_tr_b16 v[46:47], v27 offset:39424
    global_load_dwordx4 a[192:195], v7, s[40:41] offset:1024 sc1
    v_exp_f32 v112, v76
    v_exp_f32 v113, v77
    s_waitcnt lgkmcnt(4)
    v_mfma_f32_32x32x16_bf16 v[96:111], v[56:59], a[128:131], v[96:111]
    ds_read_b64_tr_b16 v[48:49], v27 offset:40960
    ds_read_b64_tr_b16 v[50:51], v27 offset:41472
    global_load_dwordx4 a[196:199], v7, s[40:41] offset:2048 sc1
    v_exp_f32 v114, v78
    v_mfma_f32_32x32x16_bf16 v[96:111], v[60:63], a[132:135], v[96:111]
    ds_read_b64_tr_b16 v[52:53], v27 offset:43008
    ds_read_b64_tr_b16 v[54:55], v27 offset:43520
    v_exp_f32 v115, v79
    v_fma_f32 v116, v112, -0.5, -1.0
    v_fma_f32 v117, v113, -0.5, -1.0
    v_add_u32 v7, 43008, v6
    s_waitcnt lgkmcnt(4)
    v_mfma_f32_32x32x16_bf16 v[96:111], v[40:43], a[136:139], v[96:111]
    ds_read_b64_tr_b16 v[56:57], v27 offset:45056
    ds_read_b64_tr_b16 v[58:59], v27 offset:45568
    global_load_dwordx4 a[200:203], v7, s[40:41] offset:-2048 sc1
    v_fma_f32 v118, v114, -0.5, -1.0
    v_fma_f32 v119, v115, -0.5, -1.0
    v_fma_f32 v116, v112, v116, s77
    v_fma_f32 v117, v113, v117, s77
    v_mfma_f32_32x32x16_bf16 v[96:111], v[44:47], a[140:143], v[96:111]
    ds_read_b64_tr_b16 v[60:61], v27 offset:47104
    ds_read_b64_tr_b16 v[62:63], v27 offset:47616
    global_load_dwordx4 a[204:207], v7, s[40:41] offset:-1024 sc1
    v_fma_f32 v118, v114, v118, s77
    v_fma_f32 v119, v115, v119, s77
    v_rcp_f32 v116, v116
    s_waitcnt lgkmcnt(4)
    v_mfma_f32_32x32x16_bf16 v[96:111], v[48:51], a[144:147], v[96:111]
    ds_read_b128 v[40:43], v30 offset:2048
    global_load_dwordx4 a[208:211], v7, s[40:41] offset:0 sc1
    v_rcp_f32 v117, v117
    v_rcp_f32 v118, v118
    v_mfma_f32_32x32x16_bf16 v[96:111], v[52:55], a[148:151], v[96:111]
    ds_read_b64_tr_b16 v[44:45], v28 offset:0
    ds_read_b64_tr_b16 v[46:47], v28 offset:512
    v_rcp_f32 v119, v119
    v_fma_f32 v76, v76, v116, v76
    s_waitcnt lgkmcnt(3)
    v_mfma_f32_32x32x16_bf16 v[96:111], v[56:59], a[152:155], v[96:111]
    ds_read_b64_tr_b16 v[48:49], v28 offset:2048
    ds_read_b64_tr_b16 v[50:51], v28 offset:2560
    global_load_dwordx4 a[212:215], v7, s[40:41] offset:1024 sc1
    v_fma_f32 v77, v77, v117, v77
    v_fma_f32 v78, v78, v118, v78
    v_fma_f32 v79, v79, v119, v79
    v_mfma_f32_32x32x16_bf16 v[96:111], v[60:63], a[156:159], v[96:111]
    ds_read_b64_tr_b16 v[52:53], v28 offset:4096
    ds_read_b64_tr_b16 v[54:55], v28 offset:4608
    global_load_dwordx4 a[216:219], v7, s[40:41] offset:2048 sc1
    v_cvt_pk_bf16_f32 v126, v76, v77
    v_cvt_pk_bf16_f32 v127, v78, v79
    s_waitcnt lgkmcnt(4)
    v_mfma_f32_32x32x16_bf16 v[96:111], v[40:43], v[36:39], v[96:111]
    ds_read_b64_tr_b16 v[56:57], v28 offset:6144
    ds_read_b64_tr_b16 v[58:59], v28 offset:6656
    buffer_store_dwordx4 v[124:127], v31, s[40:43], s84 offen offset:1280 sc1
    v_add_u32 v7, 63488, v6
    v_mfma_f32_32x32x16_bf16 v[64:79], v[44:47], a[0:3], 0
    ds_read_b64_tr_b16 v[60:61], v28 offset:8192
    ds_read_b64_tr_b16 v[62:63], v28 offset:8704
    global_load_dwordx4 a[220:223], v7, s[40:41] offset:-2048 sc1
    s_waitcnt lgkmcnt(4)
    v_mfma_f32_32x32x16_bf16 v[64:79], v[48:51], a[4:7], v[64:79]
    ds_read_b64_tr_b16 v[40:41], v28 offset:10240
    ds_read_b64_tr_b16 v[42:43], v28 offset:10752
    global_load_dwordx4 a[224:227], v7, s[40:41] offset:-1024 sc1
    v_mul_f32 v96, v96, v33
    v_mul_f32 v97, v97, v33
    v_mul_f32 v98, v98, v33
    v_mul_f32 v99, v99, v33
    v_mfma_f32_32x32x16_bf16 v[64:79], v[52:55], a[8:11], v[64:79]
    ds_read_b64_tr_b16 v[44:45], v28 offset:12288
    ds_read_b64_tr_b16 v[46:47], v28 offset:12800
    v_exp_f32 v112, v96
    v_exp_f32 v113, v97
    s_waitcnt lgkmcnt(4)
    v_mfma_f32_32x32x16_bf16 v[64:79], v[56:59], a[12:15], v[64:79]
    ds_read_b64_tr_b16 v[48:49], v28 offset:14336
    ds_read_b64_tr_b16 v[50:51], v28 offset:14848
    global_load_dwordx4 a[228:231], v7, s[40:41] offset:0 sc1
    v_exp_f32 v114, v98
    v_exp_f32 v115, v99
    v_mfma_f32_32x32x16_bf16 v[64:79], v[60:63], a[16:19], v[64:79]
    ds_read_b64_tr_b16 v[52:53], v28 offset:16384
    ds_read_b64_tr_b16 v[54:55], v28 offset:16896
    global_load_dwordx4 a[232:235], v7, s[40:41] offset:1024 sc1
    v_fma_f32 v116, v112, -0.5, -1.0
    v_fma_f32 v117, v113, -0.5, -1.0
    v_fma_f32 v118, v114, -0.5, -1.0
    v_fma_f32 v119, v115, -0.5, -1.0
    s_waitcnt lgkmcnt(4)
    v_mfma_f32_32x32x16_bf16 v[64:79], v[40:43], a[20:23], v[64:79]
    ds_read_b64_tr_b16 v[56:57], v28 offset:18432
    ds_read_b64_tr_b16 v[58:59], v28 offset:18944
    v_fma_f32 v116, v112, v116, -1.0
    v_fma_f32 v117, v113, v117, -1.0
    v_fma_f32 v118, v114, v118, -1.0
    v_mfma_f32_32x32x16_bf16 v[64:79], v[44:47], a[24:27], v[64:79]
    ds_read_b64_tr_b16 v[60:61], v28 offset:20480
    ds_read_b64_tr_b16 v[62:63], v28 offset:20992
    global_load_dwordx4 a[236:239], v7, s[40:41] offset:2048 sc1
    v_fma_f32 v119, v115, v119, -1.0
    v_rcp_f32 v116, v116
    v_rcp_f32 v117, v117
    s_waitcnt lgkmcnt(4)
    v_mfma_f32_32x32x16_bf16 v[64:79], v[48:51], a[28:31], v[64:79]
    ds_read_b64_tr_b16 v[40:41], v28 offset:22528
    ds_read_b64_tr_b16 v[42:43], v28 offset:23040
    v_rcp_f32 v118, v118
    v_rcp_f32 v119, v119
    v_add_u32 v7, 83968, v6
    v_mfma_f32_32x32x16_bf16 v[64:79], v[52:55], a[32:35], v[64:79]
    ds_read_b64_tr_b16 v[44:45], v28 offset:24576
    ds_read_b64_tr_b16 v[46:47], v28 offset:25088
    global_load_dwordx4 v[128:131], v7, s[40:41] offset:-2048 sc1
    v_fma_f32 v96, v96, v116, v96
    v_fma_f32 v97, v97, v117, v97
    v_fma_f32 v98, v98, v118, v98
    s_waitcnt lgkmcnt(4)
    v_mfma_f32_32x32x16_bf16 v[64:79], v[56:59], a[36:39], v[64:79]
    ds_read_b64_tr_b16 v[48:49], v28 offset:26624
    ds_read_b64_tr_b16 v[50:51], v28 offset:27136
    global_load_dwordx4 v[132:135], v7, s[40:41] offset:-1024 sc1
    v_fma_f32 v99, v99, v119, v99
    v_cvt_pk_bf16_f32 v120, v96, v97
    v_cvt_pk_bf16_f32 v121, v98, v99
    v_mul_f32 v100, v100, v33
    v_mfma_f32_32x32x16_bf16 v[64:79], v[60:63], a[40:43], v[64:79]
    ds_read_b64_tr_b16 v[52:53], v28 offset:28672
    ds_read_b64_tr_b16 v[54:55], v28 offset:29184
    v_mul_f32 v101, v101, v33
    v_mul_f32 v102, v102, v33
    v_mul_f32 v103, v103, v33
    s_waitcnt lgkmcnt(4)
    v_mfma_f32_32x32x16_bf16 v[64:79], v[40:43], a[44:47], v[64:79]
    ds_read_b64_tr_b16 v[56:57], v28 offset:30720
    ds_read_b64_tr_b16 v[58:59], v28 offset:31232
    global_load_dwordx4 v[136:139], v7, s[40:41] offset:0 sc1
    v_exp_f32 v112, v100
    v_exp_f32 v113, v101
    v_mfma_f32_32x32x16_bf16 v[64:79], v[44:47], a[48:51], v[64:79]
    ds_read_b64_tr_b16 v[60:61], v29 offset:16384
    ds_read_b64_tr_b16 v[62:63], v29 offset:16896
    global_load_dwordx4 v[140:143], v7, s[40:41] offset:1024 sc1
    v_exp_f32 v114, v102
    v_exp_f32 v115, v103
    v_fma_f32 v116, v112, -0.5, -1.0
    s_waitcnt lgkmcnt(4)
    v_mfma_f32_32x32x16_bf16 v[64:79], v[48:51], a[52:55], v[64:79]
    ds_read_b64_tr_b16 v[40:41], v29 offset:18432
    ds_read_b64_tr_b16 v[42:43], v29 offset:18944
    v_fma_f32 v117, v113, -0.5, -1.0
    v_fma_f32 v118, v114, -0.5, -1.0
    v_fma_f32 v119, v115, -0.5, -1.0
    v_fma_f32 v116, v112, v116, -1.0
    v_mfma_f32_32x32x16_bf16 v[64:79], v[52:55], a[56:59], v[64:79]
    ds_read_b64_tr_b16 v[44:45], v29 offset:20480
    ds_read_b64_tr_b16 v[46:47], v29 offset:20992
    global_load_dwordx4 v[144:147], v7, s[40:41] offset:2048 sc1
    v_fma_f32 v117, v113, v117, -1.0
    v_fma_f32 v118, v114, v118, -1.0
    v_fma_f32 v119, v115, v119, -1.0
    s_waitcnt lgkmcnt(4)
    v_mfma_f32_32x32x16_bf16 v[64:79], v[56:59], a[60:63], v[64:79]
    ds_read_b64_tr_b16 v[48:49], v29 offset:22528
    ds_read_b64_tr_b16 v[50:51], v29 offset:23040
    v_rcp_f32 v116, v116
    v_rcp_f32 v117, v117
    v_mfma_f32_32x32x16_bf16 v[64:79], v[60:63], a[64:67], v[64:79]
    s_barrier
    ds_read_b64_tr_b16 v[52:53], v29 offset:24576
    ds_read_b64_tr_b16 v[54:55], v29 offset:25088
    v_rcp_f32 v118, v118
    v_rcp_f32 v119, v119
    s_add_u32 m0, s71, 0x0
    s_add_u32 s26, s82, 1327104
    s_waitcnt lgkmcnt(4)
    v_mfma_f32_32x32x16_bf16 v[64:79], v[40:43], a[68:71], v[64:79]
    ds_read_b64_tr_b16 v[56:57], v29 offset:26624
    ds_read_b64_tr_b16 v[58:59], v29 offset:27136
    buffer_load_dwordx4 v14, s[52:55], s26 offen lds
    v_fma_f32 v100, v100, v116, v100
    v_fma_f32 v101, v101, v117, v101
    v_fma_f32 v102, v102, v118, v102
    v_fma_f32 v103, v103, v119, v103
    v_mfma_f32_32x32x16_bf16 v[64:79], v[44:47], a[72:75], v[64:79]
    ds_read_b64_tr_b16 v[60:61], v29 offset:28672
    ds_read_b64_tr_b16 v[62:63], v29 offset:29184
    buffer_load_dwordx4 v15, s[52:55], s26 offen offset:1024 lds
    v_cvt_pk_bf16_f32 v122, v100, v101
    v_cvt_pk_bf16_f32 v123, v102, v103
    s_waitcnt lgkmcnt(4)
    v_mfma_f32_32x32x16_bf16 v[64:79], v[48:51], a[76:79], v[64:79]
    ds_read_b64_tr_b16 v[40:41], v29 offset:30720
    ds_read_b64_tr_b16 v[42:43], v29 offset:31232
    buffer_store_dwordx4 v[120:123], v31, s[40:43], s85 offen offset:0 sc1
    v_mul_f32 v104, v104, v33
    v_mul_f32 v105, v105, v33
    v_mul_f32 v106, v106, v33
    v_mul_f32 v107, v107, v33
    v_mfma_f32_32x32x16_bf16 v[64:79], v[52:55], a[80:83], v[64:79]
    ds_read_b64_tr_b16 v[44:45], v29 offset:49152
    ds_read_b64_tr_b16 v[46:47], v29 offset:49664
    buffer_load_dwordx4 v16, s[52:55], s26 offen offset:2048 lds
    v_exp_f32 v112, v104
    v_exp_f32 v113, v105
    s_waitcnt lgkmcnt(4)
    v_mfma_f32_32x32x16_bf16 v[64:79], v[56:59], a[84:87], v[64:79]
    ds_read_b64_tr_b16 v[48:49], v29 offset:51200
    ds_read_b64_tr_b16 v[50:51], v29 offset:51712
    buffer_load_dwordx4 v17, s[52:55], s26 offen offset:3072 lds
    v_exp_f32 v114, v106
    v_exp_f32 v115, v107
    v_mfma_f32_32x32x16_bf16 v[64:79], v[60:63], a[88:91], v[64:79]
    ds_read_b64_tr_b16 v[52:53], v29 offset:53248
    ds_read_b64_tr_b16 v[54:55], v29 offset:53760
    v_fma_f32 v116, v112, -0.5, -1.0
    v_fma_f32 v117, v113, -0.5, -1.0
    v_fma_f32 v118, v114, -0.5, -1.0
    v_fma_f32 v119, v115, -0.5, -1.0
    s_add_u32 m0, s71, 0x4000
    s_add_u32 s26, s82, 1769472
    s_waitcnt lgkmcnt(4)
    v_mfma_f32_32x32x16_bf16 v[64:79], v[40:43], a[92:95], v[64:79]
    ds_read_b64_tr_b16 v[56:57], v29 offset:55296
    ds_read_b64_tr_b16 v[58:59], v29 offset:55808
    buffer_load_dwordx4 v14, s[52:55], s26 offen lds
    v_fma_f32 v116, v112, v116, -1.0
    v_fma_f32 v117, v113, v117, -1.0
    v_fma_f32 v118, v114, v118, -1.0
    v_mfma_f32_32x32x16_bf16 v[64:79], v[44:47], a[96:99], v[64:79]
    ds_read_b64_tr_b16 v[60:61], v29 offset:57344
    ds_read_b64_tr_b16 v[62:63], v29 offset:57856
    buffer_load_dwordx4 v15, s[52:55], s26 offen offset:1024 lds
    v_fma_f32 v119, v115, v119, -1.0
    v_rcp_f32 v116, v116
    v_rcp_f32 v117, v117
    s_waitcnt lgkmcnt(4)
    v_mfma_f32_32x32x16_bf16 v[64:79], v[48:51], a[100:103], v[64:79]
    ds_read_b64_tr_b16 v[40:41], v29 offset:59392
    ds_read_b64_tr_b16 v[42:43], v29 offset:59904
    v_rcp_f32 v118, v118
    v_rcp_f32 v119, v119
    v_mfma_f32_32x32x16_bf16 v[64:79], v[52:55], a[104:107], v[64:79]
    ds_read_b64_tr_b16 v[44:45], v29 offset:61440
    ds_read_b64_tr_b16 v[46:47], v29 offset:61952
    buffer_load_dwordx4 v16, s[52:55], s26 offen offset:2048 lds
    v_fma_f32 v104, v104, v116, v104
    v_fma_f32 v105, v105, v117, v105
    v_fma_f32 v106, v106, v118, v106
    s_waitcnt lgkmcnt(4)
    v_mfma_f32_32x32x16_bf16 v[64:79], v[56:59], a[108:111], v[64:79]
    ds_read_b64_tr_b16 v[48:49], v29 offset:63488
    ds_read_b64_tr_b16 v[50:51], v29 offset:64000
    buffer_load_dwordx4 v17, s[52:55], s26 offen offset:3072 lds
    v_fma_f32 v107, v107, v119, v107
    v_cvt_pk_bf16_f32 v124, v104, v105
    v_cvt_pk_bf16_f32 v125, v106, v107
    v_mul_f32 v108, v108, v33
    v_mfma_f32_32x32x16_bf16 v[64:79], v[60:63], a[112:115], v[64:79]
    ds_read_b64_tr_b16 v[52:53], v29 offset:32768
    ds_read_b64_tr_b16 v[54:55], v29 offset:33280
    v_mul_f32 v109, v109, v33
    v_mul_f32 v110, v110, v33
    v_mul_f32 v111, v111, v33
    v_add_u32 v7, 104448, v6
    s_waitcnt lgkmcnt(4)
    v_mfma_f32_32x32x16_bf16 v[64:79], v[40:43], a[116:119], v[64:79]
    ds_read_b64_tr_b16 v[56:57], v29 offset:34816
    ds_read_b64_tr_b16 v[58:59], v29 offset:35328
    global_load_dwordx4 v[148:151], v7, s[40:41] offset:-2048 sc1
    v_exp_f32 v112, v108
    v_exp_f32 v113, v109
    v_mfma_f32_32x32x16_bf16 v[64:79], v[44:47], a[120:123], v[64:79]
    ds_read_b64_tr_b16 v[60:61], v29 offset:36864
    ds_read_b64_tr_b16 v[62:63], v29 offset:37376
    global_load_dwordx4 v[152:155], v7, s[40:41] offset:-1024 sc1
    v_exp_f32 v114, v110
    v_exp_f32 v115, v111
    v_fma_f32 v116, v112, -0.5, -1.0
    s_waitcnt lgkmcnt(4)
    v_mfma_f32_32x32x16_bf16 v[64:79], v[48:51], a[124:127], v[64:79]
    ds_read_b64_tr_b16 v[40:41], v29 offset:38912
    ds_read_b64_tr_b16 v[42:43], v29 offset:39424
    v_fma_f32 v117, v113, -0.5, -1.0
    v_fma_f32 v118, v114, -0.5, -1.0
    v_fma_f32 v119, v115, -0.5, -1.0
    v_fma_f32 v116, v112, v116, -1.0
    v_mfma_f32_32x32x16_bf16 v[64:79], v[52:55], a[128:131], v[64:79]
    ds_read_b64_tr_b16 v[44:45], v29 offset:40960
    ds_read_b64_tr_b16 v[46:47], v29 offset:41472
    global_load_dwordx4 v[156:159], v7, s[40:41] offset:0 sc1
    v_fma_f32 v117, v113, v117, -1.0
    v_fma_f32 v118, v114, v118, -1.0
    v_fma_f32 v119, v115, v119, -1.0
    s_waitcnt lgkmcnt(4)
    v_mfma_f32_32x32x16_bf16 v[64:79], v[56:59], a[132:135], v[64:79]
    ds_read_b64_tr_b16 v[48:49], v29 offset:43008
    ds_read_b64_tr_b16 v[50:51], v29 offset:43520
    global_load_dwordx4 v[160:163], v7, s[40:41] offset:1024 sc1
    v_rcp_f32 v116, v116
    v_rcp_f32 v117, v117
    v_mfma_f32_32x32x16_bf16 v[64:79], v[60:63], a[136:139], v[64:79]
    ds_read_b64_tr_b16 v[52:53], v29 offset:45056
    ds_read_b64_tr_b16 v[54:55], v29 offset:45568
    v_rcp_f32 v118, v118
    v_rcp_f32 v119, v119
    s_waitcnt lgkmcnt(4)
    v_mfma_f32_32x32x16_bf16 v[64:79], v[40:43], a[140:143], v[64:79]
    ds_read_b64_tr_b16 v[56:57], v29 offset:47104
    ds_read_b64_tr_b16 v[58:59], v29 offset:47616
    global_load_dwordx4 v[164:167], v7, s[40:41] offset:2048 sc1
    v_fma_f32 v108, v108, v116, v108
    v_fma_f32 v109, v109, v117, v109
    v_fma_f32 v110, v110, v118, v110
    v_fma_f32 v111, v111, v119, v111
    v_mfma_f32_32x32x16_bf16 v[64:79], v[44:47], a[144:147], v[64:79]
    ds_read_b128 v[60:63], v30 offset:2560
    v_cvt_pk_bf16_f32 v126, v108, v109
    v_cvt_pk_bf16_f32 v127, v110, v111
    buffer_store_dwordx4 v[124:127], v31, s[40:43], s85 offen offset:256 sc1
    s_cmp_ge_u32 s70, 5
    s_cbranch_scc1 LtailM3
    s_waitcnt lgkmcnt(3)
    v_mfma_f32_32x32x16_bf16 v[64:79], v[48:51], a[148:151], v[64:79]
    s_waitcnt vmcnt(25)
    s_barrier
    v_mov_b32 v35, s72
    buffer_store_dword v35, v32, s[40:43], s88 offen sc1
    ds_read_b64_tr_b16 v[40:41], v26 offset:32768
    ds_read_b64_tr_b16 v[42:43], v26 offset:33280
    v_mfma_f32_32x32x16_bf16 v[64:79], v[52:55], a[152:155], v[64:79]
    ds_read_b64_tr_b16 v[44:45], v26 offset:34816
    ds_read_b64_tr_b16 v[46:47], v26 offset:35328
    s_waitcnt lgkmcnt(4)
    v_mfma_f32_32x32x16_bf16 v[64:79], v[56:59], a[156:159], v[64:79]
    ds_read_b64_tr_b16 v[48:49], v26 offset:36864
    ds_read_b64_tr_b16 v[50:51], v26 offset:37376
    v_mfma_f32_32x32x16_bf16 v[64:79], v[60:63], v[36:39], v[64:79]
    ds_read_b64_tr_b16 v[52:53], v26 offset:38912
    ds_read_b64_tr_b16 v[54:55], v26 offset:39424
    v_add_u32 v7, 124928, v6
    s_waitcnt lgkmcnt(4)
    v_mfma_f32_32x32x16_bf16 v[96:111], v[40:43], a[0:3], 0
    ds_read_b64_tr_b16 v[56:57], v26 offset:40960
    ds_read_b64_tr_b16 v[58:59], v26 offset:41472
    global_load_dwordx4 v[168:171], v7, s[40:41] offset:-2048 sc1
    v_mfma_f32_32x32x16_bf16 v[96:111], v[44:47], a[4:7], v[96:111]
    ds_read_b64_tr_b16 v[60:61], v26 offset:43008
    ds_read_b64_tr_b16 v[62:63], v26 offset:43520
    global_load_dwordx4 v[172:175], v7, s[40:41] offset:-1024 sc1
    v_mul_f32 v64, v64, v33
    v_mul_f32 v65, v65, v33
    v_mul_f32 v66, v66, v33
    v_mul_f32 v67, v67, v33
    s_waitcnt lgkmcnt(4)
    v_mfma_f32_32x32x16_bf16 v[96:111], v[48:51], a[8:11], v[96:111]
    ds_read_b64_tr_b16 v[40:41], v26 offset:45056
    ds_read_b64_tr_b16 v[42:43], v26 offset:45568
    v_exp_f32 v112, v64
    v_exp_f32 v113, v65
    v_mfma_f32_32x32x16_bf16 v[96:111], v[52:55], a[12:15], v[96:111]
    ds_read_b64_tr_b16 v[44:45], v26 offset:47104
    ds_read_b64_tr_b16 v[46:47], v26 offset:47616
    global_load_dwordx4 v[176:179], v7, s[40:41] offset:0 sc1
    v_exp_f32 v114, v66
    v_exp_f32 v115, v67
    s_waitcnt lgkmcnt(4)
    v_mfma_f32_32x32x16_bf16 v[96:111], v[56:59], a[16:19], v[96:111]
    ds_read_b64_tr_b16 v[48:49], v27 offset:0
    ds_read_b64_tr_b16 v[50:51], v27 offset:512
    v_fma_f32 v116, v112, -0.5, -1.0
    v_fma_f32 v117, v113, -0.5, -1.0
    v_fma_f32 v118, v114, -0.5, -1.0
    v_fma_f32 v119, v115, -0.5, -1.0
    v_mfma_f32_32x32x16_bf16 v[96:111], v[60:63], a[20:23], v[96:111]
    ds_read_b64_tr_b16 v[52:53], v27 offset:2048
    ds_read_b64_tr_b16 v[54:55], v27 offset:2560
    global_load_dwordx4 v[180:183], v7, s[40:41] offset:1024 sc1
    v_fma_f32 v116, v112, v116, -1.0
    v_fma_f32 v117, v113, v117, -1.0
    v_fma_f32 v118, v114, v118, -1.0
    v_fma_f32 v119, v115, v119, -1.0
    s_waitcnt lgkmcnt(4)
    v_mfma_f32_32x32x16_bf16 v[96:111], v[40:43], a[24:27], v[96:111]
    ds_read_b64_tr_b16 v[56:57], v27 offset:4096
    ds_read_b64_tr_b16 v[58:59], v27 offset:4608
    v_rcp_f32 v116, v116
    v_rcp_f32 v117, v117
    v_mfma_f32_32x32x16_bf16 v[96:111], v[44:47], a[28:31], v[96:111]
    ds_read_b64_tr_b16 v[60:61], v27 offset:6144
    ds_read_b64_tr_b16 v[62:63], v27 offset:6656
    global_load_dwordx4 v[184:187], v7, s[40:41] offset:2048 sc1
    v_rcp_f32 v118, v118
    v_rcp_f32 v119, v119
    s_waitcnt lgkmcnt(4)
    v_mfma_f32_32x32x16_bf16 v[96:111], v[48:51], a[32:35], v[96:111]
    ds_read_b64_tr_b16 v[40:41], v27 offset:8192
    ds_read_b64_tr_b16 v[42:43], v27 offset:8704
    v_fma_f32 v64, v64, v116, v64
    v_fma_f32 v65, v65, v117, v65
    v_fma_f32 v66, v66, v118, v66
    v_fma_f32 v67, v67, v119, v67
    v_add_u32 v7, 145408, v6
    v_mfma_f32_32x32x16_bf16 v[96:111], v[52:55], a[36:39], v[96:111]
    ds_read_b64_tr_b16 v[44:45], v27 offset:10240
    ds_read_b64_tr_b16 v[46:47], v27 offset:10752
    global_load_dwordx4 v[188:191], v7, s[40:41] offset:-2048 sc1
    v_cvt_pk_bf16_f32 v120, v64, v65
    v_cvt_pk_bf16_f32 v121, v66, v67
    v_mul_f32 v68, v68, v33
    v_mul_f32 v69, v69, v33
    s_waitcnt lgkmcnt(4)
    v_mfma_f32_32x32x16_bf16 v[96:111], v[56:59], a[40:43], v[96:111]
    ds_read_b64_tr_b16 v[48:49], v27 offset:12288
    ds_read_b64_tr_b16 v[50:51], v27 offset:12800
    global_load_dwordx4 v[192:195], v7, s[40:41] offset:-1024 sc1
    v_mul_f32 v70, v70, v33
    v_mul_f32 v71, v71, v33
    v_exp_f32 v112, v68
    v_mfma_f32_32x32x16_bf16 v[96:111], v[60:63], a[44:47], v[96:111]
    ds_read_b64_tr_b16 v[52:53], v27 offset:14336
    ds_read_b64_tr_b16 v[54:55], v27 offset:14848
    v_exp_f32 v113, v69
    v_exp_f32 v114, v70
    s_waitcnt lgkmcnt(4)
    v_mfma_f32_32x32x16_bf16 v[96:111], v[40:43], a[48:51], v[96:111]
    ds_read_b64_tr_b16 v[56:57], v26 offset:49152
    ds_read_b64_tr_b16 v[58:59], v26 offset:49664
    global_load_dwordx4 v[196:199], v7, s[40:41] offset:0 sc1
    v_exp_f32 v115, v71
    v_fma_f32 v116, v112, -0.5, -1.0
    v_fma_f32 v117, v113, -0.5, -1.0
    v_mfma_f32_32x32x16_bf16 v[96:111], v[44:47], a[52:55], v[96:111]
    ds_read_b64_tr_b16 v[60:61], v26 offset:51200
    ds_read_b64_tr_b16 v[62:63], v26 offset:51712
    v_fma_f32 v118, v114, -0.5, -1.0
    v_fma_f32 v119, v115, -0.5, -1.0
    v_fma_f32 v116, v112, v116, -1.0
    v_fma_f32 v117, v113, v117, -1.0
    s_waitcnt lgkmcnt(4)
    v_mfma_f32_32x32x16_bf16 v[96:111], v[48:51], a[56:59], v[96:111]
    ds_read_b64_tr_b16 v[40:41], v26 offset:53248
    ds_read_b64_tr_b16 v[42:43], v26 offset:53760
    global_load_dwordx4 v[200:203], v7, s[40:41] offset:1024 sc1
    v_fma_f32 v118, v114, v118, -1.0
    v_fma_f32 v119, v115, v119, -1.0
    v_rcp_f32 v116, v116
    v_mfma_f32_32x32x16_bf16 v[96:111], v[52:55], a[60:63], v[96:111]
    ds_read_b64_tr_b16 v[44:45], v26 offset:55296
    ds_read_b64_tr_b16 v[46:47], v26 offset:55808
    v_rcp_f32 v117, v117
    v_rcp_f32 v118, v118
    s_waitcnt lgkmcnt(4)
    v_mfma_f32_32x32x16_bf16 v[96:111], v[56:59], a[64:67], v[96:111]
    ds_read_b64_tr_b16 v[48:49], v26 offset:57344
    ds_read_b64_tr_b16 v[50:51], v26 offset:57856
    global_load_dwordx4 v[204:207], v7, s[40:41] offset:2048 sc1
    v_rcp_f32 v119, v119
    v_fma_f32 v68, v68, v116, v68
    v_fma_f32 v69, v69, v117, v69
    v_mfma_f32_32x32x16_bf16 v[96:111], v[60:63], a[68:71], v[96:111]
    ds_read_b64_tr_b16 v[52:53], v26 offset:59392
    ds_read_b64_tr_b16 v[54:55], v26 offset:59904
    v_fma_f32 v70, v70, v118, v70
    v_fma_f32 v71, v71, v119, v71
    v_cvt_pk_bf16_f32 v122, v68, v69
    v_cvt_pk_bf16_f32 v123, v70, v71
    s_waitcnt lgkmcnt(4)
    v_mfma_f32_32x32x16_bf16 v[96:111], v[40:43], a[72:75], v[96:111]
    ds_read_b64_tr_b16 v[56:57], v26 offset:61440
    ds_read_b64_tr_b16 v[58:59], v26 offset:61952
    buffer_store_dwordx4 v[120:123], v31, s[40:43], s85 offen offset:1024 sc1
    v_mul_f32 v72, v72, v33
    v_mul_f32 v73, v73, v33
    v_add_u32 v7, 165888, v6
    global_load_dwordx4 v[208:211], v7, s[40:41] offset:-2048 sc1
    v_mfma_f32_32x32x16_bf16 v[96:111], v[44:47], a[76:79], v[96:111]
    ds_read_b64_tr_b16 v[60:61], v26 offset:63488
    ds_read_b64_tr_b16 v[62:63], v26 offset:64000
    global_load_dwordx4 v[212:215], v7, s[40:41] offset:-1024 sc1
    v_mul_f32 v74, v74, v33
    v_mul_f32 v75, v75, v33
    v_exp_f32 v112, v72
    s_waitcnt lgkmcnt(4)
    v_mfma_f32_32x32x16_bf16 v[96:111], v[48:51], a[80:83], v[96:111]
    s_waitcnt vmcnt(20)
    s_barrier
    ds_read_b64_tr_b16 v[40:41], v26 offset:0
    ds_read_b64_tr_b16 v[42:43], v26 offset:512
    v_exp_f32 v113, v73
    v_exp_f32 v114, v74
    v_mfma_f32_32x32x16_bf16 v[96:111], v[52:55], a[84:87], v[96:111]
    ds_read_b64_tr_b16 v[44:45], v26 offset:2048
    ds_read_b64_tr_b16 v[46:47], v26 offset:2560
    global_load_dwordx4 v[216:219], v7, s[40:41] offset:0 sc1
    v_exp_f32 v115, v75
    v_fma_f32 v116, v112, -0.5, -1.0
    v_fma_f32 v117, v113, -0.5, -1.0
    s_waitcnt lgkmcnt(4)
    v_mfma_f32_32x32x16_bf16 v[96:111], v[56:59], a[88:91], v[96:111]
    ds_read_b64_tr_b16 v[48:49], v26 offset:4096
    ds_read_b64_tr_b16 v[50:51], v26 offset:4608
    v_fma_f32 v118, v114, -0.5, -1.0
    v_fma_f32 v119, v115, -0.5, -1.0
    v_fma_f32 v116, v112, v116, -1.0
    v_fma_f32 v117, v113, v117, -1.0
    v_mfma_f32_32x32x16_bf16 v[96:111], v[60:63], a[92:95], v[96:111]
    ds_read_b64_tr_b16 v[52:53], v26 offset:6144
    ds_read_b64_tr_b16 v[54:55], v26 offset:6656
    global_load_dwordx4 v[220:223], v7, s[40:41] offset:1024 sc1
    v_fma_f32 v118, v114, v118, -1.0
    v_fma_f32 v119, v115, v119, -1.0
    v_rcp_f32 v116, v116
    s_waitcnt lgkmcnt(4)
    v_mfma_f32_32x32x16_bf16 v[96:111], v[40:43], a[96:99], v[96:111]
    ds_read_b64_tr_b16 v[56:57], v26 offset:8192
    ds_read_b64_tr_b16 v[58:59], v26 offset:8704
    v_rcp_f32 v117, v117
    v_rcp_f32 v118, v118
    v_mfma_f32_32x32x16_bf16 v[96:111], v[44:47], a[100:103], v[96:111]
    ds_read_b64_tr_b16 v[60:61], v26 offset:10240
    ds_read_b64_tr_b16 v[62:63], v26 offset:10752
    global_load_dwordx4 v[224:227], v7, s[40:41] offset:2048 sc1
    v_rcp_f32 v119, v119
    v_fma_f32 v72, v72, v116, v72
    v_fma_f32 v73, v73, v117, v73
    s_waitcnt lgkmcnt(4)
    v_mfma_f32_32x32x16_bf16 v[96:111], v[48:51], a[104:107], v[96:111]
    ds_read_b64_tr_b16 v[40:41], v26 offset:12288
    ds_read_b64_tr_b16 v[42:43], v26 offset:12800
    v_fma_f32 v74, v74, v118, v74
    v_fma_f32 v75, v75, v119, v75
    v_cvt_pk_bf16_f32 v124, v72, v73
    v_cvt_pk_bf16_f32 v125, v74, v75
    v_add_u32 v7, 186368, v6
    v_mfma_f32_32x32x16_bf16 v[96:111], v[52:55], a[108:111], v[96:111]
    ds_read_b64_tr_b16 v[44:45], v26 offset:14336
    ds_read_b64_tr_b16 v[46:47], v26 offset:14848
    global_load_dwordx4 v[228:231], v7, s[40:41] offset:-2048 sc1
    v_mul_f32 v76, v76, v33
    v_mul_f32 v77, v77, v33
    v_mul_f32 v78, v78, v33
    v_mul_f32 v79, v79, v33
    s_waitcnt lgkmcnt(4)
    v_mfma_f32_32x32x16_bf16 v[96:111], v[56:59], a[112:115], v[96:111]
    ds_read_b64_tr_b16 v[48:49], v26 offset:16384
    ds_read_b64_tr_b16 v[50:51], v26 offset:16896
    global_load_dwordx4 v[232:235], v7, s[40:41] offset:-1024 sc1
    v_exp_f32 v112, v76
    v_exp_f32 v113, v77
    v_mfma_f32_32x32x16_bf16 v[96:111], v[60:63], a[116:119], v[96:111]
    ds_read_b64_tr_b16 v[52:53], v26 offset:18432
    ds_read_b64_tr_b16 v[54:55], v26 offset:18944
    v_exp_f32 v114, v78
    v_exp_f32 v115, v79
    s_waitcnt lgkmcnt(4)
    v_mfma_f32_32x32x16_bf16 v[96:111], v[40:43], a[120:123], v[96:111]
    ds_read_b64_tr_b16 v[56:57], v26 offset:20480
    ds_read_b64_tr_b16 v[58:59], v26 offset:20992
    global_load_dwordx4 v[236:239], v7, s[40:41] offset:0 sc1
    v_fma_f32 v116, v112, -0.5, -1.0
    v_fma_f32 v117, v113, -0.5, -1.0
    v_fma_f32 v118, v114, -0.5, -1.0
    v_fma_f32 v119, v115, -0.5, -1.0
    v_mfma_f32_32x32x16_bf16 v[96:111], v[44:47], a[124:127], v[96:111]
    ds_read_b64_tr_b16 v[60:61], v26 offset:22528
    ds_read_b64_tr_b16 v[62:63], v26 offset:23040
    v_fma_f32 v116, v112, v116, -1.0
    v_fma_f32 v117, v113, v117, -1.0
    v_fma_f32 v118, v114, v118, -1.0
    v_fma_f32 v119, v115, v119, -1.0
    s_waitcnt lgkmcnt(4)
    v_mfma_f32_32x32x16_bf16 v[96:111], v[48:51], a[128:131], v[96:111]
    ds_read_b64_tr_b16 v[40:41], v26 offset:24576
    ds_read_b64_tr_b16 v[42:43], v26 offset:25088
    global_load_dwordx4 v[240:243], v7, s[40:41] offset:1024 sc1
    v_rcp_f32 v116, v116
    v_rcp_f32 v117, v117
    v_mfma_f32_32x32x16_bf16 v[96:111], v[52:55], a[132:135], v[96:111]
    ds_read_b64_tr_b16 v[44:45], v26 offset:26624
    ds_read_b64_tr_b16 v[46:47], v26 offset:27136
    v_rcp_f32 v118, v118
    v_rcp_f32 v119, v119
    s_waitcnt lgkmcnt(4)
    v_mfma_f32_32x32x16_bf16 v[96:111], v[56:59], a[136:139], v[96:111]
    ds_read_b64_tr_b16 v[48:49], v26 offset:28672
    ds_read_b64_tr_b16 v[50:51], v26 offset:29184
    global_load_dwordx4 v[244:247], v7, s[40:41] offset:2048 sc1
    v_fma_f32 v76, v76, v116, v76
    v_fma_f32 v77, v77, v117, v77
    v_fma_f32 v78, v78, v118, v78
    v_fma_f32 v79, v79, v119, v79
    v_mfma_f32_32x32x16_bf16 v[96:111], v[60:63], a[140:143], v[96:111]
    ds_read_b64_tr_b16 v[52:53], v26 offset:30720
    ds_read_b64_tr_b16 v[54:55], v26 offset:31232
    v_cvt_pk_bf16_f32 v126, v76, v77
    v_cvt_pk_bf16_f32 v127, v78, v79
    buffer_store_dwordx4 v[124:127], v31, s[40:43], s85 offen offset:1280 sc1
    s_add_u32 m0, s91, 2048
    v_add_u32 v7, 288768, v6
    s_waitcnt lgkmcnt(4)
    v_mfma_f32_32x32x16_bf16 v[96:111], v[40:43], a[144:147], v[96:111]
    ds_read_b128 v[56:59], v30 offset:3072
    global_load_lds_dwordx4 v7, s[40:41] offset:-2048 sc1
    v_mfma_f32_32x32x16_bf16 v[96:111], v[44:47], a[148:151], v[96:111]
    ds_read_b64_tr_b16 v[60:61], v28 offset:32768
    ds_read_b64_tr_b16 v[62:63], v28 offset:33280
    buffer_load_dword v24, v20, s[40:43], 0 offen sc1
    s_mul_i32 s77, s93, 5
    s_waitcnt lgkmcnt(3)
    v_mfma_f32_32x32x16_bf16 v[96:111], v[48:51], a[152:155], v[96:111]
    ds_read_b64_tr_b16 v[40:41], v28 offset:34816
    ds_read_b64_tr_b16 v[42:43], v28 offset:35328
    global_load_lds_dwordx4 v7, s[40:41] offset:-1024 sc1
    s_lshr_b32 s77, s77, 1
    v_mfma_f32_32x32x16_bf16 v[96:111], v[52:55], a[156:159], v[96:111]
    ds_read_b64_tr_b16 v[44:45], v28 offset:36864
    ds_read_b64_tr_b16 v[46:47], v28 offset:37376
    s_lshl_b32 s77, s77, 8
    s_add_u32 s77, s77, 77824
    s_waitcnt lgkmcnt(4)
    v_mfma_f32_32x32x16_bf16 v[96:111], v[56:59], v[36:39], v[96:111]
    ds_read_b64_tr_b16 v[48:49], v28 offset:38912
    ds_read_b64_tr_b16 v[50:51], v28 offset:39424
    global_load_lds_dwordx4 v7, s[40:41] offset:0 sc1
    v_mfma_f32_32x32x16_bf16 v[64:79], v[60:63], a[0:3], 0
    ds_read_b64_tr_b16 v[52:53], v28 offset:40960
    ds_read_b64_tr_b16 v[54:55], v28 offset:41472
    s_waitcnt lgkmcnt(4)
    v_mfma_f32_32x32x16_bf16 v[64:79], v[40:43], a[4:7], v[64:79]
    ds_read_b64_tr_b16 v[56:57], v28 offset:43008
    ds_read_b64_tr_b16 v[58:59], v28 offset:43520
    global_load_lds_dwordx4 v7, s[40:41] offset:1024 sc1
    s_nop 0
    v_mul_f32 v96, v96, v33
    v_mul_f32 v97, v97, v33
    v_mul_f32 v98, v98, v33
    v_mul_f32 v99, v99, v33
    v_mfma_f32_32x32x16_bf16 v[64:79], v[44:47], a[8:11], v[64:79]
    ds_read_b64_tr_b16 v[60:61], v28 offset:45056
    ds_read_b64_tr_b16 v[62:63], v28 offset:45568
    v_exp_f32 v112, v96
    v_exp_f32 v113, v97
    s_waitcnt lgkmcnt(4)
    v_mfma_f32_32x32x16_bf16 v[64:79], v[48:51], a[12:15], v[64:79]
    ds_read_b64_tr_b16 v[40:41], v28 offset:47104
    ds_read_b64_tr_b16 v[42:43], v28 offset:47616
    global_load_lds_dwordx4 v7, s[40:41] offset:2048 sc1
    v_exp_f32 v114, v98
    v_mfma_f32_32x32x16_bf16 v[64:79], v[52:55], a[16:19], v[64:79]
    ds_read_b64_tr_b16 v[44:45], v29 offset:0
    ds_read_b64_tr_b16 v[46:47], v29 offset:512
    v_exp_f32 v115, v99
    v_fma_f32 v116, v112, -0.5, -1.0
    v_fma_f32 v117, v113, -0.5, -1.0
    s_waitcnt lgkmcnt(4)
    v_mfma_f32_32x32x16_bf16 v[64:79], v[56:59], a[20:23], v[64:79]
    ds_read_b64_tr_b16 v[48:49], v29 offset:2048
    ds_read_b64_tr_b16 v[50:51], v29 offset:2560
    v_fma_f32 v118, v114, -0.5, -1.0
    v_fma_f32 v119, v115, -0.5, -1.0
    v_fma_f32 v116, v112, v116, -1.0
    v_fma_f32 v117, v113, v117, -1.0
    s_add_u32 m0, s91, 7168
    v_add_u32 v7, 309248, v6
    v_mfma_f32_32x32x16_bf16 v[64:79], v[60:63], a[24:27], v[64:79]
    ds_read_b64_tr_b16 v[52:53], v29 offset:4096
    ds_read_b64_tr_b16 v[54:55], v29 offset:4608
    global_load_lds_dwordx4 v7, s[40:41] offset:-2048 sc1
    v_fma_f32 v118, v114, v118, -1.0
    v_fma_f32 v119, v115, v119, -1.0
    v_rcp_f32 v116, v116
    s_waitcnt lgkmcnt(4)
    v_mfma_f32_32x32x16_bf16 v[64:79], v[40:43], a[28:31], v[64:79]
    ds_read_b64_tr_b16 v[56:57], v29 offset:6144
    ds_read_b64_tr_b16 v[58:59], v29 offset:6656
    v_rcp_f32 v117, v117
    v_rcp_f32 v118, v118
    v_mfma_f32_32x32x16_bf16 v[64:79], v[44:47], a[32:35], v[64:79]
    ds_read_b64_tr_b16 v[60:61], v29 offset:8192
    ds_read_b64_tr_b16 v[62:63], v29 offset:8704
    global_load_lds_dwordx4 v7, s[40:41] offset:-1024 sc1
    v_rcp_f32 v119, v119
    v_fma_f32 v96, v96, v116, v96
    s_waitcnt lgkmcnt(4)
    v_mfma_f32_32x32x16_bf16 v[64:79], v[48:51], a[36:39], v[64:79]
    ds_read_b64_tr_b16 v[40:41], v29 offset:10240
    ds_read_b64_tr_b16 v[42:43], v29 offset:10752
    v_fma_f32 v97, v97, v117, v97
    v_fma_f32 v98, v98, v118, v98
    v_fma_f32 v99, v99, v119, v99
    v_mfma_f32_32x32x16_bf16 v[64:79], v[52:55], a[40:43], v[64:79]
    ds_read_b64_tr_b16 v[44:45], v29 offset:12288
    ds_read_b64_tr_b16 v[46:47], v29 offset:12800
    global_load_lds_dwordx4 v7, s[40:41] offset:0 sc1
    v_cvt_pk_bf16_f32 v120, v96, v97
    v_cvt_pk_bf16_f32 v121, v98, v99
    v_mul_f32 v100, v100, v33
    v_mul_f32 v101, v101, v33
    s_waitcnt lgkmcnt(4)
    v_mfma_f32_32x32x16_bf16 v[64:79], v[56:59], a[44:47], v[64:79]
    ds_read_b64_tr_b16 v[48:49], v29 offset:14336
    ds_read_b64_tr_b16 v[50:51], v29 offset:14848
    v_mul_f32 v102, v102, v33
    v_mul_f32 v103, v103, v33
    v_exp_f32 v112, v100
    v_mfma_f32_32x32x16_bf16 v[64:79], v[60:63], a[48:51], v[64:79]
    ds_read_b64_tr_b16 v[52:53], v28 offset:49152
    ds_read_b64_tr_b16 v[54:55], v28 offset:49664
    global_load_lds_dwordx4 v7, s[40:41] offset:1024 sc1
    v_exp_f32 v113, v101
    v_exp_f32 v114, v102
    s_waitcnt lgkmcnt(4)
    v_mfma_f32_32x32x16_bf16 v[64:79], v[40:43], a[52:55], v[64:79]
    ds_read_b64_tr_b16 v[56:57], v28 offset:51200
    ds_read_b64_tr_b16 v[58:59], v28 offset:51712
    v_exp_f32 v115, v103
    v_fma_f32 v116, v112, -0.5, -1.0
    v_mfma_f32_32x32x16_bf16 v[64:79], v[44:47], a[56:59], v[64:79]
    ds_read_b64_tr_b16 v[60:61], v28 offset:53248
    ds_read_b64_tr_b16 v[62:63], v28 offset:53760
    global_load_lds_dwordx4 v7, s[40:41] offset:2048 sc1
    v_fma_f32 v117, v113, -0.5, -1.0
    v_fma_f32 v118, v114, -0.5, -1.0
    v_fma_f32 v119, v115, -0.5, -1.0
    s_waitcnt vmcnt(9)
    v_cmp_ne_u32 vcc, s72, v24
    s_nop 4
    s_cbranch_vccnz Lslow1
Lback1:
    s_waitcnt lgkmcnt(4)
    v_mfma_f32_32x32x16_bf16 v[64:79], v[48:51], a[60:63], v[64:79]
    ds_read_b64_tr_b16 v[40:41], v28 offset:55296
    ds_read_b64_tr_b16 v[42:43], v28 offset:55808
    v_fma_f32 v116, v112, v116, -1.0
    v_fma_f32 v117, v113, v117, -1.0
    v_fma_f32 v118, v114, v118, -1.0
    v_fma_f32 v119, v115, v119, -1.0
    v_mfma_f32_32x32x16_bf16 v[64:79], v[52:55], a[64:67], v[64:79]
    ds_read_b64_tr_b16 v[44:45], v28 offset:57344
    ds_read_b64_tr_b16 v[46:47], v28 offset:57856
    buffer_load_dwordx4 v[8:11], v252, s[40:43], s77 offen offset:0 sc1
    v_rcp_f32 v116, v116
    v_rcp_f32 v117, v117
    s_waitcnt lgkmcnt(4)
    v_mfma_f32_32x32x16_bf16 v[64:79], v[56:59], a[68:71], v[64:79]
    ds_read_b64_tr_b16 v[48:49], v28 offset:59392
    ds_read_b64_tr_b16 v[50:51], v28 offset:59904
    buffer_load_dwordx4 v[12:15], v252, s[40:43], s77 offen offset:256 sc1
    v_rcp_f32 v118, v118
    v_rcp_f32 v119, v119
    v_mfma_f32_32x32x16_bf16 v[64:79], v[60:63], a[72:75], v[64:79]
    s_barrier
    v_mov_b32 v35, s72
    buffer_store_dword v35, v32, s[40:43], s89 offen sc1
    ds_read_b64_tr_b16 v[52:53], v28 offset:61440
    ds_read_b64_tr_b16 v[54:55], v28 offset:61952
    v_fma_f32 v100, v100, v116, v100
    v_fma_f32 v101, v101, v117, v101
    v_fma_f32 v102, v102, v118, v102
    s_waitcnt lgkmcnt(4)
    v_mfma_f32_32x32x16_bf16 v[64:79], v[40:43], a[76:79], v[64:79]
    ds_read_b64_tr_b16 v[56:57], v28 offset:63488
    ds_read_b64_tr_b16 v[58:59], v28 offset:64000
    buffer_load_dwordx4 v[16:19], v252, s[40:43], s77 offen offset:512 sc1
    v_fma_f32 v103, v103, v119, v103
    v_cvt_pk_bf16_f32 v122, v100, v101
    v_cvt_pk_bf16_f32 v123, v102, v103
    v_mfma_f32_32x32x16_bf16 v[64:79], v[44:47], a[80:83], v[64:79]
    ds_read_b64_tr_b16 v[60:61], v28 offset:0
    ds_read_b64_tr_b16 v[62:63], v28 offset:512
    buffer_store_dwordx4 v[120:123], v31, s[40:43], s86 offen offset:0 sc1
    v_mul_f32 v104, v104, v33
    v_mul_f32 v105, v105, v33
    s_waitcnt lgkmcnt(4)
    v_mfma_f32_32x32x16_bf16 v[64:79], v[48:51], a[84:87], v[64:79]
    ds_read_b64_tr_b16 v[40:41], v28 offset:2048
    ds_read_b64_tr_b16 v[42:43], v28 offset:2560
    buffer_load_dword v24, v21, s[40:43], 0 offen sc1
    v_mul_f32 v106, v106, v33
    v_mul_f32 v107, v107, v33
    v_exp_f32 v112, v104
    v_mfma_f32_32x32x16_bf16 v[64:79], v[52:55], a[88:91], v[64:79]
    ds_read_b64_tr_b16 v[44:45], v28 offset:4096
    ds_read_b64_tr_b16 v[46:47], v28 offset:4608
    v_exp_f32 v113, v105
    ds_read_b64_tr_b16 a[0:1], v22 offset:0
    s_waitcnt lgkmcnt(5)
    v_mfma_f32_32x32x16_bf16 v[64:79], v[56:59], a[92:95], v[64:79]
    ds_read_b64_tr_b16 v[48:49], v28 offset:6144
    ds_read_b64_tr_b16 v[50:51], v28 offset:6656
    v_exp_f32 v114, v106
    v_exp_f32 v115, v107
    v_fma_f32 v116, v112, -0.5, -1.0
    ds_read_b64_tr_b16 a[2:3], v22 offset:160
    v_mfma_f32_32x32x16_bf16 v[64:79], v[60:63], a[96:99], v[64:79]
    ds_read_b64_tr_b16 v[52:53], v28 offset:8192
    ds_read_b64_tr_b16 v[54:55], v28 offset:8704
    v_fma_f32 v117, v113, -0.5, -1.0
    v_fma_f32 v118, v114, -0.5, -1.0
    v_fma_f32 v119, v115, -0.5, -1.0
    ds_read_b64_tr_b16 a[4:5], v22 offset:320
    s_waitcnt lgkmcnt(7)
    v_mfma_f32_32x32x16_bf16 v[64:79], v[40:43], a[100:103], v[64:79]
    ds_read_b64_tr_b16 v[56:57], v28 offset:10240
    ds_read_b64_tr_b16 v[58:59], v28 offset:10752
    v_fma_f32 v116, v112, v116, -1.0
    v_fma_f32 v117, v113, v117, -1.0
    v_fma_f32 v118, v114, v118, -1.0
    v_fma_f32 v119, v115, v119, -1.0
    ds_read_b64_tr_b16 a[6:7], v22 offset:480
    v_mfma_f32_32x32x16_bf16 v[64:79], v[44:47], a[104:107], v[64:79]
    ds_read_b64_tr_b16 v[60:61], v28 offset:12288
    ds_read_b64_tr_b16 v[62:63], v28 offset:12800
    v_rcp_f32 v116, v116
    v_rcp_f32 v117, v117
    ds_read_b64_tr_b16 a[8:9], v22 offset:640
    s_waitcnt lgkmcnt(7)
    v_mfma_f32_32x32x16_bf16 v[64:79], v[48:51], a[108:111], v[64:79]
    ds_read_b64_tr_b16 v[40:41], v28 offset:14336
    ds_read_b64_tr_b16 v[42:43], v28 offset:14848
    v_rcp_f32 v118, v118
    ds_read_b64_tr_b16 a[10:11], v22 offset:800
    s_add_u32 m0, s91, 12288
    v_add_u32 v7, 329728, v6
    v_mfma_f32_32x32x16_bf16 v[64:79], v[52:55], a[112:115], v[64:79]
    ds_read_b64_tr_b16 v[44:45], v28 offset:16384
    ds_read_b64_tr_b16 v[46:47], v28 offset:16896
    global_load_lds_dwordx4 v7, s[40:41] offset:-2048 sc1
    v_rcp_f32 v119, v119
    v_fma_f32 v104, v104, v116, v104
    v_fma_f32 v105, v105, v117, v105
    v_fma_f32 v106, v106, v118, v106
    ds_read_b64_tr_b16 a[12:13], v23 offset:0
    s_waitcnt lgkmcnt(7)
    v_mfma_f32_32x32x16_bf16 v[64:79], v[56:59], a[116:119], v[64:79]
    ds_read_b64_tr_b16 v[48:49], v28 offset:18432
    ds_read_b64_tr_b16 v[50:51], v28 offset:18944
    v_fma_f32 v107, v107, v119, v107
    v_cvt_pk_bf16_f32 v124, v104, v105
    v_cvt_pk_bf16_f32 v125, v106, v107
    ds_read_b64_tr_b16 a[14:15], v23 offset:160
    v_mfma_f32_32x32x16_bf16 v[64:79], v[60:63], a[120:123], v[64:79]
    ds_read_b64_tr_b16 v[52:53], v28 offset:20480
    ds_read_b64_tr_b16 v[54:55], v28 offset:20992
    global_load_lds_dwordx4 v7, s[40:41] offset:-1024 sc1
    v_mul_f32 v108, v108, v33
    v_mul_f32 v109, v109, v33
    v_mul_f32 v110, v110, v33
    v_mul_f32 v111, v111, v33
    ds_read_b64_tr_b16 a[16:17], v23 offset:320
    s_waitcnt lgkmcnt(7)
    v_mfma_f32_32x32x16_bf16 v[64:79], v[40:43], a[124:127], v[64:79]
    ds_read_b64_tr_b16 v[56:57], v28 offset:22528
    ds_read_b64_tr_b16 v[58:59], v28 offset:23040
    v_exp_f32 v112, v108
    v_exp_f32 v113, v109
    ds_read_b64_tr_b16 a[18:19], v23 offset:480
    v_mfma_f32_32x32x16_bf16 v[64:79], v[44:47], a[128:131], v[64:79]
    ds_read_b64_tr_b16 v[60:61], v28 offset:24576
    ds_read_b64_tr_b16 v[62:63], v28 offset:25088
    global_load_lds_dwordx4 v7, s[40:41] offset:0 sc1
    v_exp_f32 v114, v110
    ds_read_b64_tr_b16 a[20:21], v23 offset:640
    s_waitcnt lgkmcnt(7)
    v_mfma_f32_32x32x16_bf16 v[64:79], v[48:51], a[132:135], v[64:79]
    ds_read_b64_tr_b16 v[40:41], v28 offset:26624
    ds_read_b64_tr_b16 v[42:43], v28 offset:27136
    v_exp_f32 v115, v111
    v_fma_f32 v116, v112, -0.5, -1.0
    v_fma_f32 v117, v113, -0.5, -1.0
    ds_read_b64_tr_b16 a[22:23], v23 offset:800
    v_mfma_f32_32x32x16_bf16 v[64:79], v[52:55], a[136:139], v[64:79]
    ds_read_b64_tr_b16 v[44:45], v28 offset:28672
    ds_read_b64_tr_b16 v[46:47], v28 offset:29184
    global_load_lds_dwordx4 v7, s[40:41] offset:1024 sc1
    v_fma_f32 v118, v114, -0.5, -1.0
    v_fma_f32 v119, v115, -0.5, -1.0
    v_fma_f32 v116, v112, v116, -1.0
    v_fma_f32 v117, v113, v117, -1.0
    s_waitcnt lgkmcnt(6)
    v_mfma_f32_32x32x16_bf16 v[64:79], v[56:59], a[140:143], v[64:79]
    ds_read_b64_tr_b16 v[48:49], v28 offset:30720
    ds_read_b64_tr_b16 v[50:51], v28 offset:31232
    v_fma_f32 v118, v114, v118, -1.0
    v_fma_f32 v119, v115, v119, -1.0
    v_rcp_f32 v116, v116
    v_mfma_f32_32x32x16_bf16 v[64:79], v[60:63], a[144:147], v[64:79]
    ds_read_b128 v[52:55], v30 offset:3584
    global_load_lds_dwordx4 v7, s[40:41] offset:2048 sc1
    v_rcp_f32 v117, v117
    v_rcp_f32 v118, v118
    s_mov_b32 s98, s90
    s_mov_b32 s25, s86
    s_waitcnt lgkmcnt(3)
    v_mfma_f32_32x32x16_bf16 v[64:79], v[40:43], a[148:151], v[64:79]
    v_rcp_f32 v119, v119
    v_fma_f32 v108, v108, v116, v108
    v_mfma_f32_32x32x16_bf16 v[64:79], v[44:47], a[152:155], v[64:79]
    v_fma_f32 v109, v109, v117, v109
    v_fma_f32 v110, v110, v118, v110
    v_fma_f32 v111, v111, v119, v111
    s_waitcnt lgkmcnt(0)
    v_mfma_f32_32x32x16_bf16 v[64:79], v[48:51], a[156:159], v[64:79]
    v_cvt_pk_bf16_f32 v126, v108, v109
    v_cvt_pk_bf16_f32 v127, v110, v111
    v_mfma_f32_32x32x16_bf16 v[64:79], v[52:55], v[36:39], v[64:79]
    buffer_store_dwordx4 v[124:127], v31, s[40:43], s86 offen offset:256 sc1
    s_branch Ljoin
LtailM3:
    s_nop 3
    s_waitcnt lgkmcnt(3)
    v_mfma_f32_32x32x16_bf16 v[64:79], v[48:51], a[148:151], v[64:79]
    v_mfma_f32_32x32x16_bf16 v[64:79], v[52:55], a[152:155], v[64:79]
    s_waitcnt lgkmcnt(0)
    v_mfma_f32_32x32x16_bf16 v[64:79], v[56:59], a[156:159], v[64:79]
    v_mfma_f32_32x32x16_bf16 v[64:79], v[60:63], v[36:39], v[64:79]
    buffer_load_dword v24, v20, s[40:43], 0 offen sc1
    s_mul_i32 s77, s93, 5
    s_lshr_b32 s77, s77, 1
    s_lshl_b32 s77, s77, 8
    s_add_u32 s77, s77, 77824
    s_nop 6
    v_mul_f32 v64, v64, v33
    v_mul_f32 v65, v65, v33
    v_mul_f32 v66, v66, v33
    v_mul_f32 v67, v67, v33
    v_exp_f32 v112, v64
    v_exp_f32 v113, v65
    v_add_u32 v7, 124928, v6
    global_load_dwordx4 v[168:171], v7, s[40:41] offset:-2048 sc1
    v_exp_f32 v114, v66
    v_exp_f32 v115, v67
    v_fma_f32 v116, v112, -0.5, -1.0
    v_fma_f32 v117, v113, -0.5, -1.0
    v_fma_f32 v118, v114, -0.5, -1.0
    v_fma_f32 v119, v115, -0.5, -1.0
    global_load_dwordx4 v[172:175], v7, s[40:41] offset:-1024 sc1
    v_fma_f32 v116, v112, v116, -1.0
    v_fma_f32 v117, v113, v117, -1.0
    v_fma_f32 v118, v114, v118, -1.0
    v_fma_f32 v119, v115, v119, -1.0
    v_rcp_f32 v116, v116
    v_rcp_f32 v117, v117
    global_load_dwordx4 v[176:179], v7, s[40:41] offset:0 sc1
    v_rcp_f32 v118, v118
    v_rcp_f32 v119, v119
    v_fma_f32 v64, v64, v116, v64
    v_fma_f32 v65, v65, v117, v65
    v_fma_f32 v66, v66, v118, v66
    v_fma_f32 v67, v67, v119, v67
    global_load_dwordx4 v[180:183], v7, s[40:41] offset:1024 sc1
    v_cvt_pk_bf16_f32 v120, v64, v65
    v_cvt_pk_bf16_f32 v121, v66, v67
    v_mul_f32 v68, v68, v33
    v_mul_f32 v69, v69, v33
    v_mul_f32 v70, v70, v33
    v_mul_f32 v71, v71, v33
    v_exp_f32 v112, v68
    global_load_dwordx4 v[184:187], v7, s[40:41] offset:2048 sc1
    v_exp_f32 v113, v69
    v_exp_f32 v114, v70
    v_exp_f32 v115, v71
    v_fma_f32 v116, v112, -0.5, -1.0
    v_fma_f32 v117, v113, -0.5, -1.0
    v_add_u32 v7, 145408, v6
    global_load_dwordx4 v[188:191], v7, s[40:41] offset:-2048 sc1
    v_fma_f32 v118, v114, -0.5, -1.0
    v_fma_f32 v119, v115, -0.5, -1.0
    v_fma_f32 v116, v112, v116, -1.0
    v_fma_f32 v117, v113, v117, -1.0
    v_fma_f32 v118, v114, v118, -1.0
    v_fma_f32 v119, v115, v119, -1.0
    v_rcp_f32 v116, v116
    global_load_dwordx4 v[192:195], v7, s[40:41] offset:-1024 sc1
    v_rcp_f32 v117, v117
    v_rcp_f32 v118, v118
    v_rcp_f32 v119, v119
    v_fma_f32 v68, v68, v116, v68
    v_fma_f32 v69, v69, v117, v69
    global_load_dwordx4 v[196:199], v7, s[40:41] offset:0 sc1
    v_fma_f32 v70, v70, v118, v70
    v_fma_f32 v71, v71, v119, v71
    v_cvt_pk_bf16_f32 v122, v68, v69
    v_cvt_pk_bf16_f32 v123, v70, v71
    buffer_store_dwordx4 v[120:123], v31, s[40:43], s85 offen offset:1024 sc1
    global_load_dwordx4 v[200:203], v7, s[40:41] offset:1024 sc1
    global_load_dwordx4 v[204:207], v7, s[40:41] offset:2048 sc1
    s_waitcnt lgkmcnt(0)
    s_waitcnt vmcnt(37)
    s_barrier
    v_mov_b32 v35, s72
    buffer_store_dword v35, v32, s[40:43], s88 offen sc1
    v_mul_f32 v72, v72, v33
    v_mul_f32 v73, v73, v33
    v_mul_f32 v74, v74, v33
    v_mul_f32 v75, v75, v33
    v_exp_f32 v112, v72
    v_exp_f32 v113, v73
    v_add_u32 v7, 165888, v6
    global_load_dwordx4 v[208:211], v7, s[40:41] offset:-2048 sc1
    v_exp_f32 v114, v74
    v_exp_f32 v115, v75
    v_fma_f32 v116, v112, -0.5, -1.0
    v_fma_f32 v117, v113, -0.5, -1.0
    v_fma_f32 v118, v114, -0.5, -1.0
    v_fma_f32 v119, v115, -0.5, -1.0
    global_load_dwordx4 v[212:215], v7, s[40:41] offset:-1024 sc1
    v_fma_f32 v116, v112, v116, -1.0
    v_fma_f32 v117, v113, v117, -1.0
    v_fma_f32 v118, v114, v118, -1.0
    v_fma_f32 v119, v115, v119, -1.0
    v_rcp_f32 v116, v116
    v_rcp_f32 v117, v117
    global_load_dwordx4 v[216:219], v7, s[40:41] offset:0 sc1
    v_rcp_f32 v118, v118
    v_rcp_f32 v119, v119
    v_fma_f32 v72, v72, v116, v72
    v_fma_f32 v73, v73, v117, v73
    v_fma_f32 v74, v74, v118, v74
    v_fma_f32 v75, v75, v119, v75
    global_load_dwordx4 v[220:223], v7, s[40:41] offset:1024 sc1
    v_cvt_pk_bf16_f32 v124, v72, v73
    v_cvt_pk_bf16_f32 v125, v74, v75
    v_mul_f32 v76, v76, v33
    v_mul_f32 v77, v77, v33
    v_mul_f32 v78, v78, v33
    v_mul_f32 v79, v79, v33
    v_exp_f32 v112, v76
    global_load_dwordx4 v[224:227], v7, s[40:41] offset:2048 sc1
    v_exp_f32 v113, v77
    v_exp_f32 v114, v78
    v_exp_f32 v115, v79
    v_fma_f32 v116, v112, -0.5, -1.0
    v_fma_f32 v117, v113, -0.5, -1.0
    v_add_u32 v7, 186368, v6
    global_load_dwordx4 v[228:231], v7, s[40:41] offset:-2048 sc1
    v_fma_f32 v118, v114, -0.5, -1.0
    v_fma_f32 v119, v115, -0.5, -1.0
    v_fma_f32 v116, v112, v116, -1.0
    v_fma_f32 v117, v113, v117, -1.0
    v_fma_f32 v118, v114, v118, -1.0
    v_fma_f32 v119, v115, v119, -1.0
    v_rcp_f32 v116, v116
    global_load_dwordx4 v[232:235], v7, s[40:41] offset:-1024 sc1
    v_rcp_f32 v117, v117
    v_rcp_f32 v118, v118
    v_rcp_f32 v119, v119
    v_fma_f32 v76, v76, v116, v76
    v_fma_f32 v77, v77, v117, v77
    global_load_dwordx4 v[236:239], v7, s[40:41] offset:0 sc1
    v_fma_f32 v78, v78, v118, v78
    v_fma_f32 v79, v79, v119, v79
    v_cvt_pk_bf16_f32 v126, v76, v77
    v_cvt_pk_bf16_f32 v127, v78, v79
    buffer_store_dwordx4 v[124:127], v31, s[40:43], s85 offen offset:1280 sc1
    global_load_dwordx4 v[240:243], v7, s[40:41] offset:1024 sc1
    global_load_dwordx4 v[244:247], v7, s[40:41] offset:2048 sc1
    s_add_u32 m0, s91, 2048
    v_add_u32 v7, 288768, v6
    global_load_lds_dwordx4 v7, s[40:41] offset:-2048 sc1
    global_load_lds_dwordx4 v7, s[40:41] offset:-1024 sc1
    global_load_lds_dwordx4 v7, s[40:41] offset:0 sc1
    global_load_lds_dwordx4 v7, s[40:41] offset:1024 sc1
    global_load_lds_dwordx4 v7, s[40:41] offset:2048 sc1
    s_add_u32 m0, s91, 7168
    v_add_u32 v7, 309248, v6
    global_load_lds_dwordx4 v7, s[40:41] offset:-2048 sc1
    global_load_lds_dwordx4 v7, s[40:41] offset:-1024 sc1
    global_load_lds_dwordx4 v7, s[40:41] offset:0 sc1
    s_waitcnt vmcnt(31)
    v_cmp_ne_u32 vcc, s72, v24
    s_nop 4
    s_cbranch_vccnz Lslow4
Lback4:
    buffer_load_dwordx4 v[8:11], v252, s[40:43], s77 offen offset:0 sc1
    global_load_lds_dwordx4 v7, s[40:41] offset:1024 sc1
    buffer_load_dwordx4 v[12:15], v252, s[40:43], s77 offen offset:256 sc1
    buffer_load_dwordx4 v[16:19], v252, s[40:43], s77 offen offset:512 sc1
    global_load_lds_dwordx4 v7, s[40:41] offset:2048 sc1
    buffer_load_dword v24, v21, s[40:43], 0 offen sc1
    ds_read_b64_tr_b16 a[0:1], v22 offset:0
    ds_read_b64_tr_b16 a[2:3], v22 offset:160
    s_add_u32 m0, s91, 12288
    v_add_u32 v7, 329728, v6
    global_load_lds_dwordx4 v7, s[40:41] offset:-2048 sc1
    ds_read_b64_tr_b16 a[4:5], v22 offset:320
    ds_read_b64_tr_b16 a[6:7], v22 offset:480
    ds_read_b64_tr_b16 a[8:9], v22 offset:640
    global_load_lds_dwordx4 v7, s[40:41] offset:-1024 sc1
    ds_read_b64_tr_b16 a[10:11], v22 offset:800
    ds_read_b64_tr_b16 a[12:13], v23 offset:0
    ds_read_b64_tr_b16 a[14:15], v23 offset:160
    global_load_lds_dwordx4 v7, s[40:41] offset:0 sc1
    ds_read_b64_tr_b16 a[16:17], v23 offset:320
    ds_read_b64_tr_b16 a[18:19], v23 offset:480
    ds_read_b64_tr_b16 a[20:21], v23 offset:640
    global_load_lds_dwordx4 v7, s[40:41] offset:1024 sc1
    ds_read_b64_tr_b16 a[22:23], v23 offset:800
    global_load_lds_dwordx4 v7, s[40:41] offset:2048 sc1
    s_waitcnt vmcnt(21)
    s_barrier
    v_mov_b32 v35, s72
    buffer_store_dword v35, v32, s[40:43], s89 offen sc1
    v_mov_b32 v31, 0x80000000
    s_mov_b32 s98, s89
    s_mov_b32 s25, s85
    s_branch Ljoin
LroleKV:
    s_mul_i32 s73, s70, 160
    s_add_u32 s73, s73, 1280
    s_mul_i32 s74, s68, 61440
    s_add_u32 s73, s73, s74
    s_mul_i32 s83, s68, 5120
    v_add_u32 v148, 0, v1
    v_mul_u32_u24 v149, 3277, v148
    v_lshrrev_b32 v149, 16, v149
    v_mul_u32_u24 v150, 20, v149
    v_sub_u32 v150, v148, v150
    v_cmp_le_u32 vcc, 10, v150
    v_lshlrev_b32 v150, 4, v150
    v_add_u32 v151, 1120, v150
    v_cndmask_b32 v150, v150, v151, vcc
    v_mul_u32_u24 v149, 3840, v149
    v_add3_u32 v18, v149, v150, s73
    s_mul_i32 s76, s68, 5120
    s_mov_b32 s91, 0x1f000
    s_add_u32 s76, s76, s91
    s_waitcnt lgkmcnt(0)
    s_mov_b32 s28, s4
    s_and_b32 s29, s5, 0xffff
    s_mov_b32 s30, 0x280000
    s_mov_b32 s31, 0x20000
    buffer_load_dwordx4 v[216:219], v130, s[28:31], 0 offen
    buffer_load_dwordx4 v[220:223], v130, s[28:31], 0 offen offset:512
    buffer_load_dwordx4 v[224:227], v132, s[28:31], 0 offen offset:1024
    s_mov_b32 s40, s24
    s_and_b32 s41, s25, 0xffff
    s_mov_b32 s42, 0x1200000
    s_mov_b32 s43, 0x20000
    buffer_load_dword v208, v208, s[40:43], 0 offen sc1
    s_cmp_lt_u32 s81, 30
    s_cselect_b32 s64, s6, s14
    s_cselect_b32 s65, s7, s15
    s_mov_b32 s66, 2211840
    s_cselect_b32 s66, 2457600, s66
    s_and_b32 s65, s65, 0xffff
    s_mov_b32 s67, 0x20000
    s_cmp_lt_u32 s97, 228
    s_cselect_b32 s66, s66, 0
    s_add_u32 m0, s76, 0
    s_nop 0
    buffer_load_dwordx4 v135, s[64:67], s79 offen lds
    s_add_u32 m0, s76, 1024
    s_add_u32 s79, s79, s82
    buffer_load_dwordx4 v135, s[64:67], s79 offen lds
    s_add_u32 m0, s76, 2048
    s_add_u32 s79, s79, s82
    buffer_load_dwordx4 v135, s[64:67], s79 offen lds
    s_add_u32 m0, s76, 3072
    s_add_u32 s79, s79, s82
    buffer_load_dwordx4 v135, s[64:67], s79 offen lds
    s_add_u32 m0, s76, 4096
    s_add_u32 s79, s79, s82
    buffer_load_dwordx4 v135, s[64:67], s79 offen lds
    s_mov_b32 s32, s6
    s_and_b32 s33, s7, 0xffff
    s_mov_b32 s34, 0x258000
    s_mov_b32 s35, 0x20000
    v_add_u32 v148, 64, v1
    v_mul_u32_u24 v149, 3277, v148
    v_lshrrev_b32 v149, 16, v149
    v_mul_u32_u24 v150, 20, v149
    v_sub_u32 v150, v148, v150
    v_cmp_le_u32 vcc, 10, v150
    v_lshlrev_b32 v150, 4, v150
    v_add_u32 v151, 1120, v150
    v_cndmask_b32 v150, v150, v151, vcc
    v_mul_u32_u24 v149, 3840, v149
    v_add3_u32 v19, v149, v150, s73
    v_subrev_u32 v19, 1024, v19
    v_add_u32 v148, 128, v1
    v_mul_u32_u24 v149, 3277, v148
    v_lshrrev_b32 v149, 16, v149
    v_mul_u32_u24 v150, 20, v149
    v_sub_u32 v150, v148, v150
    v_cmp_le_u32 vcc, 10, v150
    v_lshlrev_b32 v150, 4, v150
    v_add_u32 v151, 1120, v150
    v_cndmask_b32 v150, v150, v151, vcc
    v_mul_u32_u24 v149, 3840, v149
    v_add3_u32 v20, v149, v150, s73
    v_subrev_u32 v20, 2048, v20
    v_add_u32 v148, 192, v1
    v_mul_u32_u24 v149, 3277, v148
    v_lshrrev_b32 v149, 16, v149
    v_mul_u32_u24 v150, 20, v149
    v_sub_u32 v150, v148, v150
    v_cmp_le_u32 vcc, 10, v150
    v_lshlrev_b32 v150, 4, v150
    v_add_u32 v151, 1120, v150
    v_cndmask_b32 v150, v150, v151, vcc
    v_mul_u32_u24 v149, 3840, v149
    v_add3_u32 v21, v149, v150, s73
    v_subrev_u32 v21, 3072, v21
    v_add_u32 v148, 256, v1
    v_mul_u32_u24 v149, 3277, v148
    v_lshrrev_b32 v149, 16, v149
    v_mul_u32_u24 v150, 20, v149
    v_sub_u32 v150, v148, v150
    v_cmp_le_u32 vcc, 10, v150
    v_lshlrev_b32 v150, 4, v150
    v_add_u32 v151, 1120, v150
    v_cndmask_b32 v150, v150, v151, vcc
    v_mul_u32_u24 v149, 3840, v149
    v_add3_u32 v22, v149, v150, s73
    s_add_u32 m0, s71, 0x0
    s_mov_b32 s26, 0x0
    buffer_load_dwordx4 v2, s[28:31], s26 offen lds
    buffer_load_dwordx4 v3, s[28:31], s26 offen offset:1024 lds
    buffer_load_dwordx4 v4, s[28:31], s26 offen offset:2048 lds
    buffer_load_dwordx4 v5, s[28:31], s26 offen offset:3072 lds
    s_mov_b32 s36, s14
    s_and_b32 s37, s15, 0xffff
    s_mov_b32 s38, 0x21c000
    s_mov_b32 s39, 0x20000
    s_mov_b32 s44, s20
    s_and_b32 s45, s21, 0xffff
    s_mov_b32 s46, 0x280000
    s_mov_b32 s47, 0x20000
    s_mov_b32 s56, s16
    s_and_b32 s57, s17, 0xffff
    s_mov_b32 s58, 0xd80
    s_mov_b32 s59, 0x20000
    s_mov_b32 s60, s8
    s_and_b32 s61, s9, 0xffff
    s_mov_b32 s62, 0x6400
    s_mov_b32 s63, 0x20000
    s_lshl_b32 s73, s68, 5
    v_add_u32 v151, s73, v133
    s_add_u32 m0, s83, 0x10000
    s_mov_b32 s26, 0x0
    buffer_load_dwordx4 v18, s[32:35], s26 offen lds
    v_mul_u32_u24 v151, 3456, v151
    v_add_u32 v14, v151, v134
    v_add_u32 v15, 26624, v14
    v_add_u32 v16, 53248, v14
    v_add_u32 v17, 79872, v14
    v_and_b32 v148, 31, v1
    v_bfe_u32 v149, v1, 1, 3
    v_lshrrev_b32 v150, 5, v1
    v_xor_b32 v149, v149, v150
    v_lshlrev_b32 v151, 7, v148
    v_add_u32 v151, s71, v151
    v_xor_b32 v152, 0, v149
    v_lshl_add_u32 v6, v152, 4, v151
    v_add_u32 v10, 0x10000, v6
    v_xor_b32 v152, 2, v149
    v_lshl_add_u32 v7, v152, 4, v151
    v_add_u32 v11, 0x10000, v7
    buffer_load_dwordx4 v19, s[32:35], s26 offen offset:1024 lds
    v_xor_b32 v152, 4, v149
    v_lshl_add_u32 v8, v152, 4, v151
    v_add_u32 v12, 0x10000, v8
    v_xor_b32 v152, 6, v149
    v_lshl_add_u32 v9, v152, 4, v151
    v_add_u32 v13, 0x10000, v9
    v_bfe_u32 v152, v1, 4, 1
    v_bfe_u32 v153, v1, 1, 1
    v_lshl_add_u32 v152, v152, 1, v153
    v_and_b32 v153, 1, v1
    v_lshrrev_b32 v154, 1, v152
    v_lshl_add_u32 v154, v153, 1, v154
    v_bfe_u32 v155, v1, 3, 1
    v_lshlrev_b32 v155, 2, v155
    v_xor_b32 v154, v154, v155
    v_and_b32 v152, 1, v152
    v_lshlrev_b32 v152, 3, v152
    v_bfe_u32 v155, v1, 2, 2
    buffer_load_dwordx4 v20, s[32:35], s26 offen offset:2048 lds
    v_lshl_add_u32 v155, v150, 3, v155
    v_lshl_add_u32 v152, v155, 7, v152
    v_lshl_add_u32 v26, v154, 4, v152
    v_xor_b32 v28, 64, v26
    v_add_u32 v27, 0x10000, v26
    v_add_u32 v29, 0x10000, v28
    v_bfe_u32 v152, v1, 2, 1
    v_bfe_u32 v153, v1, 3, 2
    v_and_b32 v154, 3, v1
    v_lshl_add_u32 v154, v153, 2, v154
    v_lshl_add_u32 v154, v152, 4, v154
    v_lshlrev_b32 v154, 4, v154
    v_add_u32 v30, 0x27000, v154
    s_lshl_b32 s73, s69, 3
    s_lshl_b32 s74, s68, 1
    s_add_u32 s73, s73, s74
    v_bfe_u32 v152, v1, 4, 1
    buffer_load_dwordx4 v21, s[32:35], s26 offen offset:3072 lds
    v_add_u32 v152, s73, v152
    s_mov_b32 s73, 98304
    v_mul_lo_u32 v152, v152, s73
    v_and_b32 v153, 15, v1
    v_lshlrev_b32 v153, 4, v153
    v_lshl_add_u32 v153, v150, 9, v153
    v_add_u32 v152, v152, v153
    v_add_u32 v31, 0x500000, v152
    v_cmp_gt_u32 vcc, 32, v0
    v_mov_b32 v152, 0x80000000
    v_lshlrev_b32 v153, 2, v0
    v_cndmask_b32 v32, v152, v153, vcc
    s_lshl_b32 s1, s97, 7
    s_add_u32 s1, s1, 0x10000
    s_add_u32 s73, s70, 19
    s_lshl_b32 s82, s73, 7
    s_lshl_b32 s86, s73, 11
    s_mov_b32 s25, s86
    s_add_u32 m0, s83, 0x11000
    s_nop 0
    buffer_load_dwordx4 v22, s[32:35], s26 offen lds
    s_lshl_b32 s74, s69, 5
    s_add_u32 s74, s74, 384
    s_add_u32 s98, s74, s73
    s_lshl_b32 s98, s98, 7
    s_add_u32 s98, s98, 0x10000
    s_lshl_b32 s73, s70, 4
    s_add_u32 s73, s73, s69
    s_lshl_b32 s87, s73, 7
    s_add_u32 s87, s87, 0x34000
    v_bfe_u32 v148, v1, 2, 2
    v_lshrrev_b32 v149, 5, v1
    v_lshl_add_u32 v148, v149, 3, v148
    v_mul_u32_u24 v148, 320, v148
    v_add_u32 v148, 0x10000, v148
    v_and_b32 v149, 3, v1
    v_lshlrev_b32 v149, 3, v149
    v_bfe_u32 v150, v1, 2, 2
    s_add_u32 m0, s71, 0x4000
    s_mov_b32 s26, 0x80
    buffer_load_dwordx4 v2, s[28:31], s26 offen lds
    v_lshlrev_b32 v150, 3, v150
    v_and_b32 v151, 3, v1
    v_lshlrev_b32 v151, 4, v151
    v_add_u32 v151, 0x27000, v151
    v_and_b32 v152, 16, v1
    v_cmp_eq_u32 vcc, 0, v152
    v_mov_b32 v152, 0x8040703
    v_mov_b32 v153, 0x6020501
    v_cndmask_b32 v152, v152, v153, vcc
    v_bfe_u32 v153, v152, v149, 8
    v_lshl_add_u32 v64, v153, 3, v148
    v_add_u32 v69, 40960, v64
    v_bfe_u32 v153, v152, v150, 8
    v_lshl_add_u32 v74, v153, 6, v151
    v_mov_b32 v152, 0x130e120d
    v_mov_b32 v153, 0xf0c0900
    v_cndmask_b32 v152, v152, v153, vcc
    v_bfe_u32 v153, v152, v149, 8
    v_lshl_add_u32 v65, v153, 3, v148
    v_add_u32 v70, 40960, v65
    v_bfe_u32 v153, v152, v150, 8
    v_lshl_add_u32 v75, v153, 6, v151
    v_mov_b32 v152, 0x1d171c16
    v_mov_b32 v153, 0x110b100a
    v_cndmask_b32 v152, v152, v153, vcc
    v_bfe_u32 v153, v152, v149, 8
    v_lshl_add_u32 v66, v153, 3, v148
    v_add_u32 v71, 40960, v66
    v_bfe_u32 v153, v152, v150, 8
    v_lshl_add_u32 v76, v153, 6, v151
    v_mov_b32 v152, 0x27142622
    v_mov_b32 v153, 0x25211b18
    v_cndmask_b32 v152, v152, v153, vcc
    v_bfe_u32 v153, v152, v149, 8
    v_lshl_add_u32 v67, v153, 3, v148
    v_add_u32 v72, 40960, v67
    v_bfe_u32 v153, v152, v150, 8
    v_lshl_add_u32 v77, v153, 6, v151
    v_mov_b32 v152, 0x241f231e
    v_mov_b32 v153, 0x1a201915
    v_cndmask_b32 v152, v152, v153, vcc
    buffer_load_dwordx4 v3, s[28:31], s26 offen offset:1024 lds
    buffer_load_dwordx4 v4, s[28:31], s26 offen offset:2048 lds
    v_bfe_u32 v153, v152, v149, 8
    v_lshl_add_u32 v68, v153, 3, v148
    v_add_u32 v73, 40960, v68
    v_bfe_u32 v153, v152, v150, 8
    v_lshl_add_u32 v78, v153, 6, v151
    buffer_load_dwordx4 v5, s[28:31], s26 offen offset:3072 lds
    s_add_u32 m0, s83, 0x15000
    s_mov_b32 s26, 0x3c000
    buffer_load_dwordx4 v18, s[32:35], s26 offen lds
    buffer_load_dwordx4 v19, s[32:35], s26 offen offset:1024 lds
    buffer_load_dwordx4 v20, s[32:35], s26 offen offset:2048 lds
    buffer_load_dwordx4 v21, s[32:35], s26 offen offset:3072 lds
    s_add_u32 m0, s83, 0x16000
    s_nop 0
    buffer_load_dwordx4 v22, s[32:35], s26 offen lds
    s_waitcnt vmcnt(14)
    ds_read_b128 a[0:3], v6 offset:0
    ds_read_b128 a[4:7], v7 offset:0
    ds_read_b128 a[8:11], v8 offset:0
    ds_read_b128 a[12:15], v9 offset:0
    s_waitcnt vmcnt(9)
    s_barrier
    ds_read_b64_tr_b16 v[40:41], v64 offset:0
    ds_read_b64_tr_b16 v[42:43], v64 offset:1280
    ds_read_b64_tr_b16 v[44:45], v65 offset:0
    ds_read_b64_tr_b16 v[46:47], v65 offset:1280
    ds_read_b64_tr_b16 v[48:49], v66 offset:0
    ds_read_b64_tr_b16 v[50:51], v66 offset:1280
    ds_read_b64_tr_b16 v[52:53], v67 offset:0
    ds_read_b64_tr_b16 v[54:55], v67 offset:1280
    s_waitcnt lgkmcnt(4)
    v_mfma_f32_32x32x16_bf16 v[128:143], v[40:43], a[0:3], 0
    ds_read_b64_tr_b16 v[56:57], v68 offset:0
    ds_read_b64_tr_b16 v[58:59], v68 offset:1280
    s_add_u32 m0, s71, 0x8000
    s_mov_b32 s26, 0x100
    buffer_load_dwordx4 v2, s[28:31], s26 offen lds
    s_and_b32 s73, s68, 1
    s_lshr_b32 s74, s68, 1
    s_mul_i32 s75, s74, 10240
    s_add_u32 s75, s75, s91
    s_lshl_b32 s76, s73, 2
    v_bfe_u32 v232, v1, 4, 1
    v_bfe_u32 v233, v1, 1, 1
    v_mfma_f32_32x32x16_bf16 v[144:159], v[44:47], a[0:3], 0
    ds_read_b64_tr_b16 v[60:61], v64 offset:5120
    ds_read_b64_tr_b16 v[62:63], v64 offset:6400
    buffer_load_dwordx4 v3, s[28:31], s26 offen offset:1024 lds
    v_lshl_add_u32 v232, v232, 1, v233
    v_bfe_u32 v233, v1, 3, 1
    v_lshlrev_b32 v233, 2, v233
    v_xor_b32 v232, v232, v233
    v_xor_b32 v232, s76, v232
    v_and_b32 v233, 1, v1
    v_lshlrev_b32 v233, 3, v233
    v_lshl_add_u32 v232, v232, 4, v233
    s_waitcnt lgkmcnt(4)
    v_mfma_f32_32x32x16_bf16 v[160:175], v[48:51], a[0:3], 0
    ds_read_b64_tr_b16 v[40:41], v65 offset:5120
    ds_read_b64_tr_b16 v[42:43], v65 offset:6400
    v_bfe_u32 v233, v1, 2, 2
    v_lshrrev_b32 v234, 5, v1
    v_lshl_add_u32 v233, v234, 3, v233
    v_lshl_add_u32 v232, v233, 7, v232
    v_add_u32 v232, s75, v232
    ds_read_b64_tr_b16 v[80:81], v232 offset:0
    v_mfma_f32_32x32x16_bf16 v[176:191], v[52:55], a[0:3], 0
    ds_read_b64_tr_b16 v[44:45], v66 offset:5120
    ds_read_b64_tr_b16 v[46:47], v66 offset:6400
    buffer_load_dwordx4 v4, s[28:31], s26 offen offset:2048 lds
    ds_read_b64_tr_b16 v[82:83], v232 offset:512
    ds_read_b64_tr_b16 v[84:85], v232 offset:2048
    ds_read_b64_tr_b16 v[86:87], v232 offset:2560
    ds_read_b64_tr_b16 v[88:89], v232 offset:4096
    ds_read_b64_tr_b16 v[90:91], v232 offset:4608
    ds_read_b64_tr_b16 v[92:93], v232 offset:6144
    s_waitcnt lgkmcnt(11)
    v_mfma_f32_32x32x16_bf16 v[192:207], v[56:59], a[0:3], 0
    ds_read_b64_tr_b16 v[48:49], v67 offset:5120
    ds_read_b64_tr_b16 v[50:51], v67 offset:6400
    ds_read_b64_tr_b16 v[94:95], v232 offset:6656
    ds_read_b64_tr_b16 v[96:97], v232 offset:8192
    ds_read_b64_tr_b16 v[98:99], v232 offset:8704
    v_mov_b32 v236, s92
    v_mov_b32 v237, s92
    v_mov_b32 v238, s92
    v_mfma_f32_32x32x16_bf16 v[128:143], v[60:63], a[4:7], v[128:143]
    ds_read_b64_tr_b16 v[52:53], v68 offset:5120
    ds_read_b64_tr_b16 v[54:55], v68 offset:6400
    buffer_load_dwordx4 v5, s[28:31], s26 offen offset:3072 lds
    v_mov_b32 v239, s92
    s_and_b32 s75, s97, 3
    s_lshl_b32 s75, s75, 1
    s_add_u32 s75, s75, s74
    s_lshl_b32 s75, s75, 14
    s_lshr_b32 s76, s97, 2
    s_lshl_b32 s76, s76, 8
    s_waitcnt lgkmcnt(13)
    v_mfma_f32_32x32x16_bf16 v[144:159], v[40:43], a[4:7], v[144:159]
    ds_read_b64_tr_b16 v[56:57], v64 offset:10240
    ds_read_b64_tr_b16 v[58:59], v64 offset:11520
    s_add_u32 s75, s75, s76
    s_lshl_b32 s73, s73, 7
    s_add_u32 s75, s75, s73
    s_add_u32 s75, s75, 0x60000
    s_cmp_lt_u32 s97, 228
    s_cselect_b32 s76, 32, 0
    s_add_u32 m0, s83, 0x1a000
    s_mov_b32 s26, 0x78000
    v_mfma_f32_32x32x16_bf16 v[160:175], v[44:47], a[4:7], v[160:175]
    ds_read_b64_tr_b16 v[60:61], v65 offset:10240
    ds_read_b64_tr_b16 v[62:63], v65 offset:11520
    buffer_load_dwordx4 v18, s[32:35], s26 offen lds
    v_cmp_gt_u32 vcc, s76, v1
    v_lshlrev_b32 v233, 2, v1
    v_mov_b32 v234, 0x80000000
    v_cndmask_b32 v233, v234, v233, vcc
    s_waitcnt lgkmcnt(15)
    v_mfma_f32_32x32x16_bf16 v[240:255], v[236:239], v[80:83], 0
    s_waitcnt lgkmcnt(14)
    v_mfma_f32_32x32x16_bf16 v[240:255], v[236:239], v[84:87], v[240:255]
    s_waitcnt lgkmcnt(4)
    v_mfma_f32_32x32x16_bf16 v[176:191], v[48:51], a[4:7], v[176:191]
    ds_read_b64_tr_b16 v[40:41], v66 offset:10240
    ds_read_b64_tr_b16 v[42:43], v66 offset:11520
    buffer_load_dwordx4 v19, s[32:35], s26 offen offset:1024 lds
    v_mfma_f32_32x32x16_bf16 v[240:255], v[236:239], v[88:91], v[240:255]
    v_mfma_f32_32x32x16_bf16 v[240:255], v[236:239], v[92:95], v[240:255]
    v_mfma_f32_32x32x16_bf16 v[240:255], v[236:239], v[96:99], v[240:255]
    v_mfma_f32_32x32x16_bf16 v[192:207], v[52:55], a[4:7], v[192:207]
    ds_read_b64_tr_b16 v[44:45], v67 offset:10240
    ds_read_b64_tr_b16 v[46:47], v67 offset:11520
    s_nop 8
    buffer_store_dword v240, v233, s[40:43], s75 offen sc1
    v_mov_b32 v228, 0
    v_mov_b32 v229, 0
    v_dot2_f32_bf16 v228, v216, s92, v228
    v_dot2_f32_bf16 v229, v216, v216, v229
    v_dot2_f32_bf16 v228, v217, s92, v228
    v_dot2_f32_bf16 v229, v217, v217, v229
    s_waitcnt lgkmcnt(4)
    v_mfma_f32_32x32x16_bf16 v[128:143], v[56:59], a[8:11], v[128:143]
    ds_read_b64_tr_b16 v[48:49], v68 offset:10240
    ds_read_b64_tr_b16 v[50:51], v68 offset:11520
    buffer_load_dwordx4 v20, s[32:35], s26 offen offset:2048 lds
    v_dot2_f32_bf16 v228, v218, s92, v228
    v_dot2_f32_bf16 v229, v218, v218, v229
    v_dot2_f32_bf16 v228, v219, s92, v228
    v_dot2_f32_bf16 v229, v219, v219, v229
    v_dot2_f32_bf16 v228, v220, s92, v228
    v_dot2_f32_bf16 v229, v220, v220, v229
    v_mfma_f32_32x32x16_bf16 v[144:159], v[60:63], a[8:11], v[144:159]
    ds_read_b64_tr_b16 v[52:53], v64 offset:15360
    ds_read_b64_tr_b16 v[54:55], v64 offset:16640
    v_dot2_f32_bf16 v228, v221, s92, v228
    v_dot2_f32_bf16 v229, v221, v221, v229
    v_dot2_f32_bf16 v228, v222, s92, v228
    v_dot2_f32_bf16 v229, v222, v222, v229
    v_dot2_f32_bf16 v228, v223, s92, v228
    s_waitcnt lgkmcnt(4)
    v_mfma_f32_32x32x16_bf16 v[160:175], v[40:43], a[8:11], v[160:175]
    ds_read_b64_tr_b16 v[56:57], v65 offset:15360
    ds_read_b64_tr_b16 v[58:59], v65 offset:16640
    buffer_load_dwordx4 v21, s[32:35], s26 offen offset:3072 lds
    v_dot2_f32_bf16 v229, v223, v223, v229
    v_dot2_f32_bf16 v228, v224, s92, v228
    v_dot2_f32_bf16 v229, v224, v224, v229
    v_dot2_f32_bf16 v228, v225, s92, v228
    v_dot2_f32_bf16 v229, v225, v225, v229
    v_dot2_f32_bf16 v228, v226, s92, v228
    v_mfma_f32_32x32x16_bf16 v[176:191], v[44:47], a[8:11], v[176:191]
    ds_read_b64_tr_b16 v[60:61], v66 offset:15360
    ds_read_b64_tr_b16 v[62:63], v66 offset:16640
    v_dot2_f32_bf16 v229, v226, v226, v229
    v_dot2_f32_bf16 v228, v227, s92, v228
    v_dot2_f32_bf16 v229, v227, v227, v229
    v_readfirstlane_b32 s72, v208
    s_nop 3
    s_add_u32 s72, s72, 0x9e3779b1
    v_add_f32_dpp v228, v228, v228 quad_perm:[1,0,3,2] row_mask:0xf bank_mask:0xf
    s_add_u32 m0, s83, 0x1b000
    s_waitcnt lgkmcnt(4)
    v_mfma_f32_32x32x16_bf16 v[192:207], v[48:51], a[8:11], v[192:207]
    ds_read_b64_tr_b16 v[40:41], v67 offset:15360
    ds_read_b64_tr_b16 v[42:43], v67 offset:16640
    buffer_load_dwordx4 v22, s[32:35], s26 offen lds
    v_add_f32_dpp v229, v229, v229 quad_perm:[1,0,3,2] row_mask:0xf bank_mask:0xf
    v_add_f32_dpp v228, v228, v228 quad_perm:[2,3,0,1] row_mask:0xf bank_mask:0xf
    s_nop 0
    v_add_f32_dpp v229, v229, v229 quad_perm:[2,3,0,1] row_mask:0xf bank_mask:0xf
    v_add_f32_dpp v228, v228, v228 row_half_mirror row_mask:0xf bank_mask:0xf
    s_nop 0
    v_add_f32_dpp v229, v229, v229 row_half_mirror row_mask:0xf bank_mask:0xf
    v_add_f32_dpp v228, v228, v228 row_mirror row_mask:0xf bank_mask:0xf
    v_mfma_f32_32x32x16_bf16 v[128:143], v[52:55], a[12:15], v[128:143]
    ds_read_b64_tr_b16 v[44:45], v68 offset:15360
    ds_read_b64_tr_b16 v[46:47], v68 offset:16640
    v_add_f32_dpp v229, v229, v229 row_mirror row_mask:0xf bank_mask:0xf
    v_mov_b32 v230, v228
    v_mov_b32 v231, v229
    s_nop 0
    v_permlane16_swap_b32 v228, v230
    v_permlane16_swap_b32 v229, v231
    s_waitcnt lgkmcnt(4)
    v_mfma_f32_32x32x16_bf16 v[144:159], v[56:59], a[12:15], v[144:159]
    s_waitcnt vmcnt(15)
    s_waitcnt lgkmcnt(0)
    ds_read_b128 a[16:19], v6 offset:16384
    ds_read_b128 a[20:23], v7 offset:16384
    ds_read_b128 a[24:27], v8 offset:16384
    ds_read_b128 a[28:31], v9 offset:16384
    s_waitcnt vmcnt(10)
    s_barrier
    ds_read_b64_tr_b16 v[48:49], v64 offset:20480
    ds_read_b64_tr_b16 v[50:51], v64 offset:21760
    s_add_u32 m0, s71, 0xc000
    s_mov_b32 s26, 0x180
    v_add_f32 v228, v228, v230
    v_add_f32 v229, v229, v231
    v_mul_f32 v228, 0xbacccccd, v228
    v_mul_f32 v229, 0x3acccccd, v229
    v_fma_f32 v229, -v228, v228, v229
    v_max_f32 v229, 0, v229
    v_mfma_f32_32x32x16_bf16 v[160:175], v[60:63], a[12:15], v[160:175]
    ds_read_b64_tr_b16 v[52:53], v65 offset:20480
    ds_read_b64_tr_b16 v[54:55], v65 offset:21760
    buffer_load_dwordx4 v2, s[28:31], s26 offen lds
    v_add_f32 v229, 0x3727c5ac, v229
    v_rsq_f32 v221, v229
    v_cvt_pk_bf16_f32 v216, v228, v228
    v_mul_f32 v229, v229, v221
    v_lshlrev_b32 v230, 16, v216
    v_mfma_f32_32x32x16_bf16 v[176:191], v[40:43], a[12:15], v[176:191]
    ds_read_b64_tr_b16 v[56:57], v66 offset:20480
    ds_read_b64_tr_b16 v[58:59], v66 offset:21760
    buffer_load_dwordx4 v3, s[28:31], s26 offen offset:1024 lds
    v_sub_f32 v230, v228, v230
    v_cvt_pk_bf16_f32 v217, v230, v229
    v_and_b32 v231, 0xffff0000, v217
    v_sub_f32 v231, v229, v231
    v_cvt_pk_bf16_f32 v218, v231, 0
    v_mov_b32 v219, 0
    v_mfma_f32_32x32x16_bf16 v[192:207], v[44:47], a[12:15], v[192:207]
    ds_read_b64_tr_b16 v[60:61], v67 offset:20480
    ds_read_b64_tr_b16 v[62:63], v67 offset:21760
    v_mul_f32 v220, 0x3fb8aa3b, v221
    v_mov_b32 v222, 0
    v_mov_b32 v223, 0
    v_and_b32 v230, 1, v211
    s_waitcnt lgkmcnt(4)
    v_mfma_f32_32x32x16_bf16 v[128:143], v[48:51], a[16:19], v[128:143]
    ds_read_b64_tr_b16 v[40:41], v68 offset:20480
    ds_read_b64_tr_b16 v[42:43], v68 offset:21760
    buffer_load_dwordx4 v4, s[28:31], s26 offen offset:2048 lds
    v_cmp_eq_u32 vcc, 1, v230
    v_lshlrev_b32 v209, 6, v209
    v_lshl_add_u32 v209, v211, 4, v209
    v_cndmask_b32 v216, v216, v220, vcc
    v_cndmask_b32 v217, v217, v221, vcc
    v_cndmask_b32 v218, v218, v222, vcc
    v_cndmask_b32 v219, v219, v223, vcc
    v_mfma_f32_32x32x16_bf16 v[144:159], v[52:55], a[16:19], v[144:159]
    ds_read_b64_tr_b16 v[44:45], v64 offset:25600
    ds_read_b64_tr_b16 v[46:47], v64 offset:26880
    v_cmp_gt_u32 vcc, 4, v211
    v_add_u32 v209, 0x40000, v209
    v_mov_b32 v230, 0x80000000
    v_cndmask_b32 v209, v230, v209, vcc
    buffer_store_dwordx4 v[216:219], v209, s[40:43], 0 offen sc1
    s_waitcnt lgkmcnt(4)
    v_mfma_f32_32x32x16_bf16 v[160:175], v[56:59], a[16:19], v[160:175]
    ds_read_b64_tr_b16 v[48:49], v65 offset:25600
    ds_read_b64_tr_b16 v[50:51], v65 offset:26880
    buffer_load_dwordx4 v5, s[28:31], s26 offen offset:3072 lds
    v_mfma_f32_32x32x16_bf16 v[176:191], v[60:63], a[16:19], v[176:191]
    ds_read_b64_tr_b16 v[52:53], v66 offset:25600
    ds_read_b64_tr_b16 v[54:55], v66 offset:26880
    s_add_u32 m0, s83, 0x1f000
    s_mov_b32 s26, 0xb4000
    s_waitcnt lgkmcnt(4)
    v_mfma_f32_32x32x16_bf16 v[192:207], v[40:43], a[16:19], v[192:207]
    ds_read_b64_tr_b16 v[56:57], v67 offset:25600
    ds_read_b64_tr_b16 v[58:59], v67 offset:26880
    buffer_load_dwordx4 v18, s[32:35], s26 offen lds
    s_mul_i32 s73, s70, 80
    s_lshr_b32 s74, s73, 6
    v_mfma_f32_32x32x16_bf16 v[128:143], v[44:47], a[20:23], v[128:143]
    ds_read_b64_tr_b16 v[60:61], v68 offset:25600
    ds_read_b64_tr_b16 v[62:63], v68 offset:26880
    s_add_u32 s74, s74, 10
    s_add_u32 s75, s70, 49
    s_waitcnt lgkmcnt(4)
    v_mfma_f32_32x32x16_bf16 v[144:159], v[48:51], a[20:23], v[144:159]
    ds_read_b64_tr_b16 v[40:41], v64 offset:30720
    ds_read_b64_tr_b16 v[42:43], v64 offset:32000
    buffer_load_dwordx4 v19, s[32:35], s26 offen offset:1024 lds
    v_subrev_u32 v112, 4, v1
    v_bfe_u32 v113, v112, 2, 1
    v_mfma_f32_32x32x16_bf16 v[160:175], v[52:55], a[20:23], v[160:175]
    ds_read_b64_tr_b16 v[44:45], v65 offset:30720
    ds_read_b64_tr_b16 v[46:47], v65 offset:32000
    v_bfe_u32 v114, v112, 3, 1
    v_mul_u32_u24 v114, 10, v114
    s_waitcnt lgkmcnt(4)
    v_mfma_f32_32x32x16_bf16 v[176:191], v[56:59], a[20:23], v[176:191]
    ds_read_b64_tr_b16 v[48:49], v66 offset:30720
    ds_read_b64_tr_b16 v[50:51], v66 offset:32000
    buffer_load_dwordx4 v20, s[32:35], s26 offen offset:2048 lds
    v_add3_u32 v113, v113, v114, s74
    v_cmp_gt_u32 vcc, 16, v112
    v_mov_b32 v114, s75
    s_nop 0
    v_cndmask_b32 v112, v114, v113, vcc
    v_mfma_f32_32x32x16_bf16 v[192:207], v[60:63], a[20:23], v[192:207]
    ds_read_b64_tr_b16 v[52:53], v67 offset:30720
    ds_read_b64_tr_b16 v[54:55], v67 offset:32000
    s_add_u32 s73, s73, 640
    s_waitcnt lgkmcnt(4)
    v_mfma_f32_32x32x16_bf16 v[128:143], v[40:43], a[24:27], v[128:143]
    ds_read_b64_tr_b16 v[56:57], v68 offset:30720
    ds_read_b64_tr_b16 v[58:59], v68 offset:32000
    v_min_u32 v113, 159, v0
    v_mfma_f32_32x32x16_bf16 v[144:159], v[44:47], a[24:27], v[144:159]
    ds_read_b64_tr_b16 v[60:61], v64 offset:35840
    ds_read_b64_tr_b16 v[62:63], v64 offset:37120
    buffer_load_dwordx4 v21, s[32:35], s26 offen offset:3072 lds
    v_cmp_le_u32 vcc, 80, v113
    v_add_u32 v113, s73, v113
    v_add_u32 v115, 560, v113
    v_cndmask_b32 v113, v113, v115, vcc
    s_waitcnt lgkmcnt(4)
    v_mfma_f32_32x32x16_bf16 v[160:175], v[48:51], a[24:27], v[160:175]
    ds_read_b64_tr_b16 v[40:41], v65 offset:35840
    ds_read_b64_tr_b16 v[42:43], v65 offset:37120
    s_lshl_b32 s75, s75, 6
    s_add_u32 m0, s83, 0x20000
    v_mfma_f32_32x32x16_bf16 v[176:191], v[52:55], a[24:27], v[176:191]
    ds_read_b64_tr_b16 v[44:45], v66 offset:35840
    ds_read_b64_tr_b16 v[46:47], v66 offset:37120
    buffer_load_dwordx4 v22, s[32:35], s26 offen lds
    v_add_u32 v115, s75, v1
    s_waitcnt lgkmcnt(4)
    v_mfma_f32_32x32x16_bf16 v[192:207], v[56:59], a[24:27], v[192:207]
    ds_read_b64_tr_b16 v[48:49], v67 offset:35840
    ds_read_b64_tr_b16 v[50:51], v67 offset:37120
    v_cmp_le_u32 vcc, 192, v0
    s_nop 1
    v_cndmask_b32 v114, v113, v115, vcc
    v_mfma_f32_32x32x16_bf16 v[128:143], v[60:63], a[28:31], v[128:143]
    ds_read_b64_tr_b16 v[52:53], v68 offset:35840
    ds_read_b64_tr_b16 v[54:55], v68 offset:37120
    v_and_b32 v113, 3, v1
    v_lshl_add_u32 v112, v112, 2, v113
    s_waitcnt lgkmcnt(4)
    v_mfma_f32_32x32x16_bf16 v[144:159], v[40:43], a[28:31], v[144:159]
    s_waitcnt vmcnt(16)
    s_waitcnt lgkmcnt(0)
    ds_read_b128 a[32:35], v6 offset:32768
    ds_read_b128 a[36:39], v7 offset:32768
    ds_read_b128 a[40:43], v8 offset:32768
    ds_read_b128 a[44:47], v9 offset:32768
    s_waitcnt vmcnt(6)
    s_barrier
    v_mov_b32 v35, s72
    buffer_store_dword v35, v32, s[40:43], s1 offen sc1
    ds_read_b64_tr_b16 v[56:57], v69 offset:0
    ds_read_b64_tr_b16 v[58:59], v69 offset:1280
    s_add_u32 m0, s71, 0x0
    s_mov_b32 s26, 0x200
    buffer_load_dwordx4 v2, s[28:31], s26 offen lds
    s_lshl_b32 s73, s69, 4
    s_lshl_b32 s74, s68, 2
    s_add_u32 s73, s73, s74
    v_mfma_f32_32x32x16_bf16 v[160:175], v[44:47], a[28:31], v[160:175]
    ds_read_b64_tr_b16 v[60:61], v70 offset:0
    ds_read_b64_tr_b16 v[62:63], v70 offset:1280
    buffer_load_dwordx4 v3, s[28:31], s26 offen offset:1024 lds
    v_add_u32 v113, s73, v113
    v_mfma_f32_32x32x16_bf16 v[176:191], v[48:51], a[28:31], v[176:191]
    ds_read_b64_tr_b16 v[40:41], v71 offset:0
    ds_read_b64_tr_b16 v[42:43], v71 offset:1280
    v_cmp_gt_u32 vcc, 4, v1
    s_nop 1
    v_cndmask_b32 v112, v112, v113, vcc
    v_mfma_f32_32x32x16_bf16 v[192:207], v[52:55], a[28:31], v[192:207]
    ds_read_b64_tr_b16 v[44:45], v72 offset:0
    ds_read_b64_tr_b16 v[46:47], v72 offset:1280
    buffer_load_dwordx4 v4, s[28:31], s26 offen offset:2048 lds
    v_lshlrev_b32 v112, 7, v112
    v_add_u32 v125, 0x10000, v112
    s_waitcnt lgkmcnt(4)
    v_mfma_f32_32x32x16_bf16 v[128:143], v[56:59], a[32:35], v[128:143]
    ds_read_b64_tr_b16 v[48:49], v73 offset:0
    ds_read_b64_tr_b16 v[50:51], v73 offset:1280
    v_mfma_f32_32x32x16_bf16 v[144:159], v[60:63], a[32:35], v[144:159]
    ds_read_b64_tr_b16 v[52:53], v69 offset:5120
    ds_read_b64_tr_b16 v[54:55], v69 offset:6400
    buffer_load_dwordx4 v5, s[28:31], s26 offen offset:3072 lds
    s_waitcnt lgkmcnt(4)
    v_mfma_f32_32x32x16_bf16 v[160:175], v[40:43], a[32:35], v[160:175]
    ds_read_b64_tr_b16 v[56:57], v70 offset:5120
    ds_read_b64_tr_b16 v[58:59], v70 offset:6400
    v_lshlrev_b32 v106, 4, v0
    s_add_u32 m0, s83, 0x10000
    s_mov_b32 s26, 0xf0000
    v_mfma_f32_32x32x16_bf16 v[176:191], v[44:47], a[32:35], v[176:191]
    ds_read_b64_tr_b16 v[60:61], v71 offset:5120
    ds_read_b64_tr_b16 v[62:63], v71 offset:6400
    buffer_load_dwordx4 v18, s[32:35], s26 offen lds
    s_lshl_b32 s74, s68, 10
    s_waitcnt lgkmcnt(4)
    v_mfma_f32_32x32x16_bf16 v[192:207], v[48:51], a[32:35], v[192:207]
    ds_read_b64_tr_b16 v[40:41], v72 offset:5120
    ds_read_b64_tr_b16 v[42:43], v72 offset:6400
    buffer_load_dwordx4 v19, s[32:35], s26 offen offset:1024 lds
    v_mfma_f32_32x32x16_bf16 v[128:143], v[52:55], a[36:39], v[128:143]
    ds_read_b64_tr_b16 v[44:45], v73 offset:5120
    ds_read_b64_tr_b16 v[46:47], v73 offset:6400
    v_subrev_u32 v107, 10, v1
    s_waitcnt lgkmcnt(4)
    v_mfma_f32_32x32x16_bf16 v[144:159], v[56:59], a[36:39], v[144:159]
    ds_read_b64_tr_b16 v[48:49], v69 offset:10240
    ds_read_b64_tr_b16 v[50:51], v69 offset:11520
    buffer_load_dwordx4 v20, s[32:35], s26 offen offset:2048 lds
    v_mfma_f32_32x32x16_bf16 v[160:175], v[60:63], a[36:39], v[160:175]
    ds_read_b64_tr_b16 v[52:53], v70 offset:10240
    ds_read_b64_tr_b16 v[54:55], v70 offset:11520
    s_waitcnt lgkmcnt(4)
    v_mfma_f32_32x32x16_bf16 v[176:191], v[40:43], a[36:39], v[176:191]
    ds_read_b64_tr_b16 v[56:57], v71 offset:10240
    ds_read_b64_tr_b16 v[58:59], v71 offset:11520
    buffer_load_dwordx4 v21, s[32:35], s26 offen offset:3072 lds
    v_cmp_gt_u32 vcc, 50, v107
    v_lshlrev_b32 v107, 4, v107
    v_mov_b32 v108, 0x80000000
    v_cndmask_b32 v107, v108, v107, vcc
    v_mfma_f32_32x32x16_bf16 v[192:207], v[44:47], a[36:39], v[192:207]
    ds_read_b64_tr_b16 v[60:61], v72 offset:10240
    ds_read_b64_tr_b16 v[62:63], v72 offset:11520
    s_add_u32 m0, s83, 0x11000
    s_waitcnt lgkmcnt(4)
    v_mfma_f32_32x32x16_bf16 v[128:143], v[48:51], a[40:43], v[128:143]
    ds_read_b64_tr_b16 v[40:41], v73 offset:10240
    ds_read_b64_tr_b16 v[42:43], v73 offset:11520
    buffer_load_dwordx4 v22, s[32:35], s26 offen lds
    v_mfma_f32_32x32x16_bf16 v[144:159], v[52:55], a[40:43], v[144:159]
    ds_read_b64_tr_b16 v[44:45], v69 offset:15360
    ds_read_b64_tr_b16 v[46:47], v69 offset:16640
    s_add_u32 m0, s74, 0x25000
    s_mul_i32 s26, s70, 3200
    s_waitcnt lgkmcnt(4)
    v_mfma_f32_32x32x16_bf16 v[160:175], v[56:59], a[40:43], v[160:175]
    ds_read_b64_tr_b16 v[48:49], v70 offset:15360
    ds_read_b64_tr_b16 v[50:51], v70 offset:16640
    buffer_load_dwordx4 v106, s[60:63], s26 offen lds
    s_mov_b32 m0, 0x26000
    s_mul_i32 s26, s93, 800
    buffer_load_dwordx4 v107, s[60:63], s26 offen lds
    s_mov_b32 m0, 0x26400
    v_mfma_f32_32x32x16_bf16 v[176:191], v[60:63], a[40:43], v[176:191]
    ds_read_b64_tr_b16 v[52:53], v71 offset:15360
    ds_read_b64_tr_b16 v[54:55], v71 offset:16640
    buffer_load_dwordx4 v108, s[60:63], 0 offen lds
    s_waitcnt lgkmcnt(4)
    v_mfma_f32_32x32x16_bf16 v[192:207], v[40:43], a[40:43], v[192:207]
    ds_read_b64_tr_b16 v[56:57], v72 offset:15360
    ds_read_b64_tr_b16 v[58:59], v72 offset:16640
    buffer_load_dwordx4 v108, s[60:63], 0 offen offset:1024 lds
    v_mfma_f32_32x32x16_bf16 v[128:143], v[44:47], a[44:47], v[128:143]
    ds_read_b64_tr_b16 v[60:61], v73 offset:15360
    ds_read_b64_tr_b16 v[62:63], v73 offset:16640
    buffer_load_dwordx4 v108, s[60:63], 0 offen offset:2048 lds
    s_waitcnt lgkmcnt(4)
    v_mfma_f32_32x32x16_bf16 v[144:159], v[48:51], a[44:47], v[144:159]
    s_waitcnt vmcnt(20)
    s_waitcnt lgkmcnt(0)
    ds_read_b128 a[48:51], v6 offset:49152
    ds_read_b128 a[52:55], v7 offset:49152
    ds_read_b128 a[56:59], v8 offset:49152
    ds_read_b128 a[60:63], v9 offset:49152
    s_waitcnt vmcnt(15)
    s_barrier
    ds_read_b64_tr_b16 v[40:41], v69 offset:20480
    ds_read_b64_tr_b16 v[42:43], v69 offset:21760
    s_add_u32 m0, s71, 0x4000
    s_mov_b32 s26, 0x280
    v_mfma_f32_32x32x16_bf16 v[160:175], v[52:55], a[44:47], v[160:175]
    ds_read_b64_tr_b16 v[44:45], v70 offset:20480
    ds_read_b64_tr_b16 v[46:47], v70 offset:21760
    buffer_load_dwordx4 v2, s[28:31], s26 offen lds
    v_mfma_f32_32x32x16_bf16 v[176:191], v[56:59], a[44:47], v[176:191]
    ds_read_b64_tr_b16 v[48:49], v71 offset:20480
    ds_read_b64_tr_b16 v[50:51], v71 offset:21760
    buffer_load_dwordx4 v3, s[28:31], s26 offen offset:1024 lds
    v_mfma_f32_32x32x16_bf16 v[192:207], v[60:63], a[44:47], v[192:207]
    ds_read_b64_tr_b16 v[52:53], v72 offset:20480
    ds_read_b64_tr_b16 v[54:55], v72 offset:21760
    s_waitcnt lgkmcnt(4)
    v_mfma_f32_32x32x16_bf16 v[128:143], v[40:43], a[48:51], v[128:143]
    ds_read_b64_tr_b16 v[56:57], v73 offset:20480
    ds_read_b64_tr_b16 v[58:59], v73 offset:21760
    buffer_load_dwordx4 v4, s[28:31], s26 offen offset:2048 lds
    v_mfma_f32_32x32x16_bf16 v[144:159], v[44:47], a[48:51], v[144:159]
    ds_read_b64_tr_b16 v[60:61], v69 offset:25600
    ds_read_b64_tr_b16 v[62:63], v69 offset:26880
    s_waitcnt lgkmcnt(4)
    v_mfma_f32_32x32x16_bf16 v[160:175], v[48:51], a[48:51], v[160:175]
    ds_read_b64_tr_b16 v[40:41], v70 offset:25600
    ds_read_b64_tr_b16 v[42:43], v70 offset:26880
    buffer_load_dwordx4 v5, s[28:31], s26 offen offset:3072 lds
    v_mfma_f32_32x32x16_bf16 v[176:191], v[52:55], a[48:51], v[176:191]
    ds_read_b64_tr_b16 v[44:45], v71 offset:25600
    ds_read_b64_tr_b16 v[46:47], v71 offset:26880
    s_add_u32 m0, s83, 0x15000
    s_mov_b32 s26, 0x12c000
    s_waitcnt lgkmcnt(4)
    v_mfma_f32_32x32x16_bf16 v[192:207], v[56:59], a[48:51], v[192:207]
    ds_read_b64_tr_b16 v[48:49], v72 offset:25600
    ds_read_b64_tr_b16 v[50:51], v72 offset:26880
    buffer_load_dwordx4 v18, s[32:35], s26 offen lds
    v_mfma_f32_32x32x16_bf16 v[128:143], v[60:63], a[52:55], v[128:143]
    ds_read_b64_tr_b16 v[52:53], v73 offset:25600
    ds_read_b64_tr_b16 v[54:55], v73 offset:26880
    s_waitcnt lgkmcnt(4)
    v_mfma_f32_32x32x16_bf16 v[144:159], v[40:43], a[52:55], v[144:159]
    ds_read_b64_tr_b16 v[56:57], v69 offset:30720
    ds_read_b64_tr_b16 v[58:59], v69 offset:32000
    buffer_load_dwordx4 v19, s[32:35], s26 offen offset:1024 lds
    v_mfma_f32_32x32x16_bf16 v[160:175], v[44:47], a[52:55], v[160:175]
    ds_read_b64_tr_b16 v[60:61], v70 offset:30720
    ds_read_b64_tr_b16 v[62:63], v70 offset:32000
    s_waitcnt lgkmcnt(4)
    v_mfma_f32_32x32x16_bf16 v[176:191], v[48:51], a[52:55], v[176:191]
    ds_read_b64_tr_b16 v[40:41], v71 offset:30720
    ds_read_b64_tr_b16 v[42:43], v71 offset:32000
    buffer_load_dwordx4 v20, s[32:35], s26 offen offset:2048 lds
    v_mfma_f32_32x32x16_bf16 v[192:207], v[52:55], a[52:55], v[192:207]
    ds_read_b64_tr_b16 v[44:45], v72 offset:30720
    ds_read_b64_tr_b16 v[46:47], v72 offset:32000
    s_waitcnt lgkmcnt(4)
    v_mfma_f32_32x32x16_bf16 v[128:143], v[56:59], a[56:59], v[128:143]
    ds_read_b64_tr_b16 v[48:49], v73 offset:30720
    ds_read_b64_tr_b16 v[50:51], v73 offset:32000
    v_mfma_f32_32x32x16_bf16 v[144:159], v[60:63], a[56:59], v[144:159]
    ds_read_b64_tr_b16 v[52:53], v69 offset:35840
    ds_read_b64_tr_b16 v[54:55], v69 offset:37120
    buffer_load_dwordx4 v21, s[32:35], s26 offen offset:3072 lds
    s_waitcnt lgkmcnt(4)
    v_mfma_f32_32x32x16_bf16 v[160:175], v[40:43], a[56:59], v[160:175]
    ds_read_b64_tr_b16 v[56:57], v70 offset:35840
    ds_read_b64_tr_b16 v[58:59], v70 offset:37120
    s_add_u32 m0, s83, 0x16000
    v_mfma_f32_32x32x16_bf16 v[176:191], v[44:47], a[56:59], v[176:191]
    ds_read_b64_tr_b16 v[60:61], v71 offset:35840
    ds_read_b64_tr_b16 v[62:63], v71 offset:37120
    buffer_load_dwordx4 v22, s[32:35], s26 offen lds
    s_waitcnt lgkmcnt(4)
    v_mfma_f32_32x32x16_bf16 v[192:207], v[48:51], a[56:59], v[192:207]
    ds_read_b64_tr_b16 v[40:41], v72 offset:35840
    ds_read_b64_tr_b16 v[42:43], v72 offset:37120
    v_mfma_f32_32x32x16_bf16 v[128:143], v[52:55], a[60:63], v[128:143]
    ds_read_b64_tr_b16 v[44:45], v73 offset:35840
    ds_read_b64_tr_b16 v[46:47], v73 offset:37120
    s_waitcnt lgkmcnt(4)
    v_mfma_f32_32x32x16_bf16 v[144:159], v[56:59], a[60:63], v[144:159]
    s_waitcnt vmcnt(19)
    s_waitcnt lgkmcnt(0)
    ds_read_b128 a[64:67], v6 offset:0
    ds_read_b128 a[68:71], v7 offset:0
    ds_read_b128 a[72:75], v8 offset:0
    ds_read_b128 a[76:79], v9 offset:0
    s_waitcnt vmcnt(9)
    s_barrier
    ds_read_b64_tr_b16 v[48:49], v64 offset:0
    ds_read_b64_tr_b16 v[50:51], v64 offset:1280
    s_add_u32 m0, s71, 0x8000
    s_mov_b32 s26, 0x300
    v_mfma_f32_32x32x16_bf16 v[160:175], v[60:63], a[60:63], v[160:175]
    ds_read_b64_tr_b16 v[52:53], v65 offset:0
    ds_read_b64_tr_b16 v[54:55], v65 offset:1280
    buffer_load_dwordx4 v2, s[28:31], s26 offen lds
    v_mfma_f32_32x32x16_bf16 v[176:191], v[40:43], a[60:63], v[176:191]
    ds_read_b64_tr_b16 v[56:57], v66 offset:0
    ds_read_b64_tr_b16 v[58:59], v66 offset:1280
    buffer_load_dwordx4 v3, s[28:31], s26 offen offset:1024 lds
    v_lshrrev_b32 v96, 5, v1
    v_and_b32 v97, 1, v1
    v_bfe_u32 v98, v1, 4, 1
    v_bfe_u32 v99, v1, 1, 1
    v_lshl_add_u32 v98, v98, 1, v99
    v_mfma_f32_32x32x16_bf16 v[192:207], v[44:47], a[60:63], v[192:207]
    ds_read_b64_tr_b16 v[60:61], v67 offset:0
    ds_read_b64_tr_b16 v[62:63], v67 offset:1280
    v_bfe_u32 v99, v1, 2, 2
    v_mul_u32_u24 v99, 40, v99
    v_add_u32 v99, 0x25000, v99
    v_mov_b32 v100, 0x26400
    s_waitcnt lgkmcnt(4)
    v_mfma_f32_32x32x16_bf16 v[128:143], v[48:51], a[64:67], v[128:143]
    ds_read_b64_tr_b16 v[40:41], v68 offset:0
    ds_read_b64_tr_b16 v[42:43], v68 offset:1280
    buffer_load_dwordx4 v4, s[28:31], s26 offen offset:2048 lds
    v_add_u32 v101, 0, v98
    v_mul_u32_u24 v102, 52, v101
    v_lshrrev_b32 v102, 8, v102
    v_mul_u32_u24 v103, 5, v102
    v_sub_u32 v101, v101, v103
    v_mfma_f32_32x32x16_bf16 v[144:159], v[52:55], a[64:67], v[144:159]
    ds_read_b64_tr_b16 v[44:45], v64 offset:5120
    ds_read_b64_tr_b16 v[46:47], v64 offset:6400
    v_lshl_add_u32 v101, v101, 3, v99
    v_xor_b32 v103, v96, v97
    v_lshl_add_u32 v102, v103, 2, v102
    v_cmp_eq_u32 s[8:9], 0, v102
    s_waitcnt lgkmcnt(4)
    v_mfma_f32_32x32x16_bf16 v[160:175], v[56:59], a[64:67], v[160:175]
    ds_read_b64_tr_b16 v[48:49], v65 offset:5120
    ds_read_b64_tr_b16 v[50:51], v65 offset:6400
    buffer_load_dwordx4 v5, s[28:31], s26 offen offset:3072 lds
    v_cmp_eq_u32 s[12:13], 1, v102
    s_mov_b32 s76, 0x280
    v_mad_i32_i24 v104, v96, s76, v101
    v_cndmask_b32 v104, v100, v104, s[8:9]
    v_mfma_f32_32x32x16_bf16 v[176:191], v[60:63], a[64:67], v[176:191]
    ds_read_b64_tr_b16 v[52:53], v66 offset:5120
    ds_read_b64_tr_b16 v[54:55], v66 offset:6400
    ds_read_b64_tr_b16 a[160:161], v104 offset:160
    s_mov_b32 s76, 0x280
    v_mad_i32_i24 v104, v96, s76, v101
    v_cndmask_b32 v104, v100, v104, s[8:9]
    s_add_u32 m0, s83, 0x1a000
    s_mov_b32 s26, 0x168000
    s_waitcnt lgkmcnt(5)
    v_mfma_f32_32x32x16_bf16 v[192:207], v[40:43], a[64:67], v[192:207]
    ds_read_b64_tr_b16 v[56:57], v67 offset:5120
    ds_read_b64_tr_b16 v[58:59], v67 offset:6400
    buffer_load_dwordx4 v18, s[32:35], s26 offen lds
    ds_read_b64_tr_b16 a[162:163], v104 offset:320
    s_mov_b32 s76, 0x280
    v_mad_i32_i24 v104, v96, s76, v101
    v_cndmask_b32 v104, v100, v104, s[8:9]
    ds_read_b64_tr_b16 a[164:165], v104 offset:480
    v_mfma_f32_32x32x16_bf16 v[128:143], v[44:47], a[68:71], v[128:143]
    ds_read_b64_tr_b16 v[60:61], v68 offset:5120
    ds_read_b64_tr_b16 v[62:63], v68 offset:6400
    s_mov_b32 s76, 0x280
    v_mad_i32_i24 v104, v96, s76, v101
    v_cndmask_b32 v104, v100, v104, s[8:9]
    ds_read_b64_tr_b16 a[166:167], v104 offset:640
    s_waitcnt lgkmcnt(8)
    v_mfma_f32_32x32x16_bf16 v[144:159], v[48:51], a[68:71], v[144:159]
    ds_read_b64_tr_b16 v[40:41], v64 offset:10240
    ds_read_b64_tr_b16 v[42:43], v64 offset:11520
    buffer_load_dwordx4 v19, s[32:35], s26 offen offset:1024 lds
    s_mov_b32 s76, 0x5a0
    v_mad_i32_i24 v104, v96, s76, v101
    v_cndmask_b32 v104, v100, v104, s[8:9]
    ds_read_b64_tr_b16 a[168:169], v104 offset:0
    v_mfma_f32_32x32x16_bf16 v[160:175], v[52:55], a[68:71], v[160:175]
    ds_read_b64_tr_b16 v[44:45], v65 offset:10240
    ds_read_b64_tr_b16 v[46:47], v65 offset:11520
    s_mov_b32 s76, 0x1e0
    v_mad_i32_i24 v104, v96, s76, v101
    v_cndmask_b32 v104, v100, v104, s[12:13]
    ds_read_b64_tr_b16 a[170:171], v104 offset:1920
    s_waitcnt lgkmcnt(7)
    v_mfma_f32_32x32x16_bf16 v[176:191], v[56:59], a[68:71], v[176:191]
    ds_read_b64_tr_b16 v[48:49], v66 offset:10240
    ds_read_b64_tr_b16 v[50:51], v66 offset:11520
    buffer_load_dwordx4 v20, s[32:35], s26 offen offset:2048 lds
    v_add_u32 v101, 4, v98
    v_mul_u32_u24 v102, 52, v101
    v_lshrrev_b32 v102, 8, v102
    v_mul_u32_u24 v103, 5, v102
    v_mfma_f32_32x32x16_bf16 v[192:207], v[60:63], a[68:71], v[192:207]
    ds_read_b64_tr_b16 v[52:53], v67 offset:10240
    ds_read_b64_tr_b16 v[54:55], v67 offset:11520
    buffer_load_dword v115, v125, s[40:43], 0 offen sc1
    v_sub_u32 v101, v101, v103
    v_lshl_add_u32 v101, v101, 3, v99
    v_xor_b32 v103, v96, v97
    v_lshl_add_u32 v102, v103, 2, v102
    v_cmp_eq_u32 s[8:9], 0, v102
    s_waitcnt lgkmcnt(5)
    v_mfma_f32_32x32x16_bf16 v[128:143], v[40:43], a[72:75], v[128:143]
    ds_read_b64_tr_b16 v[56:57], v68 offset:10240
    ds_read_b64_tr_b16 v[58:59], v68 offset:11520
    v_cmp_eq_u32 s[12:13], 1, v102
    s_mov_b32 s76, 0x280
    v_mad_i32_i24 v104, v96, s76, v101
    v_cndmask_b32 v104, v100, v104, s[8:9]
    v_mfma_f32_32x32x16_bf16 v[144:159], v[44:47], a[72:75], v[144:159]
    ds_read_b64_tr_b16 v[60:61], v64 offset:15360
    ds_read_b64_tr_b16 v[62:63], v64 offset:16640
    buffer_load_dwordx4 v21, s[32:35], s26 offen offset:3072 lds
    ds_read_b64_tr_b16 a[172:173], v104 offset:160
    s_mov_b32 s76, 0x280
    v_mad_i32_i24 v104, v96, s76, v101
    v_cndmask_b32 v104, v100, v104, s[8:9]
    s_waitcnt lgkmcnt(5)
    v_mfma_f32_32x32x16_bf16 v[160:175], v[48:51], a[72:75], v[160:175]
    ds_read_b64_tr_b16 v[40:41], v65 offset:15360
    ds_read_b64_tr_b16 v[42:43], v65 offset:16640
    ds_read_b64_tr_b16 a[174:175], v104 offset:320
    s_mov_b32 s76, 0x280
    v_mad_i32_i24 v104, v96, s76, v101
    v_cndmask_b32 v104, v100, v104, s[8:9]
    s_add_u32 m0, s83, 0x1b000
    v_mfma_f32_32x32x16_bf16 v[176:191], v[52:55], a[72:75], v[176:191]
    ds_read_b64_tr_b16 v[44:45], v66 offset:15360
    ds_read_b64_tr_b16 v[46:47], v66 offset:16640
    buffer_load_dwordx4 v22, s[32:35], s26 offen lds
    ds_read_b64_tr_b16 a[176:177], v104 offset:480
    s_mov_b32 s76, 0x280
    v_mad_i32_i24 v104, v96, s76, v101
    v_cndmask_b32 v104, v100, v104, s[8:9]
    ds_read_b64_tr_b16 a[178:179], v104 offset:640
    s_waitcnt lgkmcnt(8)
    v_mfma_f32_32x32x16_bf16 v[192:207], v[56:59], a[72:75], v[192:207]
    ds_read_b64_tr_b16 v[48:49], v67 offset:15360
    ds_read_b64_tr_b16 v[50:51], v67 offset:16640
    s_mov_b32 s76, 0x5a0
    v_mad_i32_i24 v104, v96, s76, v101
    v_cndmask_b32 v104, v100, v104, s[8:9]
    ds_read_b64_tr_b16 a[180:181], v104 offset:0
    v_mfma_f32_32x32x16_bf16 v[128:143], v[60:63], a[76:79], v[128:143]
    ds_read_b64_tr_b16 v[52:53], v68 offset:15360
    ds_read_b64_tr_b16 v[54:55], v68 offset:16640
    s_mov_b32 s76, 0x1e0
    v_mad_i32_i24 v104, v96, s76, v101
    v_cndmask_b32 v104, v100, v104, s[12:13]
    ds_read_b64_tr_b16 a[182:183], v104 offset:1920
    s_waitcnt lgkmcnt(8)
    v_mfma_f32_32x32x16_bf16 v[144:159], v[40:43], a[76:79], v[144:159]
    s_waitcnt vmcnt(15)
    s_waitcnt lgkmcnt(0)
    ds_read_b128 a[80:83], v6 offset:16384
    ds_read_b128 a[84:87], v7 offset:16384
    ds_read_b128 a[88:91], v8 offset:16384
    ds_read_b128 a[92:95], v9 offset:16384
    s_waitcnt vmcnt(10)
    s_barrier
    ds_read_b64_tr_b16 v[56:57], v64 offset:20480
    ds_read_b64_tr_b16 v[58:59], v64 offset:21760
    s_add_u32 m0, s71, 0xc000
    s_mov_b32 s26, 0x380
    s_mov_b32 s76, 0x320
    v_mad_i32_i24 v104, v96, s76, v101
    v_cndmask_b32 v104, v100, v104, s[12:13]
    ds_read_b64_tr_b16 a[184:185], v104 offset:2080
    v_mfma_f32_32x32x16_bf16 v[160:175], v[44:47], a[76:79], v[160:175]
    ds_read_b64_tr_b16 v[60:61], v65 offset:20480
    ds_read_b64_tr_b16 v[62:63], v65 offset:21760
    buffer_load_dwordx4 v2, s[28:31], s26 offen lds
    s_mov_b32 s76, 0x320
    v_mad_i32_i24 v104, v96, s76, v101
    v_cndmask_b32 v104, v100, v104, s[12:13]
    ds_read_b64_tr_b16 a[186:187], v104 offset:2240
    v_mfma_f32_32x32x16_bf16 v[176:191], v[48:51], a[76:79], v[176:191]
    ds_read_b64_tr_b16 v[40:41], v66 offset:20480
    ds_read_b64_tr_b16 v[42:43], v66 offset:21760
    buffer_load_dwordx4 v3, s[28:31], s26 offen offset:1024 lds
    s_mov_b32 s76, 0x3c0
    v_mad_i32_i24 v104, v96, s76, v101
    v_cndmask_b32 v104, v100, v104, s[12:13]
    ds_read_b64_tr_b16 a[188:189], v104 offset:1600
    v_mfma_f32_32x32x16_bf16 v[192:207], v[52:55], a[76:79], v[192:207]
    ds_read_b64_tr_b16 v[44:45], v67 offset:20480
    ds_read_b64_tr_b16 v[46:47], v67 offset:21760
    s_mov_b32 s76, 0x3c0
    v_mad_i32_i24 v104, v96, s76, v101
    v_cndmask_b32 v104, v100, v104, s[12:13]
    ds_read_b64_tr_b16 a[190:191], v104 offset:1760
    s_waitcnt lgkmcnt(7)
    v_mfma_f32_32x32x16_bf16 v[128:143], v[56:59], a[80:83], v[128:143]
    ds_read_b64_tr_b16 v[48:49], v68 offset:20480
    ds_read_b64_tr_b16 v[50:51], v68 offset:21760
    buffer_load_dwordx4 v4, s[28:31], s26 offen offset:2048 lds
    v_add_u32 v101, 8, v98
    v_mul_u32_u24 v102, 52, v101
    v_lshrrev_b32 v102, 8, v102
    v_mul_u32_u24 v103, 5, v102
    v_sub_u32 v101, v101, v103
    v_mfma_f32_32x32x16_bf16 v[144:159], v[60:63], a[80:83], v[144:159]
    ds_read_b64_tr_b16 v[52:53], v64 offset:25600
    ds_read_b64_tr_b16 v[54:55], v64 offset:26880
    v_lshl_add_u32 v101, v101, 3, v99
    v_xor_b32 v103, v96, v97
    v_lshl_add_u32 v102, v103, 2, v102
    v_cmp_eq_u32 s[8:9], 0, v102
    s_waitcnt lgkmcnt(5)
    v_mfma_f32_32x32x16_bf16 v[160:175], v[40:43], a[80:83], v[160:175]
    ds_read_b64_tr_b16 v[56:57], v65 offset:25600
    ds_read_b64_tr_b16 v[58:59], v65 offset:26880
    buffer_load_dwordx4 v5, s[28:31], s26 offen offset:3072 lds
    v_cmp_eq_u32 s[12:13], 1, v102
    s_mov_b32 s76, 0x5a0
    v_mad_i32_i24 v104, v96, s76, v101
    v_cndmask_b32 v104, v100, v104, s[8:9]
    ds_read_b64_tr_b16 a[192:193], v104 offset:0
    v_mfma_f32_32x32x16_bf16 v[176:191], v[44:47], a[80:83], v[176:191]
    ds_read_b64_tr_b16 v[60:61], v66 offset:25600
    ds_read_b64_tr_b16 v[62:63], v66 offset:26880
    s_mov_b32 s76, 0x1e0
    v_mad_i32_i24 v104, v96, s76, v101
    v_cndmask_b32 v104, v100, v104, s[12:13]
    ds_read_b64_tr_b16 a[194:195], v104 offset:1920
    s_add_u32 m0, s83, 0x1f000
    s_mov_b32 s26, 0x1a4000
    s_waitcnt lgkmcnt(6)
    v_mfma_f32_32x32x16_bf16 v[192:207], v[48:51], a[80:83], v[192:207]
    ds_read_b64_tr_b16 v[40:41], v67 offset:25600
    ds_read_b64_tr_b16 v[42:43], v67 offset:26880
    buffer_load_dwordx4 v18, s[32:35], s26 offen lds
    s_mov_b32 s76, 0x320
    v_mad_i32_i24 v104, v96, s76, v101
    v_cndmask_b32 v104, v100, v104, s[12:13]
    ds_read_b64_tr_b16 a[196:197], v104 offset:2080
    v_mfma_f32_32x32x16_bf16 v[128:143], v[52:55], a[84:87], v[128:143]
    ds_read_b64_tr_b16 v[44:45], v68 offset:25600
    ds_read_b64_tr_b16 v[46:47], v68 offset:26880
    s_mov_b32 s76, 0x320
    v_mad_i32_i24 v104, v96, s76, v101
    v_cndmask_b32 v104, v100, v104, s[12:13]
    ds_read_b64_tr_b16 a[198:199], v104 offset:2240
    s_waitcnt lgkmcnt(7)
    v_mfma_f32_32x32x16_bf16 v[144:159], v[56:59], a[84:87], v[144:159]
    ds_read_b64_tr_b16 v[48:49], v64 offset:30720
    ds_read_b64_tr_b16 v[50:51], v64 offset:32000
    buffer_load_dwordx4 v19, s[32:35], s26 offen offset:1024 lds
    s_mov_b32 s76, 0x3c0
    v_mad_i32_i24 v104, v96, s76, v101
    v_cndmask_b32 v104, v100, v104, s[12:13]
    ds_read_b64_tr_b16 a[200:201], v104 offset:1600
    v_mfma_f32_32x32x16_bf16 v[160:175], v[60:63], a[84:87], v[160:175]
    ds_read_b64_tr_b16 v[52:53], v65 offset:30720
    ds_read_b64_tr_b16 v[54:55], v65 offset:32000
    s_mov_b32 s76, 0x3c0
    v_mad_i32_i24 v104, v96, s76, v101
    v_cndmask_b32 v104, v100, v104, s[12:13]
    ds_read_b64_tr_b16 a[202:203], v104 offset:1760
    s_waitcnt lgkmcnt(7)
    v_mfma_f32_32x32x16_bf16 v[176:191], v[40:43], a[84:87], v[176:191]
    ds_read_b64_tr_b16 v[56:57], v66 offset:30720
    ds_read_b64_tr_b16 v[58:59], v66 offset:32000
    buffer_load_dwordx4 v20, s[32:35], s26 offen offset:2048 lds
    s_waitcnt vmcnt(9)
    v_cmp_ne_u32 vcc, s72, v115
    s_nop 4
    s_cbranch_vccnz Lslow5
Lback5:
    v_lshlrev_b32 v112, 2, v114
    v_mfma_f32_32x32x16_bf16 v[192:207], v[44:47], a[84:87], v[192:207]
    ds_read_b64_tr_b16 v[60:61], v67 offset:30720
    ds_read_b64_tr_b16 v[62:63], v67 offset:32000
    v_subrev_u32 v113, 1920, v114
    s_waitcnt lgkmcnt(5)
    v_mfma_f32_32x32x16_bf16 v[128:143], v[48:51], a[88:91], v[128:143]
    ds_read_b64_tr_b16 v[40:41], v68 offset:30720
    ds_read_b64_tr_b16 v[42:43], v68 offset:32000
    v_cmp_le_u32 vcc, 1920, v114
    v_lshlrev_b32 v113, 1, v113
    v_mov_b32 v115, 0x80000000
    v_cndmask_b32 v113, v115, v113, vcc
    s_mov_b32 s73, 0x60000
    v_mfma_f32_32x32x16_bf16 v[144:159], v[52:55], a[88:91], v[144:159]
    ds_read_b64_tr_b16 v[44:45], v64 offset:35840
    ds_read_b64_tr_b16 v[46:47], v64 offset:37120
    buffer_load_dwordx4 v21, s[32:35], s26 offen offset:3072 lds
    buffer_load_dword v116, v112, s[40:43], s73 offen sc1
    s_mov_b32 s73, 0x64000
    s_waitcnt lgkmcnt(4)
    v_mfma_f32_32x32x16_bf16 v[160:175], v[56:59], a[88:91], v[160:175]
    ds_read_b64_tr_b16 v[48:49], v65 offset:35840
    ds_read_b64_tr_b16 v[50:51], v65 offset:37120
    buffer_load_dword v117, v112, s[40:43], s73 offen sc1
    s_mov_b32 s73, 0x68000
    s_add_u32 m0, s83, 0x20000
    v_mfma_f32_32x32x16_bf16 v[176:191], v[60:63], a[88:91], v[176:191]
    ds_read_b64_tr_b16 v[52:53], v66 offset:35840
    ds_read_b64_tr_b16 v[54:55], v66 offset:37120
    buffer_load_dwordx4 v22, s[32:35], s26 offen lds
    buffer_load_dword v118, v112, s[40:43], s73 offen sc1
    s_mov_b32 s73, 0x6c000
    s_waitcnt lgkmcnt(4)
    v_mfma_f32_32x32x16_bf16 v[192:207], v[40:43], a[88:91], v[192:207]
    ds_read_b64_tr_b16 v[56:57], v67 offset:35840
    ds_read_b64_tr_b16 v[58:59], v67 offset:37120
    buffer_load_dword v119, v112, s[40:43], s73 offen sc1
    s_mov_b32 s73, 0x70000
    v_mfma_f32_32x32x16_bf16 v[128:143], v[44:47], a[92:95], v[128:143]
    ds_read_b64_tr_b16 v[60:61], v68 offset:35840
    ds_read_b64_tr_b16 v[62:63], v68 offset:37120
    buffer_load_dword v120, v112, s[40:43], s73 offen sc1
    s_waitcnt lgkmcnt(4)
    v_mfma_f32_32x32x16_bf16 v[144:159], v[48:51], a[92:95], v[144:159]
    s_waitcnt lgkmcnt(0)
    ds_read_b128 a[96:99], v6 offset:32768
    ds_read_b128 a[100:103], v7 offset:32768
    ds_read_b128 a[104:107], v8 offset:32768
    ds_read_b128 a[108:111], v9 offset:32768
    s_waitcnt vmcnt(14)
    s_barrier
    ds_read_b64_tr_b16 v[40:41], v69 offset:0
    ds_read_b64_tr_b16 v[42:43], v69 offset:1280
    s_add_u32 m0, s71, 0x0
    s_mov_b32 s26, 0x400
    buffer_load_dwordx4 v2, s[28:31], s26 offen lds
    s_mov_b32 s73, 0x74000
    buffer_load_dword v121, v112, s[40:43], s73 offen sc1
    v_mfma_f32_32x32x16_bf16 v[160:175], v[52:55], a[92:95], v[160:175]
    ds_read_b64_tr_b16 v[44:45], v70 offset:0
    ds_read_b64_tr_b16 v[46:47], v70 offset:1280
    s_mov_b32 s73, 0x78000
    buffer_load_dword v122, v112, s[40:43], s73 offen sc1
    v_mfma_f32_32x32x16_bf16 v[176:191], v[56:59], a[92:95], v[176:191]
    ds_read_b64_tr_b16 v[48:49], v71 offset:0
    ds_read_b64_tr_b16 v[50:51], v71 offset:1280
    buffer_load_dwordx4 v3, s[28:31], s26 offen offset:1024 lds
    s_mov_b32 s73, 0x7c000
    buffer_load_dword v123, v112, s[40:43], s73 offen sc1
    v_mfma_f32_32x32x16_bf16 v[192:207], v[60:63], a[92:95], v[192:207]
    ds_read_b64_tr_b16 v[52:53], v72 offset:0
    ds_read_b64_tr_b16 v[54:55], v72 offset:1280
    buffer_load_ushort v124, v113, s[56:59], 0 offen
    s_lshl_b32 s73, s69, 7
    s_waitcnt lgkmcnt(4)
    v_mfma_f32_32x32x16_bf16 v[128:143], v[40:43], a[96:99], v[128:143]
    ds_read_b64_tr_b16 v[56:57], v73 offset:0
    ds_read_b64_tr_b16 v[58:59], v73 offset:1280
    buffer_load_dwordx4 v4, s[28:31], s26 offen offset:2048 lds
    s_lshl_b32 s74, s68, 5
    s_add_u32 s73, s73, s74
    s_lshl_b32 s73, s73, 6
    v_mfma_f32_32x32x16_bf16 v[144:159], v[44:47], a[96:99], v[144:159]
    ds_read_b64_tr_b16 v[60:61], v69 offset:5120
    ds_read_b64_tr_b16 v[62:63], v69 offset:6400
    s_add_u32 s73, s73, 0x40000
    v_and_b32 v112, 31, v1
    v_lshlrev_b32 v112, 6, v112
    s_waitcnt lgkmcnt(4)
    v_mfma_f32_32x32x16_bf16 v[160:175], v[48:51], a[96:99], v[160:175]
    ds_read_b64_tr_b16 v[40:41], v70 offset:5120
    ds_read_b64_tr_b16 v[42:43], v70 offset:6400
    buffer_load_dwordx4 v5, s[28:31], s26 offen offset:3072 lds
    v_cmp_gt_u32 vcc, 32, v1
    buffer_load_dwordx2 v[126:127], v112, s[40:43], s73 offen offset:16 sc1
    s_nop 0
    v_cndmask_b32 v113, v115, v112, vcc
    v_mfma_f32_32x32x16_bf16 v[176:191], v[52:55], a[96:99], v[176:191]
    ds_read_b64_tr_b16 v[44:45], v71 offset:5120
    ds_read_b64_tr_b16 v[46:47], v71 offset:6400
    buffer_load_dwordx4 v[36:39], v113, s[40:43], s73 offen sc1
    s_add_u32 m0, s83, 0x10000
    s_mov_b32 s26, 0x1e0000
    s_waitcnt lgkmcnt(4)
    v_mfma_f32_32x32x16_bf16 v[192:207], v[56:59], a[96:99], v[192:207]
    ds_read_b64_tr_b16 v[48:49], v72 offset:5120
    ds_read_b64_tr_b16 v[50:51], v72 offset:6400
    buffer_load_dwordx4 v18, s[32:35], s26 offen lds
    v_mfma_f32_32x32x16_bf16 v[128:143], v[60:63], a[100:103], v[128:143]
    ds_read_b64_tr_b16 v[52:53], v73 offset:5120
    ds_read_b64_tr_b16 v[54:55], v73 offset:6400
    s_waitcnt lgkmcnt(4)
    v_mfma_f32_32x32x16_bf16 v[144:159], v[40:43], a[100:103], v[144:159]
    ds_read_b64_tr_b16 v[56:57], v69 offset:10240
    ds_read_b64_tr_b16 v[58:59], v69 offset:11520
    buffer_load_dwordx4 v19, s[32:35], s26 offen offset:1024 lds
    v_mfma_f32_32x32x16_bf16 v[160:175], v[44:47], a[100:103], v[160:175]
    ds_read_b64_tr_b16 v[60:61], v70 offset:10240
    ds_read_b64_tr_b16 v[62:63], v70 offset:11520
    s_waitcnt lgkmcnt(4)
    v_mfma_f32_32x32x16_bf16 v[176:191], v[48:51], a[100:103], v[176:191]
    ds_read_b64_tr_b16 v[40:41], v71 offset:10240
    ds_read_b64_tr_b16 v[42:43], v71 offset:11520
    buffer_load_dwordx4 v20, s[32:35], s26 offen offset:2048 lds
    v_mfma_f32_32x32x16_bf16 v[192:207], v[52:55], a[100:103], v[192:207]
    ds_read_b64_tr_b16 v[44:45], v72 offset:10240
    ds_read_b64_tr_b16 v[46:47], v72 offset:11520
    s_waitcnt lgkmcnt(4)
    v_mfma_f32_32x32x16_bf16 v[128:143], v[56:59], a[104:107], v[128:143]
    ds_read_b64_tr_b16 v[48:49], v73 offset:10240
    ds_read_b64_tr_b16 v[50:51], v73 offset:11520
    v_mfma_f32_32x32x16_bf16 v[144:159], v[60:63], a[104:107], v[144:159]
    ds_read_b64_tr_b16 v[52:53], v69 offset:15360
    ds_read_b64_tr_b16 v[54:55], v69 offset:16640
    buffer_load_dwordx4 v21, s[32:35], s26 offen offset:3072 lds
    s_waitcnt lgkmcnt(4)
    v_mfma_f32_32x32x16_bf16 v[160:175], v[40:43], a[104:107], v[160:175]
    ds_read_b64_tr_b16 v[56:57], v70 offset:15360
    ds_read_b64_tr_b16 v[58:59], v70 offset:16640
    s_add_u32 m0, s83, 0x11000
    v_mfma_f32_32x32x16_bf16 v[176:191], v[44:47], a[104:107], v[176:191]
    ds_read_b64_tr_b16 v[60:61], v71 offset:15360
    ds_read_b64_tr_b16 v[62:63], v71 offset:16640
    buffer_load_dwordx4 v22, s[32:35], s26 offen lds
    s_waitcnt lgkmcnt(4)
    v_mfma_f32_32x32x16_bf16 v[192:207], v[48:51], a[104:107], v[192:207]
    ds_read_b64_tr_b16 v[40:41], v72 offset:15360
    ds_read_b64_tr_b16 v[42:43], v72 offset:16640
    v_mfma_f32_32x32x16_bf16 v[128:143], v[52:55], a[108:111], v[128:143]
    ds_read_b64_tr_b16 v[44:45], v73 offset:15360
    ds_read_b64_tr_b16 v[46:47], v73 offset:16640
    s_waitcnt lgkmcnt(4)
    v_mfma_f32_32x32x16_bf16 v[144:159], v[56:59], a[108:111], v[144:159]
    s_waitcnt vmcnt(25)
    s_waitcnt lgkmcnt(0)
    ds_read_b128 a[112:115], v6 offset:49152
    ds_read_b128 a[116:119], v7 offset:49152
    ds_read_b128 a[120:123], v8 offset:49152
    ds_read_b128 a[124:127], v9 offset:49152
    s_waitcnt vmcnt(18)
    s_barrier
    ds_read_b64_tr_b16 v[48:49], v69 offset:20480
    ds_read_b64_tr_b16 v[50:51], v69 offset:21760
    s_add_u32 m0, s71, 0x4000
    s_mov_b32 s26, 0x480
    v_mfma_f32_32x32x16_bf16 v[160:175], v[60:63], a[108:111], v[160:175]
    ds_read_b64_tr_b16 v[52:53], v70 offset:20480
    ds_read_b64_tr_b16 v[54:55], v70 offset:21760
    buffer_load_dwordx4 v2, s[28:31], s26 offen lds
    v_mfma_f32_32x32x16_bf16 v[176:191], v[40:43], a[108:111], v[176:191]
    ds_read_b64_tr_b16 v[56:57], v71 offset:20480
    ds_read_b64_tr_b16 v[58:59], v71 offset:21760
    buffer_load_dwordx4 v3, s[28:31], s26 offen offset:1024 lds
    v_mfma_f32_32x32x16_bf16 v[192:207], v[44:47], a[108:111], v[192:207]
    ds_read_b64_tr_b16 v[60:61], v72 offset:20480
    ds_read_b64_tr_b16 v[62:63], v72 offset:21760
    s_waitcnt lgkmcnt(4)
    v_mfma_f32_32x32x16_bf16 v[128:143], v[48:51], a[112:115], v[128:143]
    ds_read_b64_tr_b16 v[40:41], v73 offset:20480
    ds_read_b64_tr_b16 v[42:43], v73 offset:21760
    buffer_load_dwordx4 v4, s[28:31], s26 offen offset:2048 lds
    v_mfma_f32_32x32x16_bf16 v[144:159], v[52:55], a[112:115], v[144:159]
    ds_read_b64_tr_b16 v[44:45], v69 offset:25600
    ds_read_b64_tr_b16 v[46:47], v69 offset:26880
    s_waitcnt lgkmcnt(4)
    v_mfma_f32_32x32x16_bf16 v[160:175], v[56:59], a[112:115], v[160:175]
    ds_read_b64_tr_b16 v[48:49], v70 offset:25600
    ds_read_b64_tr_b16 v[50:51], v70 offset:26880
    buffer_load_dwordx4 v5, s[28:31], s26 offen offset:3072 lds
    v_mfma_f32_32x32x16_bf16 v[176:191], v[60:63], a[112:115], v[176:191]
    ds_read_b64_tr_b16 v[52:53], v71 offset:25600
    ds_read_b64_tr_b16 v[54:55], v71 offset:26880
    s_add_u32 m0, s83, 0x15000
    s_mov_b32 s26, 0x21c000
    s_waitcnt lgkmcnt(4)
    v_mfma_f32_32x32x16_bf16 v[192:207], v[40:43], a[112:115], v[192:207]
    ds_read_b64_tr_b16 v[56:57], v72 offset:25600
    ds_read_b64_tr_b16 v[58:59], v72 offset:26880
    buffer_load_dwordx4 v18, s[32:35], s26 offen lds
    v_mfma_f32_32x32x16_bf16 v[128:143], v[44:47], a[116:119], v[128:143]
    ds_read_b64_tr_b16 v[60:61], v73 offset:25600
    ds_read_b64_tr_b16 v[62:63], v73 offset:26880
    s_waitcnt lgkmcnt(4)
    v_mfma_f32_32x32x16_bf16 v[144:159], v[48:51], a[116:119], v[144:159]
    ds_read_b64_tr_b16 v[40:41], v69 offset:30720
    ds_read_b64_tr_b16 v[42:43], v69 offset:32000
    buffer_load_dwordx4 v19, s[32:35], s26 offen offset:1024 lds
    v_add_f32 v116, v116, v117
    s_waitcnt vmcnt(22)
    v_add_f32 v118, v118, v119
    v_mfma_f32_32x32x16_bf16 v[160:175], v[52:55], a[116:119], v[160:175]
    ds_read_b64_tr_b16 v[44:45], v70 offset:30720
    ds_read_b64_tr_b16 v[46:47], v70 offset:32000
    s_waitcnt vmcnt(19)
    v_add_f32 v120, v120, v121
    s_waitcnt vmcnt(16)
    v_add_f32 v122, v122, v123
    s_waitcnt lgkmcnt(4)
    v_mfma_f32_32x32x16_bf16 v[176:191], v[56:59], a[116:119], v[176:191]
    ds_read_b64_tr_b16 v[48:49], v71 offset:30720
    ds_read_b64_tr_b16 v[50:51], v71 offset:32000
    buffer_load_dwordx4 v20, s[32:35], s26 offen offset:2048 lds
    v_add_f32 v116, v116, v118
    v_add_f32 v120, v120, v122
    v_mfma_f32_32x32x16_bf16 v[192:207], v[60:63], a[116:119], v[192:207]
    ds_read_b64_tr_b16 v[52:53], v72 offset:30720
    ds_read_b64_tr_b16 v[54:55], v72 offset:32000
    v_lshlrev_b32 v112, 4, v0
    v_add_f32 v116, v116, v120
    s_waitcnt lgkmcnt(4)
    v_mfma_f32_32x32x16_bf16 v[128:143], v[40:43], a[120:123], v[128:143]
    ds_read_b64_tr_b16 v[56:57], v73 offset:30720
    ds_read_b64_tr_b16 v[58:59], v73 offset:32000
    v_add_u32 v112, 0x27000, v112
    v_cvt_pk_bf16_f32 v117, v116, v116
    v_mfma_f32_32x32x16_bf16 v[144:159], v[44:47], a[120:123], v[144:159]
    ds_read_b64_tr_b16 v[60:61], v69 offset:35840
    ds_read_b64_tr_b16 v[62:63], v69 offset:37120
    buffer_load_dwordx4 v21, s[32:35], s26 offen offset:3072 lds
    v_mov_b32 v123, 0
    v_lshlrev_b32 v118, 16, v117
    s_waitcnt lgkmcnt(4)
    v_mfma_f32_32x32x16_bf16 v[160:175], v[48:51], a[120:123], v[160:175]
    ds_read_b64_tr_b16 v[40:41], v70 offset:35840
    ds_read_b64_tr_b16 v[42:43], v70 offset:37120
    v_and_b32 v117, 0xffff, v117
    v_sub_f32 v118, v116, v118
    s_add_u32 m0, s83, 0x16000
    v_mfma_f32_32x32x16_bf16 v[176:191], v[52:55], a[120:123], v[176:191]
    ds_read_b64_tr_b16 v[44:45], v71 offset:35840
    ds_read_b64_tr_b16 v[46:47], v71 offset:37120
    buffer_load_dwordx4 v22, s[32:35], s26 offen lds
    s_waitcnt vmcnt(18)
    v_lshl_or_b32 v121, v124, 16, v117
    v_cvt_pk_bf16_f32 v120, v116, v118
    s_waitcnt lgkmcnt(4)
    v_mfma_f32_32x32x16_bf16 v[192:207], v[56:59], a[120:123], v[192:207]
    ds_read_b64_tr_b16 v[48:49], v72 offset:35840
    ds_read_b64_tr_b16 v[50:51], v72 offset:37120
    v_mov_b32 v122, v124
    s_waitcnt vmcnt(15)
    v_mov_b32 v33, v126
    v_mfma_f32_32x32x16_bf16 v[128:143], v[60:63], a[124:127], v[128:143]
    ds_read_b64_tr_b16 v[52:53], v73 offset:35840
    ds_read_b64_tr_b16 v[54:55], v73 offset:37120
    v_mov_b32 v34, v127
    ds_write_b128 v112, v[120:123]
    s_waitcnt lgkmcnt(5)
    v_mfma_f32_32x32x16_bf16 v[144:159], v[40:43], a[124:127], v[144:159]
    s_waitcnt lgkmcnt(0)
    ds_read_b128 a[128:131], v6 offset:0
    ds_read_b128 a[132:135], v7 offset:0
    ds_read_b128 a[136:139], v8 offset:0
    ds_read_b128 a[140:143], v9 offset:0
    s_waitcnt vmcnt(9)
    s_barrier
    ds_read_b64_tr_b16 v[56:57], v64 offset:0
    ds_read_b64_tr_b16 v[58:59], v64 offset:1280
    s_add_u32 m0, s71, 0x8000
    s_add_u32 s26, s82, 0
    v_mfma_f32_32x32x16_bf16 v[160:175], v[44:47], a[124:127], v[160:175]
    ds_read_b64_tr_b16 v[60:61], v65 offset:0
    ds_read_b64_tr_b16 v[62:63], v65 offset:1280
    buffer_load_dwordx4 v14, s[36:39], s26 offen lds
    v_mfma_f32_32x32x16_bf16 v[176:191], v[48:51], a[124:127], v[176:191]
    ds_read_b64_tr_b16 v[40:41], v66 offset:0
    ds_read_b64_tr_b16 v[42:43], v66 offset:1280
    buffer_load_dwordx4 v15, s[36:39], s26 offen offset:1024 lds
    v_mfma_f32_32x32x16_bf16 v[192:207], v[52:55], a[124:127], v[192:207]
    ds_read_b64_tr_b16 v[44:45], v67 offset:0
    ds_read_b64_tr_b16 v[46:47], v67 offset:1280
    s_waitcnt lgkmcnt(4)
    v_mfma_f32_32x32x16_bf16 v[128:143], v[56:59], a[128:131], v[128:143]
    ds_read_b64_tr_b16 v[48:49], v68 offset:0
    ds_read_b64_tr_b16 v[50:51], v68 offset:1280
    buffer_load_dwordx4 v16, s[36:39], s26 offen offset:2048 lds
    v_mfma_f32_32x32x16_bf16 v[144:159], v[60:63], a[128:131], v[144:159]
    ds_read_b64_tr_b16 v[52:53], v64 offset:5120
    ds_read_b64_tr_b16 v[54:55], v64 offset:6400
    s_waitcnt lgkmcnt(4)
    v_mfma_f32_32x32x16_bf16 v[160:175], v[40:43], a[128:131], v[160:175]
    ds_read_b64_tr_b16 v[56:57], v65 offset:5120
    ds_read_b64_tr_b16 v[58:59], v65 offset:6400
    buffer_load_dwordx4 v17, s[36:39], s26 offen offset:3072 lds
    v_mfma_f32_32x32x16_bf16 v[176:191], v[44:47], a[128:131], v[176:191]
    ds_read_b64_tr_b16 v[60:61], v66 offset:5120
    ds_read_b64_tr_b16 v[62:63], v66 offset:6400
    s_add_u32 m0, s71, 0xc000
    s_add_u32 s26, s82, 442368
    s_waitcnt lgkmcnt(4)
    v_mfma_f32_32x32x16_bf16 v[192:207], v[48:51], a[128:131], v[192:207]
    ds_read_b64_tr_b16 v[40:41], v67 offset:5120
    ds_read_b64_tr_b16 v[42:43], v67 offset:6400
    buffer_load_dwordx4 v14, s[36:39], s26 offen lds
    v_mfma_f32_32x32x16_bf16 v[128:143], v[52:55], a[132:135], v[128:143]
    ds_read_b64_tr_b16 v[44:45], v68 offset:5120
    ds_read_b64_tr_b16 v[46:47], v68 offset:6400
    s_waitcnt lgkmcnt(4)
    v_mfma_f32_32x32x16_bf16 v[144:159], v[56:59], a[132:135], v[144:159]
    ds_read_b64_tr_b16 v[48:49], v64 offset:10240
    ds_read_b64_tr_b16 v[50:51], v64 offset:11520
    buffer_load_dwordx4 v15, s[36:39], s26 offen offset:1024 lds
    v_mfma_f32_32x32x16_bf16 v[160:175], v[60:63], a[132:135], v[160:175]
    ds_read_b64_tr_b16 v[52:53], v65 offset:10240
    ds_read_b64_tr_b16 v[54:55], v65 offset:11520
    s_waitcnt lgkmcnt(4)
    v_mfma_f32_32x32x16_bf16 v[176:191], v[40:43], a[132:135], v[176:191]
    ds_read_b64_tr_b16 v[56:57], v66 offset:10240
    ds_read_b64_tr_b16 v[58:59], v66 offset:11520
    buffer_load_dwordx4 v16, s[36:39], s26 offen offset:2048 lds
    v_mfma_f32_32x32x16_bf16 v[192:207], v[44:47], a[132:135], v[192:207]
    ds_read_b64_tr_b16 v[60:61], v67 offset:10240
    ds_read_b64_tr_b16 v[62:63], v67 offset:11520
    s_waitcnt lgkmcnt(4)
    v_mfma_f32_32x32x16_bf16 v[128:143], v[48:51], a[136:139], v[128:143]
    ds_read_b64_tr_b16 v[40:41], v68 offset:10240
    ds_read_b64_tr_b16 v[42:43], v68 offset:11520
    buffer_load_dwordx4 v17, s[36:39], s26 offen offset:3072 lds
    v_mfma_f32_32x32x16_bf16 v[144:159], v[52:55], a[136:139], v[144:159]
    ds_read_b64_tr_b16 v[44:45], v64 offset:15360
    ds_read_b64_tr_b16 v[46:47], v64 offset:16640
    s_add_u32 m0, s71, 0x0
    s_add_u32 s26, s82, 884736
    s_waitcnt lgkmcnt(4)
    v_mfma_f32_32x32x16_bf16 v[160:175], v[56:59], a[136:139], v[160:175]
    ds_read_b64_tr_b16 v[48:49], v65 offset:15360
    ds_read_b64_tr_b16 v[50:51], v65 offset:16640
    buffer_load_dwordx4 v14, s[36:39], s26 offen lds
    v_mfma_f32_32x32x16_bf16 v[176:191], v[60:63], a[136:139], v[176:191]
    ds_read_b64_tr_b16 v[52:53], v66 offset:15360
    ds_read_b64_tr_b16 v[54:55], v66 offset:16640
    buffer_load_dwordx4 v15, s[36:39], s26 offen offset:1024 lds
    s_waitcnt lgkmcnt(4)
    v_mfma_f32_32x32x16_bf16 v[192:207], v[40:43], a[136:139], v[192:207]
    ds_read_b64_tr_b16 v[56:57], v67 offset:15360
    ds_read_b64_tr_b16 v[58:59], v67 offset:16640
    v_mfma_f32_32x32x16_bf16 v[128:143], v[44:47], a[140:143], v[128:143]
    ds_read_b64_tr_b16 v[60:61], v68 offset:15360
    ds_read_b64_tr_b16 v[62:63], v68 offset:16640
    buffer_load_dwordx4 v16, s[36:39], s26 offen offset:2048 lds
    s_waitcnt lgkmcnt(4)
    v_mfma_f32_32x32x16_bf16 v[144:159], v[48:51], a[140:143], v[144:159]
    s_waitcnt vmcnt(16)
    s_waitcnt lgkmcnt(0)
    ds_read_b128 a[144:147], v6 offset:16384
    ds_read_b128 a[148:151], v7 offset:16384
    ds_read_b128 a[152:155], v8 offset:16384
    ds_read_b128 a[156:159], v9 offset:16384
    s_waitcnt vmcnt(11)
    s_barrier
    ds_read_b64_tr_b16 v[40:41], v64 offset:20480
    ds_read_b64_tr_b16 v[42:43], v64 offset:21760
    v_mfma_f32_32x32x16_bf16 v[160:175], v[52:55], a[140:143], v[160:175]
    ds_read_b64_tr_b16 v[44:45], v65 offset:20480
    ds_read_b64_tr_b16 v[46:47], v65 offset:21760
    buffer_load_dwordx4 v17, s[36:39], s26 offen offset:3072 lds
    v_mfma_f32_32x32x16_bf16 v[176:191], v[56:59], a[140:143], v[176:191]
    ds_read_b64_tr_b16 v[48:49], v66 offset:20480
    ds_read_b64_tr_b16 v[50:51], v66 offset:21760
    s_add_u32 m0, s71, 0x4000
    s_add_u32 s26, s82, 1327104
    v_mfma_f32_32x32x16_bf16 v[192:207], v[60:63], a[140:143], v[192:207]
    ds_read_b64_tr_b16 v[52:53], v67 offset:20480
    ds_read_b64_tr_b16 v[54:55], v67 offset:21760
    s_waitcnt lgkmcnt(8)
    buffer_load_dwordx4 v14, s[36:39], s26 offen lds
    s_waitcnt lgkmcnt(4)
    v_mfma_f32_32x32x16_bf16 v[128:143], v[40:43], a[144:147], v[128:143]
    ds_read_b64_tr_b16 v[56:57], v68 offset:20480
    ds_read_b64_tr_b16 v[58:59], v68 offset:21760
    v_mfma_f32_32x32x16_bf16 v[144:159], v[44:47], a[144:147], v[144:159]
    ds_read_b64_tr_b16 v[60:61], v64 offset:25600
    ds_read_b64_tr_b16 v[62:63], v64 offset:26880
    buffer_load_dwordx4 v15, s[36:39], s26 offen offset:1024 lds
    s_waitcnt lgkmcnt(4)
    v_mfma_f32_32x32x16_bf16 v[160:175], v[48:51], a[144:147], v[160:175]
    ds_read_b64_tr_b16 v[40:41], v65 offset:25600
    ds_read_b64_tr_b16 v[42:43], v65 offset:26880
    v_mfma_f32_32x32x16_bf16 v[176:191], v[52:55], a[144:147], v[176:191]
    ds_read_b64_tr_b16 v[44:45], v66 offset:25600
    ds_read_b64_tr_b16 v[46:47], v66 offset:26880
    buffer_load_dwordx4 v16, s[36:39], s26 offen offset:2048 lds
    s_waitcnt lgkmcnt(4)
    v_mfma_f32_32x32x16_bf16 v[192:207], v[56:59], a[144:147], v[192:207]
    ds_read_b64_tr_b16 v[48:49], v67 offset:25600
    ds_read_b64_tr_b16 v[50:51], v67 offset:26880
    v_mfma_f32_32x32x16_bf16 v[128:143], v[60:63], a[148:151], v[128:143]
    ds_read_b64_tr_b16 v[52:53], v68 offset:25600
    ds_read_b64_tr_b16 v[54:55], v68 offset:26880
    buffer_load_dwordx4 v17, s[36:39], s26 offen offset:3072 lds
    s_waitcnt lgkmcnt(4)
    v_mfma_f32_32x32x16_bf16 v[144:159], v[40:43], a[148:151], v[144:159]
    ds_read_b64_tr_b16 v[56:57], v64 offset:30720
    ds_read_b64_tr_b16 v[58:59], v64 offset:32000
    s_mul_i32 s73, s96, 389120
    s_mul_i32 s74, s68, 5120
    s_add_u32 m0, s71, 0x10000
    s_add_u32 s26, s82, 1769472
    v_mfma_f32_32x32x16_bf16 v[160:175], v[44:47], a[148:151], v[160:175]
    ds_read_b64_tr_b16 v[60:61], v65 offset:30720
    ds_read_b64_tr_b16 v[62:63], v65 offset:32000
    buffer_load_dwordx4 v14, s[36:39], s26 offen lds
    s_add_u32 s73, s73, s74
    s_waitcnt lgkmcnt(4)
    v_mfma_f32_32x32x16_bf16 v[176:191], v[48:51], a[148:151], v[176:191]
    ds_read_b64_tr_b16 v[40:41], v66 offset:30720
    ds_read_b64_tr_b16 v[42:43], v66 offset:32000
    s_add_u32 s73, s73, 0x200000
    v_lshlrev_b32 v6, 4, v1
    v_mfma_f32_32x32x16_bf16 v[192:207], v[52:55], a[148:151], v[192:207]
    ds_read_b64_tr_b16 v[44:45], v67 offset:30720
    ds_read_b64_tr_b16 v[46:47], v67 offset:32000
    buffer_load_dwordx4 v15, s[36:39], s26 offen offset:1024 lds
    v_add_u32 v6, s73, v6
    s_mul_i32 s91, s68, 15360
    s_waitcnt lgkmcnt(4)
    v_mfma_f32_32x32x16_bf16 v[128:143], v[56:59], a[152:155], v[128:143]
    ds_read_b64_tr_b16 v[48:49], v68 offset:30720
    ds_read_b64_tr_b16 v[50:51], v68 offset:32000
    s_add_u32 s91, s91, 0x14000
    v_mfma_f32_32x32x16_bf16 v[144:159], v[60:63], a[152:155], v[144:159]
    ds_read_b64_tr_b16 v[52:53], v64 offset:35840
    ds_read_b64_tr_b16 v[54:55], v64 offset:37120
    buffer_load_dwordx4 v16, s[36:39], s26 offen offset:2048 lds
    s_lshl_b32 s73, s68, 5
    v_and_b32 v118, 31, v1
    s_waitcnt lgkmcnt(4)
    v_mfma_f32_32x32x16_bf16 v[160:175], v[40:43], a[152:155], v[160:175]
    ds_read_b64_tr_b16 v[56:57], v65 offset:35840
    ds_read_b64_tr_b16 v[58:59], v65 offset:37120
    v_add_u32 v118, s73, v118
    v_mul_u32_u24 v118, 544, v118
    v_mfma_f32_32x32x16_bf16 v[176:191], v[44:47], a[152:155], v[176:191]
    ds_read_b64_tr_b16 v[60:61], v66 offset:35840
    ds_read_b64_tr_b16 v[62:63], v66 offset:37120
    buffer_load_dwordx4 v17, s[36:39], s26 offen offset:3072 lds
    v_lshrrev_b32 v119, 5, v1
    v_lshl_add_u32 v118, v119, 7, v118
    s_waitcnt lgkmcnt(4)
    v_mfma_f32_32x32x16_bf16 v[192:207], v[48:51], a[152:155], v[192:207]
    ds_read_b64_tr_b16 v[40:41], v67 offset:35840
    ds_read_b64_tr_b16 v[42:43], v67 offset:37120
    v_add_u32 v118, 0x14000, v118
    v_mfma_f32_32x32x16_bf16 v[128:143], v[52:55], a[156:159], v[128:143]
    ds_read_b64_tr_b16 v[44:45], v68 offset:35840
    ds_read_b64_tr_b16 v[46:47], v68 offset:37120
    v_mov_b32 v104, 0x3f80
    v_mov_b32 v105, 0
    s_waitcnt lgkmcnt(4)
    v_mfma_f32_32x32x16_bf16 v[144:159], v[56:59], a[156:159], v[144:159]
    s_barrier
    ds_read_b128 v[48:51], v74 offset:0
    s_mul_i32 s73, s96, 5
    s_lshr_b32 s73, s73, 2
    v_mfma_f32_32x32x16_bf16 v[160:175], v[60:63], a[156:159], v[160:175]
    ds_read_b128 v[52:55], v75 offset:0
    s_mul_i32 s73, s73, 74
    s_mul_i32 s74, s68, 40
    s_waitcnt lgkmcnt(2)
    v_mfma_f32_32x32x16_bf16 v[176:191], v[40:43], a[156:159], v[176:191]
    ds_read_b128 v[56:59], v76 offset:0
    v_min_u32 v2, 9, v1
    v_lshl_add_u32 v2, v2, 2, s74
    v_mfma_f32_32x32x16_bf16 v[192:207], v[44:47], a[156:159], v[192:207]
    ds_read_b128 v[60:63], v77 offset:0
    v_min_u32 v2, 147, v2
    s_waitcnt lgkmcnt(2)
    v_mfma_f32_32x32x16_bf16 v[128:143], v[48:51], v[36:39], v[128:143]
    ds_read_b128 v[40:43], v78 offset:0
    v_add_u32 v2, s73, v2
    v_bfe_u32 v2, v2, 2, 7
    v_mfma_f32_32x32x16_bf16 v[144:159], v[52:55], v[36:39], v[144:159]
    v_lshlrev_b32 v2, 7, v2
    v_add_u32 v2, 0x8000, v2
    s_waitcnt lgkmcnt(1)
    v_mfma_f32_32x32x16_bf16 v[160:175], v[56:59], v[36:39], v[160:175]
    buffer_load_dword v3, v2, s[40:43], 0 offen sc1
    v_mfma_f32_32x32x16_bf16 v[176:191], v[60:63], v[36:39], v[176:191]
    s_waitcnt lgkmcnt(0)
    v_mfma_f32_32x32x16_bf16 v[192:207], v[40:43], v[36:39], v[192:207]
    s_barrier
    v_cvt_pk_bf16_f32 v64, v128, v129
    v_cvt_pk_bf16_f32 v65, v130, v131
    v_cvt_pk_bf16_f32 v66, v132, v133
    v_cvt_pk_bf16_f32 v67, v134, v135
    v_cvt_pk_bf16_f32 v68, v136, v137
    v_cvt_pk_bf16_f32 v69, v138, v139
    v_cvt_pk_bf16_f32 v70, v140, v141
    v_cvt_pk_bf16_f32 v71, v142, v143
    v_cvt_pk_bf16_f32 v72, v144, v145
    v_cvt_pk_bf16_f32 v73, v146, v147
    v_cvt_pk_bf16_f32 v74, v148, v149
    v_cvt_pk_bf16_f32 v75, v150, v151
    v_cvt_pk_bf16_f32 v76, v152, v153
    v_cvt_pk_bf16_f32 v77, v154, v155
    v_cvt_pk_bf16_f32 v78, v156, v157
    v_cvt_pk_bf16_f32 v79, v158, v159
    v_cvt_pk_bf16_f32 v80, v160, v161
    v_cvt_pk_bf16_f32 v81, v162, v163
    v_cvt_pk_bf16_f32 v82, v164, v165
    v_cvt_pk_bf16_f32 v83, v166, v167
    v_mfma_f32_32x32x16_bf16 v[208:223], a[160:163], v[64:67], 0
    v_mul_f32 v168, v168, v34
    v_mul_f32 v169, v169, v34
    v_mul_f32 v170, v170, v34
    v_mul_f32 v171, v171, v34
    v_cvt_pk_bf16_f32 v84, v168, v169
    v_cvt_pk_bf16_f32 v85, v170, v171
    v_mfma_f32_32x32x16_bf16 v[208:223], a[164:167], v[68:71], v[208:223]
    s_mov_b32 s76, 0x8
    v_mad_i32_i24 v117, v119, s76, v118
    ds_write_b64 v117, v[84:85] offset:96
    v_mul_f32 v172, v172, v34
    v_mul_f32 v173, v173, v34
    v_mul_f32 v174, v174, v34
    v_mfma_f32_32x32x16_bf16 v[208:223], a[168:171], v[72:75], v[208:223]
    v_mul_f32 v175, v175, v34
    v_cvt_pk_bf16_f32 v86, v172, v173
    v_cvt_pk_bf16_f32 v87, v174, v175
    s_mov_b32 s76, 0x8
    v_mad_i32_i24 v117, v119, s76, v118
    ds_write_b64 v117, v[86:87] offset:104
    v_mfma_f32_32x32x16_bf16 v[224:239], a[172:175], v[64:67], 0
    v_mul_f32 v176, v176, v34
    v_mul_f32 v177, v177, v34
    v_mul_f32 v178, v178, v34
    v_mul_f32 v179, v179, v34
    v_cvt_pk_bf16_f32 v88, v176, v177
    v_cvt_pk_bf16_f32 v89, v178, v179
    v_mfma_f32_32x32x16_bf16 v[224:239], a[176:179], v[68:71], v[224:239]
    s_mov_b32 s76, 0xfffffff0
    v_mad_i32_i24 v117, v119, s76, v118
    ds_write_b64 v117, v[88:89] offset:112
    v_mul_f32 v180, v180, v34
    v_mul_f32 v181, v181, v34
    v_mul_f32 v182, v182, v34
    v_mfma_f32_32x32x16_bf16 v[224:239], a[180:183], v[72:75], v[224:239]
    v_mul_f32 v183, v183, v34
    v_cvt_pk_bf16_f32 v90, v180, v181
    v_cvt_pk_bf16_f32 v91, v182, v183
    s_mov_b32 s76, 0xfffffff8
    v_mad_i32_i24 v117, v119, s76, v118
    ds_write_b64 v117, v[90:91] offset:360
    v_mfma_f32_32x32x16_bf16 v[224:239], a[184:187], v[76:79], v[224:239]
    v_mul_f32 v184, v184, v34
    v_mul_f32 v185, v185, v34
    v_mul_f32 v186, v186, v34
    v_mul_f32 v187, v187, v34
    v_cvt_pk_bf16_f32 v92, v184, v185
    v_cvt_pk_bf16_f32 v93, v186, v187
    v_mfma_f32_32x32x16_bf16 v[224:239], a[188:191], v[80:83], v[224:239]
    s_mov_b32 s76, 0xfffffff8
    v_mad_i32_i24 v117, v119, s76, v118
    ds_write_b64 v117, v[92:93] offset:368
    v_mul_f32 v188, v188, v34
    v_mul_f32 v189, v189, v34
    v_mul_f32 v190, v190, v34
    v_mfma_f32_32x32x16_bf16 v[240:255], a[192:195], v[72:75], 0
    v_mul_f32 v191, v191, v34
    v_cvt_pk_bf16_f32 v94, v188, v189
    v_cvt_pk_bf16_f32 v95, v190, v191
    s_mov_b32 s76, 0x120
    v_mad_i32_i24 v117, v119, s76, v118
    ds_write_b64 v117, v[94:95] offset:80
    v_mfma_f32_32x32x16_bf16 v[240:255], a[196:199], v[76:79], v[240:255]
    v_mul_f32 v192, v192, v34
    v_mul_f32 v193, v193, v34
    v_mul_f32 v194, v194, v34
    v_mul_f32 v195, v195, v34
    v_cvt_pk_bf16_f32 v96, v192, v193
    v_cvt_pk_bf16_f32 v97, v194, v195
    v_mfma_f32_32x32x16_bf16 v[240:255], a[200:203], v[80:83], v[240:255]
    s_mov_b32 s76, 0xfffffff8
    v_mad_i32_i24 v117, v119, s76, v118
    ds_write_b64 v117, v[96:97] offset:88
    v_mul_f32 v196, v196, v34
    v_mul_f32 v197, v197, v34
    v_mul_f32 v198, v198, v34
    v_mul_f32 v199, v199, v34
    v_cvt_pk_bf16_f32 v98, v196, v197
    v_cvt_pk_bf16_f32 v99, v198, v199
    s_mov_b32 s76, 0xfffffef8
    v_mad_i32_i24 v117, v119, s76, v118
    ds_write_b64 v117, v[98:99] offset:352
    v_mul_f32 v200, v200, v34
    v_mul_f32 v201, v201, v34
    v_mul_f32 v202, v202, v34
    v_mul_f32 v203, v203, v34
    v_cvt_pk_bf16_f32 v100, v200, v201
    v_cvt_pk_bf16_f32 v101, v202, v203
    ds_write_b64 v118, v[100:101] offset:336
    v_mul_f32 v204, v204, v34
    v_mul_f32 v205, v205, v34
    v_mul_f32 v206, v206, v34
    v_mul_f32 v207, v207, v34
    v_cvt_pk_bf16_f32 v102, v204, v205
    v_cvt_pk_bf16_f32 v103, v206, v207
    ds_write_b64 v118, v[102:103] offset:344
    ds_write_b64 v118, v[104:105] offset:120
    ds_write_b64 v118, v[104:105] offset:376
    s_waitcnt vmcnt(0)
    v_cmp_ne_u32 vcc, s72, v3
    s_nop 4
    s_cbranch_vccnz Lslow6
Lback6:
    s_barrier
    v_max3_f32 v124, v208, v209, v210
    v_min3_f32 v126, v208, v209, v210
    v_max3_f32 v124, v124, v211, v212
    v_min3_f32 v126, v126, v211, v212
    v_max3_f32 v124, v124, v213, v214
    v_min3_f32 v126, v126, v213, v214
    v_max3_f32 v124, v124, v215, v216
    v_min3_f32 v126, v126, v215, v216
    v_max3_f32 v124, v124, v217, v218
    v_min3_f32 v126, v126, v217, v218
    v_max3_f32 v124, v124, v219, v220
    v_min3_f32 v126, v126, v219, v220
    v_max3_f32 v124, v124, v221, v222
    v_min3_f32 v126, v126, v221, v222
    v_max3_f32 v124, v124, v223, v224
    v_min3_f32 v126, v126, v223, v224
    v_add_u32 v7, 2048, v6
    global_load_dwordx4 a[160:163], v7, s[40:41] offset:-2048 sc1
    v_max3_f32 v124, v124, v225, v226
    v_min3_f32 v126, v126, v225, v226
    v_max_f32 v124, v124, v227
    v_min_f32 v126, v126, v227
    v_mul_f32 v124, v124, v33
    v_mul_f32 v126, v126, v33
    v_mov_b32 v122, v33
    v_pk_fma_f32 v[84:85], v[208:209], v[122:123], v[126:127] op_sel_hi:[1,0,0] neg_lo:[0,1,0] neg_hi:[0,1,0]
    v_pk_fma_f32 v[64:65], v[208:209], v[122:123], v[124:125] op_sel_hi:[1,0,0] neg_lo:[0,0,1] neg_hi:[0,0,1]
    v_pk_fma_f32 v[86:87], v[210:211], v[122:123], v[126:127] op_sel_hi:[1,0,0] neg_lo:[0,1,0] neg_hi:[0,1,0]
    v_pk_fma_f32 v[66:67], v[210:211], v[122:123], v[124:125] op_sel_hi:[1,0,0] neg_lo:[0,0,1] neg_hi:[0,0,1]
    v_pk_fma_f32 v[88:89], v[212:213], v[122:123], v[126:127] op_sel_hi:[1,0,0] neg_lo:[0,1,0] neg_hi:[0,1,0]
    v_pk_fma_f32 v[68:69], v[212:213], v[122:123], v[124:125] op_sel_hi:[1,0,0] neg_lo:[0,0,1] neg_hi:[0,0,1]
    v_pk_fma_f32 v[90:91], v[214:215], v[122:123], v[126:127] op_sel_hi:[1,0,0] neg_lo:[0,1,0] neg_hi:[0,1,0]
    v_pk_fma_f32 v[70:71], v[214:215], v[122:123], v[124:125] op_sel_hi:[1,0,0] neg_lo:[0,0,1] neg_hi:[0,0,1]
    global_load_dwordx4 a[164:167], v7, s[40:41] offset:-1024 sc1
    v_pk_fma_f32 v[92:93], v[216:217], v[122:123], v[126:127] op_sel_hi:[1,0,0] neg_lo:[0,1,0] neg_hi:[0,1,0]
    v_pk_fma_f32 v[72:73], v[216:217], v[122:123], v[124:125] op_sel_hi:[1,0,0] neg_lo:[0,0,1] neg_hi:[0,0,1]
    v_pk_fma_f32 v[94:95], v[218:219], v[122:123], v[126:127] op_sel_hi:[1,0,0] neg_lo:[0,1,0] neg_hi:[0,1,0]
    v_pk_fma_f32 v[74:75], v[218:219], v[122:123], v[124:125] op_sel_hi:[1,0,0] neg_lo:[0,0,1] neg_hi:[0,0,1]
    v_pk_fma_f32 v[96:97], v[220:221], v[122:123], v[126:127] op_sel_hi:[1,0,0] neg_lo:[0,1,0] neg_hi:[0,1,0]
    v_pk_fma_f32 v[76:77], v[220:221], v[122:123], v[124:125] op_sel_hi:[1,0,0] neg_lo:[0,0,1] neg_hi:[0,0,1]
    v_pk_fma_f32 v[98:99], v[222:223], v[122:123], v[126:127] op_sel_hi:[1,0,0] neg_lo:[0,1,0] neg_hi:[0,1,0]
    v_pk_fma_f32 v[78:79], v[222:223], v[122:123], v[124:125] op_sel_hi:[1,0,0] neg_lo:[0,0,1] neg_hi:[0,0,1]
    v_pk_fma_f32 v[100:101], v[224:225], v[122:123], v[126:127] op_sel_hi:[1,0,0] neg_lo:[0,1,0] neg_hi:[0,1,0]
    v_pk_fma_f32 v[80:81], v[224:225], v[122:123], v[124:125] op_sel_hi:[1,0,0] neg_lo:[0,0,1] neg_hi:[0,0,1]
    v_pk_fma_f32 v[102:103], v[226:227], v[122:123], v[126:127] op_sel_hi:[1,0,0] neg_lo:[0,1,0] neg_hi:[0,1,0]
    v_pk_fma_f32 v[82:83], v[226:227], v[122:123], v[124:125] op_sel_hi:[1,0,0] neg_lo:[0,0,1] neg_hi:[0,0,1]
    v_exp_f32 v64, v64
    v_exp_f32 v84, v84
    global_load_dwordx4 a[168:171], v7, s[40:41] offset:0 sc1
    v_exp_f32 v65, v65
    v_exp_f32 v85, v85
    v_exp_f32 v66, v66
    v_exp_f32 v86, v86
    v_exp_f32 v67, v67
    v_exp_f32 v87, v87
    v_exp_f32 v68, v68
    global_load_dwordx4 a[172:175], v7, s[40:41] offset:1024 sc1
    v_exp_f32 v88, v88
    v_exp_f32 v69, v69
    v_exp_f32 v89, v89
    v_exp_f32 v70, v70
    v_exp_f32 v90, v90
    v_exp_f32 v71, v71
    v_exp_f32 v91, v91
    v_exp_f32 v72, v72
    global_load_dwordx4 a[176:179], v7, s[40:41] offset:2048 sc1
    v_exp_f32 v92, v92
    v_exp_f32 v73, v73
    v_exp_f32 v93, v93
    v_exp_f32 v74, v74
    v_exp_f32 v94, v94
    v_exp_f32 v75, v75
    v_exp_f32 v95, v95
    v_exp_f32 v76, v76
    v_add_u32 v7, 22528, v6
    global_load_dwordx4 a[180:183], v7, s[40:41] offset:-2048 sc1
    v_exp_f32 v96, v96
    v_exp_f32 v77, v77
    v_exp_f32 v97, v97
    v_exp_f32 v78, v78
    v_exp_f32 v98, v98
    v_exp_f32 v79, v79
    v_exp_f32 v99, v99
    global_load_dwordx4 a[184:187], v7, s[40:41] offset:-1024 sc1
    v_exp_f32 v80, v80
    v_exp_f32 v100, v100
    v_exp_f32 v81, v81
    v_exp_f32 v101, v101
    v_exp_f32 v82, v82
    v_exp_f32 v102, v102
    v_exp_f32 v83, v83
    v_exp_f32 v103, v103
    global_load_dwordx4 a[188:191], v7, s[40:41] offset:0 sc1
    v_pk_add_f32 v[124:125], v[64:65], v[66:67]
    v_pk_add_f32 v[126:127], v[84:85], v[86:87]
    v_pk_add_f32 v[124:125], v[124:125], v[68:69]
    v_pk_add_f32 v[126:127], v[126:127], v[88:89]
    v_pk_add_f32 v[124:125], v[124:125], v[70:71]
    v_pk_add_f32 v[126:127], v[126:127], v[90:91]
    v_pk_add_f32 v[124:125], v[124:125], v[72:73]
    v_pk_add_f32 v[126:127], v[126:127], v[92:93]
    v_pk_add_f32 v[124:125], v[124:125], v[74:75]
    v_pk_add_f32 v[126:127], v[126:127], v[94:95]
    v_pk_add_f32 v[124:125], v[124:125], v[76:77]
    v_pk_add_f32 v[126:127], v[126:127], v[96:97]
    v_pk_add_f32 v[124:125], v[124:125], v[78:79]
    v_pk_add_f32 v[126:127], v[126:127], v[98:99]
    v_pk_add_f32 v[124:125], v[124:125], v[80:81]
    global_load_dwordx4 a[192:195], v7, s[40:41] offset:1024 sc1
    v_pk_add_f32 v[126:127], v[126:127], v[100:101]
    v_pk_add_f32 v[124:125], v[124:125], v[82:83]
    v_pk_add_f32 v[126:127], v[126:127], v[102:103]
    v_add_f32 v124, v124, v125
    v_add_f32 v126, v126, v127
    v_rcp_f32 v124, v124
    v_rcp_f32 v126, v126
    v_pk_mul_f32 v[64:65], v[64:65], v[124:125] op_sel_hi:[1,0]
    v_pk_mul_f32 v[84:85], v[84:85], v[126:127] op_sel_hi:[1,0]
    v_pk_mul_f32 v[66:67], v[66:67], v[124:125] op_sel_hi:[1,0]
    v_pk_mul_f32 v[86:87], v[86:87], v[126:127] op_sel_hi:[1,0]
    v_pk_mul_f32 v[68:69], v[68:69], v[124:125] op_sel_hi:[1,0]
    v_pk_mul_f32 v[88:89], v[88:89], v[126:127] op_sel_hi:[1,0]
    global_load_dwordx4 a[196:199], v7, s[40:41] offset:2048 sc1
    v_pk_mul_f32 v[70:71], v[70:71], v[124:125] op_sel_hi:[1,0]
    v_pk_mul_f32 v[90:91], v[90:91], v[126:127] op_sel_hi:[1,0]
    v_pk_mul_f32 v[72:73], v[72:73], v[124:125] op_sel_hi:[1,0]
    v_pk_mul_f32 v[92:93], v[92:93], v[126:127] op_sel_hi:[1,0]
    v_pk_mul_f32 v[74:75], v[74:75], v[124:125] op_sel_hi:[1,0]
    v_pk_mul_f32 v[94:95], v[94:95], v[126:127] op_sel_hi:[1,0]
    v_pk_mul_f32 v[76:77], v[76:77], v[124:125] op_sel_hi:[1,0]
    v_pk_mul_f32 v[96:97], v[96:97], v[126:127] op_sel_hi:[1,0]
    v_pk_mul_f32 v[78:79], v[78:79], v[124:125] op_sel_hi:[1,0]
    v_pk_mul_f32 v[98:99], v[98:99], v[126:127] op_sel_hi:[1,0]
    v_pk_mul_f32 v[80:81], v[80:81], v[124:125] op_sel_hi:[1,0]
    v_pk_mul_f32 v[100:101], v[100:101], v[126:127] op_sel_hi:[1,0]
    v_pk_mul_f32 v[82:83], v[82:83], v[124:125] op_sel_hi:[1,0]
    v_pk_mul_f32 v[102:103], v[102:103], v[126:127] op_sel_hi:[1,0]
    v_cvt_pk_bf16_f32 v40, v64, v65
    v_add_u32 v7, 43008, v6
    global_load_dwordx4 a[200:203], v7, s[40:41] offset:-2048 sc1
    v_cvt_pk_bf16_f32 v41, v66, v67
    v_cvt_pk_bf16_f32 v42, v68, v69
    v_cvt_pk_bf16_f32 v43, v70, v71
    v_cvt_pk_bf16_f32 v44, v72, v73
    v_cvt_pk_bf16_f32 v45, v74, v75
    v_cvt_pk_bf16_f32 v46, v76, v77
    v_cvt_pk_bf16_f32 v47, v78, v79
    v_cvt_pk_bf16_f32 v48, v80, v81
    v_cvt_pk_bf16_f32 v49, v82, v83
    v_cvt_pk_bf16_f32 v50, v84, v85
    v_cvt_pk_bf16_f32 v51, v86, v87
    v_cvt_pk_bf16_f32 v52, v88, v89
    v_cvt_pk_bf16_f32 v53, v90, v91
    v_cvt_pk_bf16_f32 v54, v92, v93
    v_cvt_pk_bf16_f32 v55, v94, v95
    global_load_dwordx4 a[204:207], v7, s[40:41] offset:-1024 sc1
    v_cvt_pk_bf16_f32 v56, v96, v97
    v_cvt_pk_bf16_f32 v57, v98, v99
    v_cvt_pk_bf16_f32 v58, v100, v101
    v_cvt_pk_bf16_f32 v59, v102, v103
    ds_write_b128 v118, v[40:43] offset:0
    ds_write_b128 v118, v[44:47] offset:16
    ds_write_b128 v118, v[48:51] offset:32
    ds_write_b128 v118, v[52:55] offset:48
    ds_write_b128 v118, v[56:59] offset:64
    v_max3_f32 v124, v228, v229, v230
    v_min3_f32 v126, v228, v229, v230
    v_max3_f32 v124, v124, v231, v232
    v_min3_f32 v126, v126, v231, v232
    v_max3_f32 v124, v124, v233, v234
    global_load_dwordx4 a[208:211], v7, s[40:41] offset:0 sc1
    v_min3_f32 v126, v126, v233, v234
    v_max3_f32 v124, v124, v235, v236
    v_min3_f32 v126, v126, v235, v236
    v_max3_f32 v124, v124, v237, v238
    v_min3_f32 v126, v126, v237, v238
    v_max3_f32 v124, v124, v239, v240
    v_min3_f32 v126, v126, v239, v240
    v_max3_f32 v124, v124, v241, v242
    v_min3_f32 v126, v126, v241, v242
    v_max3_f32 v124, v124, v243, v244
    v_min3_f32 v126, v126, v243, v244
    v_max3_f32 v124, v124, v245, v246
    v_min3_f32 v126, v126, v245, v246
    v_max_f32 v124, v124, v247
    v_min_f32 v126, v126, v247
    global_load_dwordx4 a[212:215], v7, s[40:41] offset:1024 sc1
    v_mul_f32 v124, v124, v33
    v_mul_f32 v126, v126, v33
    v_mov_b32 v122, v33
    v_pk_fma_f32 v[84:85], v[228:229], v[122:123], v[126:127] op_sel_hi:[1,0,0] neg_lo:[0,1,0] neg_hi:[0,1,0]
    v_pk_fma_f32 v[64:65], v[228:229], v[122:123], v[124:125] op_sel_hi:[1,0,0] neg_lo:[0,0,1] neg_hi:[0,0,1]
    v_pk_fma_f32 v[86:87], v[230:231], v[122:123], v[126:127] op_sel_hi:[1,0,0] neg_lo:[0,1,0] neg_hi:[0,1,0]
    v_pk_fma_f32 v[66:67], v[230:231], v[122:123], v[124:125] op_sel_hi:[1,0,0] neg_lo:[0,0,1] neg_hi:[0,0,1]
    v_pk_fma_f32 v[88:89], v[232:233], v[122:123], v[126:127] op_sel_hi:[1,0,0] neg_lo:[0,1,0] neg_hi:[0,1,0]
    v_pk_fma_f32 v[68:69], v[232:233], v[122:123], v[124:125] op_sel_hi:[1,0,0] neg_lo:[0,0,1] neg_hi:[0,0,1]
    v_pk_fma_f32 v[90:91], v[234:235], v[122:123], v[126:127] op_sel_hi:[1,0,0] neg_lo:[0,1,0] neg_hi:[0,1,0]
    v_pk_fma_f32 v[70:71], v[234:235], v[122:123], v[124:125] op_sel_hi:[1,0,0] neg_lo:[0,0,1] neg_hi:[0,0,1]
    v_pk_fma_f32 v[92:93], v[236:237], v[122:123], v[126:127] op_sel_hi:[1,0,0] neg_lo:[0,1,0] neg_hi:[0,1,0]
    v_pk_fma_f32 v[72:73], v[236:237], v[122:123], v[124:125] op_sel_hi:[1,0,0] neg_lo:[0,0,1] neg_hi:[0,0,1]
    v_pk_fma_f32 v[94:95], v[238:239], v[122:123], v[126:127] op_sel_hi:[1,0,0] neg_lo:[0,1,0] neg_hi:[0,1,0]
    v_pk_fma_f32 v[74:75], v[238:239], v[122:123], v[124:125] op_sel_hi:[1,0,0] neg_lo:[0,0,1] neg_hi:[0,0,1]
    global_load_dwordx4 a[216:219], v7, s[40:41] offset:2048 sc1
    v_pk_fma_f32 v[96:97], v[240:241], v[122:123], v[126:127] op_sel_hi:[1,0,0] neg_lo:[0,1,0] neg_hi:[0,1,0]
    v_pk_fma_f32 v[76:77], v[240:241], v[122:123], v[124:125] op_sel_hi:[1,0,0] neg_lo:[0,0,1] neg_hi:[0,0,1]
    v_pk_fma_f32 v[98:99], v[242:243], v[122:123], v[126:127] op_sel_hi:[1,0,0] neg_lo:[0,1,0] neg_hi:[0,1,0]
    v_pk_fma_f32 v[78:79], v[242:243], v[122:123], v[124:125] op_sel_hi:[1,0,0] neg_lo:[0,0,1] neg_hi:[0,0,1]
    v_pk_fma_f32 v[100:101], v[244:245], v[122:123], v[126:127] op_sel_hi:[1,0,0] neg_lo:[0,1,0] neg_hi:[0,1,0]
    v_pk_fma_f32 v[80:81], v[244:245], v[122:123], v[124:125] op_sel_hi:[1,0,0] neg_lo:[0,0,1] neg_hi:[0,0,1]
    v_pk_fma_f32 v[102:103], v[246:247], v[122:123], v[126:127] op_sel_hi:[1,0,0] neg_lo:[0,1,0] neg_hi:[0,1,0]
    v_pk_fma_f32 v[82:83], v[246:247], v[122:123], v[124:125] op_sel_hi:[1,0,0] neg_lo:[0,0,1] neg_hi:[0,0,1]
    v_exp_f32 v64, v64
    v_exp_f32 v84, v84
    v_exp_f32 v65, v65
    v_exp_f32 v85, v85
    v_add_u32 v7, 63488, v6
    global_load_dwordx4 a[220:223], v7, s[40:41] offset:-2048 sc1
    v_exp_f32 v66, v66
    v_exp_f32 v86, v86
    v_exp_f32 v67, v67
    v_exp_f32 v87, v87
    v_exp_f32 v68, v68
    v_exp_f32 v88, v88
    v_exp_f32 v69, v69
    v_exp_f32 v89, v89
    global_load_dwordx4 a[224:227], v7, s[40:41] offset:-1024 sc1
    v_exp_f32 v70, v70
    v_exp_f32 v90, v90
    v_exp_f32 v71, v71
    v_exp_f32 v91, v91
    v_exp_f32 v72, v72
    v_exp_f32 v92, v92
    v_exp_f32 v73, v73
    global_load_dwordx4 a[228:231], v7, s[40:41] offset:0 sc1
    v_exp_f32 v93, v93
    v_exp_f32 v74, v74
    v_exp_f32 v94, v94
    v_exp_f32 v75, v75
    v_exp_f32 v95, v95
    v_exp_f32 v76, v76
    v_exp_f32 v96, v96
    v_exp_f32 v77, v77
    global_load_dwordx4 a[232:235], v7, s[40:41] offset:1024 sc1
    v_exp_f32 v97, v97
    v_exp_f32 v78, v78
    v_exp_f32 v98, v98
    v_exp_f32 v79, v79
    v_exp_f32 v99, v99
    v_exp_f32 v80, v80
    v_exp_f32 v100, v100
    v_exp_f32 v81, v81
    global_load_dwordx4 a[236:239], v7, s[40:41] offset:2048 sc1
    v_exp_f32 v101, v101
    v_exp_f32 v82, v82
    v_exp_f32 v102, v102
    v_exp_f32 v83, v83
    v_exp_f32 v103, v103
    v_pk_add_f32 v[124:125], v[64:65], v[66:67]
    v_pk_add_f32 v[126:127], v[84:85], v[86:87]
    v_pk_add_f32 v[124:125], v[124:125], v[68:69]
    v_pk_add_f32 v[126:127], v[126:127], v[88:89]
    v_add_u32 v7, 83968, v6
    global_load_dwordx4 v[128:131], v7, s[40:41] offset:-2048 sc1
    v_pk_add_f32 v[124:125], v[124:125], v[70:71]
    v_pk_add_f32 v[126:127], v[126:127], v[90:91]
    v_pk_add_f32 v[124:125], v[124:125], v[72:73]
    v_pk_add_f32 v[126:127], v[126:127], v[92:93]
    v_pk_add_f32 v[124:125], v[124:125], v[74:75]
    v_pk_add_f32 v[126:127], v[126:127], v[94:95]
    v_pk_add_f32 v[124:125], v[124:125], v[76:77]
    v_pk_add_f32 v[126:127], v[126:127], v[96:97]
    v_pk_add_f32 v[124:125], v[124:125], v[78:79]
    v_pk_add_f32 v[126:127], v[126:127], v[98:99]
    v_pk_add_f32 v[124:125], v[124:125], v[80:81]
    v_pk_add_f32 v[126:127], v[126:127], v[100:101]
    v_pk_add_f32 v[124:125], v[124:125], v[82:83]
    v_pk_add_f32 v[126:127], v[126:127], v[102:103]
    v_add_f32 v124, v124, v125
    global_load_dwordx4 v[132:135], v7, s[40:41] offset:-1024 sc1
    v_add_f32 v126, v126, v127
    v_rcp_f32 v124, v124
    v_rcp_f32 v126, v126
    v_pk_mul_f32 v[64:65], v[64:65], v[124:125] op_sel_hi:[1,0]
    v_pk_mul_f32 v[84:85], v[84:85], v[126:127] op_sel_hi:[1,0]
    v_pk_mul_f32 v[66:67], v[66:67], v[124:125] op_sel_hi:[1,0]
    v_pk_mul_f32 v[86:87], v[86:87], v[126:127] op_sel_hi:[1,0]
    v_pk_mul_f32 v[68:69], v[68:69], v[124:125] op_sel_hi:[1,0]
    v_pk_mul_f32 v[88:89], v[88:89], v[126:127] op_sel_hi:[1,0]
    v_pk_mul_f32 v[70:71], v[70:71], v[124:125] op_sel_hi:[1,0]
    v_pk_mul_f32 v[90:91], v[90:91], v[126:127] op_sel_hi:[1,0]
    v_pk_mul_f32 v[72:73], v[72:73], v[124:125] op_sel_hi:[1,0]
    v_pk_mul_f32 v[92:93], v[92:93], v[126:127] op_sel_hi:[1,0]
    global_load_dwordx4 v[136:139], v7, s[40:41] offset:0 sc1
    v_pk_mul_f32 v[74:75], v[74:75], v[124:125] op_sel_hi:[1,0]
    v_pk_mul_f32 v[94:95], v[94:95], v[126:127] op_sel_hi:[1,0]
    v_pk_mul_f32 v[76:77], v[76:77], v[124:125] op_sel_hi:[1,0]
    v_pk_mul_f32 v[96:97], v[96:97], v[126:127] op_sel_hi:[1,0]
    v_pk_mul_f32 v[78:79], v[78:79], v[124:125] op_sel_hi:[1,0]
    v_pk_mul_f32 v[98:99], v[98:99], v[126:127] op_sel_hi:[1,0]
    v_pk_mul_f32 v[80:81], v[80:81], v[124:125] op_sel_hi:[1,0]
    v_pk_mul_f32 v[100:101], v[100:101], v[126:127] op_sel_hi:[1,0]
    v_pk_mul_f32 v[82:83], v[82:83], v[124:125] op_sel_hi:[1,0]
    v_pk_mul_f32 v[102:103], v[102:103], v[126:127] op_sel_hi:[1,0]
    v_cvt_pk_bf16_f32 v40, v64, v65
    v_cvt_pk_bf16_f32 v41, v66, v67
    v_cvt_pk_bf16_f32 v42, v68, v69
    v_cvt_pk_bf16_f32 v43, v70, v71
    v_cvt_pk_bf16_f32 v44, v72, v73
    v_cvt_pk_bf16_f32 v45, v74, v75
    global_load_dwordx4 v[140:143], v7, s[40:41] offset:1024 sc1
    v_cvt_pk_bf16_f32 v46, v76, v77
    v_cvt_pk_bf16_f32 v47, v78, v79
    v_cvt_pk_bf16_f32 v48, v80, v81
    v_cvt_pk_bf16_f32 v49, v82, v83
    v_cvt_pk_bf16_f32 v50, v84, v85
    v_cvt_pk_bf16_f32 v51, v86, v87
    v_cvt_pk_bf16_f32 v52, v88, v89
    v_cvt_pk_bf16_f32 v53, v90, v91
    v_cvt_pk_bf16_f32 v54, v92, v93
    v_cvt_pk_bf16_f32 v55, v94, v95
    v_cvt_pk_bf16_f32 v56, v96, v97
    v_cvt_pk_bf16_f32 v57, v98, v99
    v_cvt_pk_bf16_f32 v58, v100, v101
    v_cvt_pk_bf16_f32 v59, v102, v103
    ds_write_b128 v118, v[40:43] offset:256
    global_load_dwordx4 v[144:147], v7, s[40:41] offset:2048 sc1
    ds_write_b128 v118, v[44:47] offset:272
    ds_write_b128 v118, v[48:51] offset:288
    ds_write_b128 v118, v[52:55] offset:304
    ds_write_b128 v118, v[56:59] offset:320
    v_lshrrev_b32 v60, 5, v1
    v_bfe_u32 v61, v1, 4, 1
    v_lshlrev_b32 v60, 4, v60
    v_lshl_add_u32 v60, v61, 2, v60
    v_bfe_u32 v61, v1, 2, 2
    v_add_u32 v60, v60, v61
    v_mul_u32_u24 v60, 544, v60
    s_lshl_b32 s73, s68, 7
    s_add_u32 s73, s73, 0x14000
    v_add_u32 v60, s73, v60
    v_and_b32 v62, 3, v1
    v_lshl_add_u32 v61, v62, 3, v60
    v_lshl_add_u32 v60, v62, 4, v60
    s_waitcnt lgkmcnt(0)
    s_barrier
    ds_read_b64_tr_b16 v[40:41], v60 offset:0
    ds_read_b64_tr_b16 v[42:43], v60 offset:4352
    ds_read_b64_tr_b16 v[44:45], v60 offset:8
    ds_read_b64_tr_b16 v[46:47], v60 offset:4360
    v_add_u32 v7, 104448, v6
    global_load_dwordx4 v[148:151], v7, s[40:41] offset:-2048 sc1
    ds_read_b64_tr_b16 v[48:49], v61 offset:64
    ds_read_b64_tr_b16 v[50:51], v61 offset:4416
    ds_read_b64_tr_b16 v[52:53], v61 offset:80
    ds_read_b64_tr_b16 v[54:55], v61 offset:4432
    ds_read_b64_tr_b16 v[56:57], v61 offset:112
    ds_read_b64_tr_b16 v[58:59], v61 offset:4464
    global_load_dwordx4 v[152:155], v7, s[40:41] offset:-1024 sc1
    ds_read_b64_tr_b16 v[64:65], v60 offset:17408
    ds_read_b64_tr_b16 v[66:67], v60 offset:21760
    ds_read_b64_tr_b16 v[68:69], v60 offset:17416
    ds_read_b64_tr_b16 v[70:71], v60 offset:21768
    global_load_dwordx4 v[156:159], v7, s[40:41] offset:0 sc1
    ds_read_b64_tr_b16 v[72:73], v61 offset:17472
    ds_read_b64_tr_b16 v[74:75], v61 offset:21824
    ds_read_b64_tr_b16 v[76:77], v61 offset:17488
    ds_read_b64_tr_b16 v[78:79], v61 offset:21840
    ds_read_b64_tr_b16 v[80:81], v61 offset:17520
    ds_read_b64_tr_b16 v[82:83], v61 offset:21872
    global_load_dwordx4 v[160:163], v7, s[40:41] offset:1024 sc1
    ds_read_b64_tr_b16 v[84:85], v60 offset:34816
    ds_read_b64_tr_b16 v[86:87], v60 offset:39168
    ds_read_b64_tr_b16 v[88:89], v60 offset:34824
    ds_read_b64_tr_b16 v[90:91], v60 offset:39176
    global_load_dwordx4 v[164:167], v7, s[40:41] offset:2048 sc1
    ds_read_b64_tr_b16 v[92:93], v61 offset:34880
    ds_read_b64_tr_b16 v[94:95], v61 offset:39232
    ds_read_b64_tr_b16 v[96:97], v61 offset:34896
    ds_read_b64_tr_b16 v[98:99], v61 offset:39248
    ds_read_b64_tr_b16 v[100:101], v61 offset:34928
    ds_read_b64_tr_b16 v[102:103], v61 offset:39280
    ds_read_b64_tr_b16 v[104:105], v60 offset:52224
    ds_read_b64_tr_b16 v[106:107], v60 offset:56576
    ds_read_b64_tr_b16 v[108:109], v60 offset:52232
    ds_read_b64_tr_b16 v[110:111], v60 offset:56584
    ds_read_b64_tr_b16 v[112:113], v61 offset:52288
    ds_read_b64_tr_b16 v[114:115], v61 offset:56640
    ds_read_b64_tr_b16 v[116:117], v61 offset:52304
    ds_read_b64_tr_b16 v[118:119], v61 offset:56656
    ds_read_b64_tr_b16 v[120:121], v61 offset:52336
    ds_read_b64_tr_b16 v[122:123], v61 offset:56688
    s_waitcnt lgkmcnt(15)
    v_mfma_f32_16x16x32_bf16 v[208:211], v[40:43], v[52:55], 0
    v_add_u32 v7, 124928, v6
    global_load_dwordx4 v[168:171], v7, s[40:41] offset:-2048 sc1
    v_mfma_f32_16x16x32_bf16 v[212:215], v[44:47], v[52:55], 0
    s_lshl_b32 s73, s70, 2
    s_add_u32 s73, s73, s68
    v_mfma_f32_16x16x32_bf16 v[216:219], v[48:51], v[52:55], 0
    s_lshl_b32 s73, s73, 4
    s_add_u32 s73, s73, s69
    v_mfma_f32_16x16x32_bf16 v[220:223], v[40:43], v[56:59], 0
    s_lshl_b32 s73, s73, 11
    s_add_u32 s73, s73, 0x100000
    v_mfma_f32_16x16x32_bf16 v[224:227], v[44:47], v[56:59], 0
    global_load_dwordx4 v[172:175], v7, s[40:41] offset:-1024 sc1
    v_lshlrev_b32 v232, 4, v1
    v_mfma_f32_16x16x32_bf16 v[228:231], v[48:51], v[56:59], 0
    v_lshrrev_b32 v233, 4, v1
    v_and_b32 v234, 15, v1
    v_mfma_f32_16x16x32_bf16 v[208:211], v[64:67], v[76:79], v[208:211]
    v_lshl_add_u32 v233, v233, 3, v234
    v_mov_b32 v235, 0x80000000
    v_mfma_f32_16x16x32_bf16 v[212:215], v[68:71], v[76:79], v[212:215]
    v_cmp_gt_u32 vcc, 8, v234
    v_lshlrev_b32 v236, 4, v233
    v_mfma_f32_16x16x32_bf16 v[216:219], v[72:75], v[76:79], v[216:219]
    v_lshlrev_b32 v237, 3, v233
    v_cndmask_b32 v236, v235, v236, vcc
    v_mfma_f32_16x16x32_bf16 v[220:223], v[64:67], v[80:83], v[220:223]
    global_load_dwordx4 v[176:179], v7, s[40:41] offset:0 sc1
    v_cndmask_b32 v237, v235, v237, vcc
    v_mfma_f32_16x16x32_bf16 v[224:227], v[68:71], v[80:83], v[224:227]
    v_cmp_gt_u32 vcc, 32, v1
    v_lshlrev_b32 v238, 3, v1
    v_mfma_f32_16x16x32_bf16 v[228:231], v[72:75], v[80:83], v[228:231]
    s_nop 0
    v_cndmask_b32 v237, v235, v237, vcc
    s_waitcnt lgkmcnt(12)
    v_mfma_f32_16x16x32_bf16 v[208:211], v[84:87], v[96:99], v[208:211]
    v_cndmask_b32 v238, v235, v238, vcc
    v_mfma_f32_16x16x32_bf16 v[212:215], v[88:91], v[96:99], v[212:215]
    v_mfma_f32_16x16x32_bf16 v[216:219], v[92:95], v[96:99], v[216:219]
    global_load_dwordx4 v[180:183], v7, s[40:41] offset:1024 sc1
    s_waitcnt lgkmcnt(10)
    v_mfma_f32_16x16x32_bf16 v[220:223], v[84:87], v[100:103], v[220:223]
    v_mfma_f32_16x16x32_bf16 v[224:227], v[88:91], v[100:103], v[224:227]
    v_mfma_f32_16x16x32_bf16 v[228:231], v[92:95], v[100:103], v[228:231]
    s_waitcnt lgkmcnt(2)
    v_mfma_f32_16x16x32_bf16 v[208:211], v[104:107], v[116:119], v[208:211]
    v_mfma_f32_16x16x32_bf16 v[212:215], v[108:111], v[116:119], v[212:215]
    global_load_dwordx4 v[184:187], v7, s[40:41] offset:2048 sc1
    v_mfma_f32_16x16x32_bf16 v[216:219], v[112:115], v[116:119], v[216:219]
    s_waitcnt lgkmcnt(0)
    v_mfma_f32_16x16x32_bf16 v[220:223], v[104:107], v[120:123], v[220:223]
    v_mfma_f32_16x16x32_bf16 v[224:227], v[108:111], v[120:123], v[224:227]
    v_mfma_f32_16x16x32_bf16 v[228:231], v[112:115], v[120:123], v[228:231]
    s_nop 0
    v_cvt_pk_bf16_f32 v240, v208, v209
    v_cvt_pk_bf16_f32 v241, v210, v211
    v_cvt_pk_bf16_f32 v242, v212, v213
    v_cvt_pk_bf16_f32 v243, v214, v215
    v_cvt_pk_bf16_f32 v244, v216, v217
    v_cvt_pk_bf16_f32 v245, v218, v219
    v_cvt_pk_bf16_f32 v246, v220, v221
    v_cvt_pk_bf16_f32 v247, v222, v223
    v_cvt_pk_bf16_f32 v248, v224, v225
    v_cvt_pk_bf16_f32 v249, v226, v227
    v_cvt_pk_bf16_f32 v250, v228, v229
    v_cvt_pk_bf16_f32 v251, v230, v231
    buffer_store_dwordx4 v[240:243], v232, s[40:43], s73 offen sc1
    buffer_store_dwordx2 v[244:245], v238, s[40:43], s73 offen offset:1536 sc1
    buffer_store_dwordx4 v[246:249], v236, s[40:43], s73 offen offset:1024 sc1
    buffer_store_dwordx2 v[250:251], v237, s[40:43], s73 offen offset:1792 sc1
    s_barrier
    ds_read_b64_tr_b16 v[40:41], v26 offset:32768
    ds_read_b64_tr_b16 v[42:43], v26 offset:33280
    ds_read_b64_tr_b16 v[44:45], v26 offset:34816
    ds_read_b64_tr_b16 v[46:47], v26 offset:35328
    ds_read_b64_tr_b16 v[48:49], v26 offset:36864
    ds_read_b64_tr_b16 v[50:51], v26 offset:37376
    ds_read_b64_tr_b16 v[52:53], v26 offset:38912
    ds_read_b64_tr_b16 v[54:55], v26 offset:39424
    s_waitcnt lgkmcnt(4)
    v_mfma_f32_32x32x16_bf16 v[96:111], v[40:43], a[0:3], 0
    ds_read_b64_tr_b16 v[56:57], v26 offset:40960
    ds_read_b64_tr_b16 v[58:59], v26 offset:41472
    v_add_u32 v7, 145408, v6
    v_mfma_f32_32x32x16_bf16 v[96:111], v[44:47], a[4:7], v[96:111]
    ds_read_b64_tr_b16 v[60:61], v26 offset:43008
    ds_read_b64_tr_b16 v[62:63], v26 offset:43520
    global_load_dwordx4 v[188:191], v7, s[40:41] offset:-2048 sc1
    s_waitcnt lgkmcnt(4)
    v_mfma_f32_32x32x16_bf16 v[96:111], v[48:51], a[8:11], v[96:111]
    ds_read_b64_tr_b16 v[40:41], v26 offset:45056
    ds_read_b64_tr_b16 v[42:43], v26 offset:45568
    v_mfma_f32_32x32x16_bf16 v[96:111], v[52:55], a[12:15], v[96:111]
    ds_read_b64_tr_b16 v[44:45], v26 offset:47104
    ds_read_b64_tr_b16 v[46:47], v26 offset:47616
    global_load_dwordx4 v[192:195], v7, s[40:41] offset:-1024 sc1
    s_waitcnt lgkmcnt(4)
    v_mfma_f32_32x32x16_bf16 v[96:111], v[56:59], a[16:19], v[96:111]
    ds_read_b64_tr_b16 v[48:49], v26 offset:49152
    ds_read_b64_tr_b16 v[50:51], v26 offset:49664
    v_mfma_f32_32x32x16_bf16 v[96:111], v[60:63], a[20:23], v[96:111]
    ds_read_b64_tr_b16 v[52:53], v26 offset:51200
    ds_read_b64_tr_b16 v[54:55], v26 offset:51712
    global_load_dwordx4 v[196:199], v7, s[40:41] offset:0 sc1
    s_waitcnt lgkmcnt(4)
    v_mfma_f32_32x32x16_bf16 v[96:111], v[40:43], a[24:27], v[96:111]
    ds_read_b64_tr_b16 v[56:57], v26 offset:53248
    ds_read_b64_tr_b16 v[58:59], v26 offset:53760
    v_mfma_f32_32x32x16_bf16 v[96:111], v[44:47], a[28:31], v[96:111]
    ds_read_b64_tr_b16 v[60:61], v26 offset:55296
    ds_read_b64_tr_b16 v[62:63], v26 offset:55808
    s_waitcnt lgkmcnt(4)
    v_mfma_f32_32x32x16_bf16 v[96:111], v[48:51], a[32:35], v[96:111]
    ds_read_b64_tr_b16 v[40:41], v26 offset:57344
    ds_read_b64_tr_b16 v[42:43], v26 offset:57856
    global_load_dwordx4 v[200:203], v7, s[40:41] offset:1024 sc1
    s_mul_i32 s76, s93, 5
    s_lshr_b32 s76, s76, 1
    s_lshr_b32 s73, s76, 3
    v_mfma_f32_32x32x16_bf16 v[96:111], v[52:55], a[36:39], v[96:111]
    ds_read_b64_tr_b16 v[44:45], v26 offset:59392
    ds_read_b64_tr_b16 v[46:47], v26 offset:59904
    s_add_u32 s74, s76, 2
    s_lshr_b32 s74, s74, 3
    s_sub_u32 s74, s74, s73
    s_lshl_b32 s75, s94, 5
    s_waitcnt lgkmcnt(4)
    v_mfma_f32_32x32x16_bf16 v[96:111], v[56:59], a[40:43], v[96:111]
    ds_read_b64_tr_b16 v[48:49], v26 offset:61440
    ds_read_b64_tr_b16 v[50:51], v26 offset:61952
    global_load_dwordx4 v[204:207], v7, s[40:41] offset:2048 sc1
    s_add_u32 s73, s73, s75
    s_add_u32 s73, s73, 896
    v_and_b32 v8, 1, v1
    v_mfma_f32_32x32x16_bf16 v[96:111], v[60:63], a[44:47], v[96:111]
    ds_read_b64_tr_b16 v[52:53], v26 offset:63488
    ds_read_b64_tr_b16 v[54:55], v26 offset:64000
    v_mul_u32_u24 v8, s74, v8
    v_bfe_u32 v9, v1, 1, 1
    v_lshl_add_u32 v8, v9, 4, v8
    s_waitcnt lgkmcnt(4)
    v_mfma_f32_32x32x16_bf16 v[96:111], v[40:43], a[48:51], v[96:111]
    ds_read_b64_tr_b16 v[56:57], v26 offset:0
    ds_read_b64_tr_b16 v[58:59], v26 offset:512
    v_add_u32 v8, s73, v8
    v_lshlrev_b32 v8, 7, v8
    v_add_u32 v20, 0x10000, v8
    v_add_u32 v7, 165888, v6
    v_mfma_f32_32x32x16_bf16 v[96:111], v[44:47], a[52:55], v[96:111]
    ds_read_b64_tr_b16 v[60:61], v26 offset:2048
    ds_read_b64_tr_b16 v[62:63], v26 offset:2560
    global_load_dwordx4 v[208:211], v7, s[40:41] offset:-2048 sc1
    s_lshr_b32 s73, s93, 2
    s_lshl_b32 s73, s73, 4
    s_add_u32 s73, s73, 1152
    v_and_b32 v8, 15, v1
    s_waitcnt lgkmcnt(4)
    v_mfma_f32_32x32x16_bf16 v[96:111], v[48:51], a[56:59], v[96:111]
    ds_read_b64_tr_b16 v[40:41], v26 offset:4096
    ds_read_b64_tr_b16 v[42:43], v26 offset:4608
    v_add_u32 v8, s73, v8
    v_lshlrev_b32 v8, 7, v8
    v_add_u32 v21, 0x10000, v8
    v_mfma_f32_32x32x16_bf16 v[96:111], v[52:55], a[60:63], v[96:111]
    ds_read_b64_tr_b16 v[44:45], v26 offset:6144
    ds_read_b64_tr_b16 v[46:47], v26 offset:6656
    global_load_dwordx4 v[212:215], v7, s[40:41] offset:-1024 sc1
    s_lshl_b32 s73, s94, 4
    s_lshl_b32 s74, s68, 2
    s_add_u32 s73, s73, s74
    s_waitcnt lgkmcnt(4)
    v_mfma_f32_32x32x16_bf16 v[96:111], v[56:59], a[64:67], v[96:111]
    ds_read_b64_tr_b16 v[48:49], v26 offset:8192
    ds_read_b64_tr_b16 v[50:51], v26 offset:8704
    v_lshrrev_b32 v8, 4, v1
    v_add_u32 v8, s73, v8
    s_mov_b32 s73, 98304
    v_mul_lo_u32 v8, v8, s73
    v_mfma_f32_32x32x16_bf16 v[96:111], v[60:63], a[68:71], v[96:111]
    ds_read_b64_tr_b16 v[52:53], v26 offset:10240
    ds_read_b64_tr_b16 v[54:55], v26 offset:10752
    global_load_dwordx4 v[216:219], v7, s[40:41] offset:0 sc1
    v_add_u32 v8, 0x500000, v8
    v_and_b32 v9, 15, v1
    v_lshl_add_u32 v252, v9, 4, v8
    s_waitcnt lgkmcnt(4)
    v_mfma_f32_32x32x16_bf16 v[96:111], v[40:43], a[72:75], v[96:111]
    s_waitcnt vmcnt(8)
    s_barrier
    v_mov_b32 v35, s72
    buffer_store_dword v35, v32, s[40:43], s87 offen sc1
    ds_read_b64_tr_b16 v[56:57], v26 offset:12288
    ds_read_b64_tr_b16 v[58:59], v26 offset:12800
    v_lshl_add_u32 v253, v9, 3, v8
    s_and_b32 s73, s93, 1
    s_mul_i32 s73, s73, 160
    v_mfma_f32_32x32x16_bf16 v[96:111], v[44:47], a[76:79], v[96:111]
    ds_read_b64_tr_b16 v[60:61], v26 offset:14336
    ds_read_b64_tr_b16 v[62:63], v26 offset:14848
    s_sub_u32 s73, 0x260a0, s73
    v_bfe_u32 v8, v1, 2, 2
    v_mul_u32_u24 v8, 40, v8
    s_waitcnt lgkmcnt(4)
    v_mfma_f32_32x32x16_bf16 v[96:111], v[48:51], a[80:83], v[96:111]
    ds_read_b64_tr_b16 v[40:41], v26 offset:16384
    ds_read_b64_tr_b16 v[42:43], v26 offset:16896
    global_load_dwordx4 v[220:223], v7, s[40:41] offset:1024 sc1
    v_bfe_u32 v9, v1, 4, 1
    v_bfe_u32 v10, v1, 1, 1
    v_lshl_add_u32 v9, v9, 1, v10
    v_lshl_add_u32 v8, v9, 3, v8
    v_mfma_f32_32x32x16_bf16 v[96:111], v[52:55], a[84:87], v[96:111]
    ds_read_b64_tr_b16 v[44:45], v26 offset:18432
    ds_read_b64_tr_b16 v[46:47], v26 offset:18944
    v_add_u32 v8, s73, v8
    v_lshrrev_b32 v10, 5, v1
    v_and_b32 v23, 1, v1
    s_waitcnt lgkmcnt(4)
    v_mfma_f32_32x32x16_bf16 v[96:111], v[56:59], a[88:91], v[96:111]
    ds_read_b64_tr_b16 v[48:49], v26 offset:20480
    ds_read_b64_tr_b16 v[50:51], v26 offset:20992
    global_load_dwordx4 v[224:227], v7, s[40:41] offset:2048 sc1
    v_xor_b32 v10, v10, v23
    v_cmp_eq_u32 vcc, 0, v10
    v_mov_b32 v23, 0x26400
    v_or_b32 v10, v10, v9
    v_cndmask_b32 v22, v23, v8, vcc
    v_mfma_f32_32x32x16_bf16 v[96:111], v[60:63], a[92:95], v[96:111]
    ds_read_b64_tr_b16 v[52:53], v26 offset:22528
    ds_read_b64_tr_b16 v[54:55], v26 offset:23040
    s_waitcnt lgkmcnt(4)
    v_mfma_f32_32x32x16_bf16 v[96:111], v[40:43], a[96:99], v[96:111]
    ds_read_b64_tr_b16 v[56:57], v26 offset:24576
    ds_read_b64_tr_b16 v[58:59], v26 offset:25088
    v_cmp_eq_u32 vcc, 0, v10
    v_add_u32 v8, 32, v8
    s_nop 0
    v_cndmask_b32 v23, v23, v8, vcc
    s_lshl_b32 s73, s68, 5
    v_add_u32 v7, 186368, v6
    v_mfma_f32_32x32x16_bf16 v[96:111], v[44:47], a[100:103], v[96:111]
    ds_read_b64_tr_b16 v[60:61], v26 offset:26624
    ds_read_b64_tr_b16 v[62:63], v26 offset:27136
    global_load_dwordx4 v[228:231], v7, s[40:41] offset:-2048 sc1
    v_and_b32 v8, 31, v1
    v_add_u32 v8, s73, v8
    v_lshrrev_b32 v9, 5, v1
    s_waitcnt lgkmcnt(4)
    v_mfma_f32_32x32x16_bf16 v[96:111], v[48:51], a[104:107], v[96:111]
    ds_read_b64_tr_b16 v[40:41], v26 offset:28672
    ds_read_b64_tr_b16 v[42:43], v26 offset:29184
    v_lshlrev_b32 v25, 4, v8
    v_lshl_add_u32 v25, v9, 14, v25
    s_lshl_b32 s74, s93, 15
    v_mfma_f32_32x32x16_bf16 v[96:111], v[52:55], a[108:111], v[96:111]
    ds_read_b64_tr_b16 v[44:45], v26 offset:30720
    ds_read_b64_tr_b16 v[46:47], v26 offset:31232
    global_load_dwordx4 v[232:235], v7, s[40:41] offset:-1024 sc1
    s_add_u32 s74, s74, 0x100000
    v_add_u32 v25, s74, v25
    v_and_b32 v10, 15, v8
    v_lshrrev_b32 v11, 4, v8
    s_waitcnt lgkmcnt(4)
    v_mfma_f32_32x32x16_bf16 v[96:111], v[56:59], a[112:115], v[96:111]
    ds_read_b64_tr_b16 v[48:49], v27 offset:0
    ds_read_b64_tr_b16 v[50:51], v27 offset:512
    v_mul_u32_u24 v10, 80, v10
    v_lshl_add_u32 v10, v11, 4, v10
    v_lshl_add_u32 v254, v9, 3, v10
    v_mfma_f32_32x32x16_bf16 v[96:111], v[60:63], a[116:119], v[96:111]
    ds_read_b64_tr_b16 v[52:53], v27 offset:2048
    ds_read_b64_tr_b16 v[54:55], v27 offset:2560
    v_and_b32 v10, 7, v8
    v_bfe_u32 v11, v8, 3, 2
    v_mul_u32_u24 v10, 80, v10
    s_waitcnt lgkmcnt(4)
    v_mfma_f32_32x32x16_bf16 v[96:111], v[40:43], a[120:123], v[96:111]
    ds_read_b64_tr_b16 v[56:57], v27 offset:4096
    ds_read_b64_tr_b16 v[58:59], v27 offset:4608
    global_load_dwordx4 v[236:239], v7, s[40:41] offset:0 sc1
    v_lshl_add_u32 v10, v11, 4, v10
    v_lshl_add_u32 v10, v9, 3, v10
    v_add_u32 v10, 1280, v10
    v_mfma_f32_32x32x16_bf16 v[96:111], v[44:47], a[124:127], v[96:111]
    ds_read_b64_tr_b16 v[60:61], v27 offset:6144
    ds_read_b64_tr_b16 v[62:63], v27 offset:6656
    v_cmp_le_u32 vcc, 64, v8
    v_and_b32 v11, 15, v8
    v_lshl_add_u32 v11, v11, 1, v9
    v_cndmask_b32 v254, v254, v10, vcc
    s_waitcnt lgkmcnt(4)
    v_mfma_f32_32x32x16_bf16 v[96:111], v[48:51], a[128:131], v[96:111]
    ds_read_b64_tr_b16 v[40:41], v27 offset:8192
    ds_read_b64_tr_b16 v[42:43], v27 offset:8704
    global_load_dwordx4 v[240:243], v7, s[40:41] offset:1024 sc1
    v_and_b32 v12, 15, v11
    v_mul_u32_u24 v12, 80, v12
    v_lshrrev_b32 v13, 4, v11
    v_mfma_f32_32x32x16_bf16 v[96:111], v[52:55], a[132:135], v[96:111]
    ds_read_b64_tr_b16 v[44:45], v27 offset:10240
    ds_read_b64_tr_b16 v[46:47], v27 offset:10752
    v_lshl_add_u32 v12, v13, 3, v12
    v_add_u32 v12, 64, v12
    s_waitcnt lgkmcnt(4)
    v_mfma_f32_32x32x16_bf16 v[96:111], v[56:59], a[136:139], v[96:111]
    ds_read_b64_tr_b16 v[48:49], v27 offset:12288
    ds_read_b64_tr_b16 v[50:51], v27 offset:12800
    v_cmp_le_u32 vcc, 96, v8
    v_and_b32 v13, 7, v11
    v_mul_u32_u24 v13, 80, v13
    v_cndmask_b32 v254, v254, v12, vcc
    v_bfe_u32 v12, v11, 3, 1
    v_mfma_f32_32x32x16_bf16 v[96:111], v[60:63], a[140:143], v[96:111]
    ds_read_b64_tr_b16 v[52:53], v27 offset:14336
    ds_read_b64_tr_b16 v[54:55], v27 offset:14848
    global_load_dwordx4 v[244:247], v7, s[40:41] offset:2048 sc1
    v_lshl_add_u32 v13, v12, 3, v13
    v_add_u32 v13, 1344, v13
    s_waitcnt lgkmcnt(4)
    v_mfma_f32_32x32x16_bf16 v[96:111], v[40:43], a[144:147], v[96:111]
    ds_read_b128 v[56:59], v30 offset:3072
    v_cmp_le_u32 vcc, 112, v8
    v_mov_b32 v12, 2560
    s_nop 0
    v_cndmask_b32 v254, v254, v13, vcc
    v_mfma_f32_32x32x16_bf16 v[96:111], v[44:47], a[148:151], v[96:111]
    ds_read_b64_tr_b16 v[60:61], v28 offset:32768
    ds_read_b64_tr_b16 v[62:63], v28 offset:33280
    v_cmp_le_u32 vcc, 120, v8
    s_nop 1
    v_cndmask_b32 v254, v254, v12, vcc
    s_add_u32 m0, s91, 2048
    v_add_u32 v7, 288768, v6
    s_waitcnt lgkmcnt(3)
    v_mfma_f32_32x32x16_bf16 v[96:111], v[48:51], a[152:155], v[96:111]
    ds_read_b64_tr_b16 v[40:41], v28 offset:34816
    ds_read_b64_tr_b16 v[42:43], v28 offset:35328
    global_load_lds_dwordx4 v7, s[40:41] offset:-2048 sc1
    v_add_u32 v254, 0x24000, v254
    s_mul_i32 s77, s93, 5
    v_mfma_f32_32x32x16_bf16 v[96:111], v[52:55], a[156:159], v[96:111]
    ds_read_b64_tr_b16 v[44:45], v28 offset:36864
    ds_read_b64_tr_b16 v[46:47], v28 offset:37376
    buffer_load_dword v24, v20, s[40:43], 0 offen sc1
    s_lshr_b32 s77, s77, 1
    s_lshl_b32 s77, s77, 8
    s_add_u32 s77, s77, 77824
    s_waitcnt lgkmcnt(4)
    v_mfma_f32_32x32x16_bf16 v[96:111], v[56:59], v[36:39], v[96:111]
    ds_read_b64_tr_b16 v[48:49], v28 offset:38912
    ds_read_b64_tr_b16 v[50:51], v28 offset:39424
    global_load_lds_dwordx4 v7, s[40:41] offset:-1024 sc1
    v_mfma_f32_32x32x16_bf16 v[64:79], v[60:63], a[0:3], 0
    ds_read_b64_tr_b16 v[52:53], v28 offset:40960
    ds_read_b64_tr_b16 v[54:55], v28 offset:41472
    s_waitcnt lgkmcnt(4)
    v_mfma_f32_32x32x16_bf16 v[64:79], v[40:43], a[4:7], v[64:79]
    ds_read_b64_tr_b16 v[56:57], v28 offset:43008
    ds_read_b64_tr_b16 v[58:59], v28 offset:43520
    global_load_lds_dwordx4 v7, s[40:41] offset:0 sc1
    s_nop 0
    v_mul_f32 v96, v96, v33
    v_mul_f32 v97, v97, v33
    v_mul_f32 v98, v98, v33
    v_mul_f32 v99, v99, v33
    v_mfma_f32_32x32x16_bf16 v[64:79], v[44:47], a[8:11], v[64:79]
    ds_read_b64_tr_b16 v[60:61], v28 offset:45056
    ds_read_b64_tr_b16 v[62:63], v28 offset:45568
    v_exp_f32 v112, v96
    v_exp_f32 v113, v97
    s_waitcnt lgkmcnt(4)
    v_mfma_f32_32x32x16_bf16 v[64:79], v[48:51], a[12:15], v[64:79]
    ds_read_b64_tr_b16 v[40:41], v28 offset:47104
    ds_read_b64_tr_b16 v[42:43], v28 offset:47616
    v_exp_f32 v114, v98
    v_mfma_f32_32x32x16_bf16 v[64:79], v[52:55], a[16:19], v[64:79]
    ds_read_b64_tr_b16 v[44:45], v28 offset:49152
    ds_read_b64_tr_b16 v[46:47], v28 offset:49664
    global_load_lds_dwordx4 v7, s[40:41] offset:1024 sc1
    v_exp_f32 v115, v99
    v_fma_f32 v116, v112, -0.5, -1.0
    v_fma_f32 v117, v113, -0.5, -1.0
    s_waitcnt lgkmcnt(4)
    v_mfma_f32_32x32x16_bf16 v[64:79], v[56:59], a[20:23], v[64:79]
    ds_read_b64_tr_b16 v[48:49], v28 offset:51200
    ds_read_b64_tr_b16 v[50:51], v28 offset:51712
    v_fma_f32 v118, v114, -0.5, -1.0
    v_fma_f32 v119, v115, -0.5, -1.0
    v_fma_f32 v116, v112, v116, -1.0
    v_fma_f32 v117, v113, v117, -1.0
    v_mfma_f32_32x32x16_bf16 v[64:79], v[60:63], a[24:27], v[64:79]
    ds_read_b64_tr_b16 v[52:53], v28 offset:53248
    ds_read_b64_tr_b16 v[54:55], v28 offset:53760
    global_load_lds_dwordx4 v7, s[40:41] offset:2048 sc1
    v_fma_f32 v118, v114, v118, -1.0
    v_fma_f32 v119, v115, v119, -1.0
    v_rcp_f32 v116, v116
    s_waitcnt lgkmcnt(4)
    v_mfma_f32_32x32x16_bf16 v[64:79], v[40:43], a[28:31], v[64:79]
    ds_read_b64_tr_b16 v[56:57], v28 offset:55296
    ds_read_b64_tr_b16 v[58:59], v28 offset:55808
    v_rcp_f32 v117, v117
    v_rcp_f32 v118, v118
    v_mfma_f32_32x32x16_bf16 v[64:79], v[44:47], a[32:35], v[64:79]
    ds_read_b64_tr_b16 v[60:61], v28 offset:57344
    ds_read_b64_tr_b16 v[62:63], v28 offset:57856
    v_rcp_f32 v119, v119
    v_fma_f32 v96, v96, v116, v96
    s_add_u32 m0, s91, 7168
    v_add_u32 v7, 309248, v6
    s_waitcnt lgkmcnt(4)
    v_mfma_f32_32x32x16_bf16 v[64:79], v[48:51], a[36:39], v[64:79]
    ds_read_b64_tr_b16 v[40:41], v28 offset:59392
    ds_read_b64_tr_b16 v[42:43], v28 offset:59904
    global_load_lds_dwordx4 v7, s[40:41] offset:-2048 sc1
    v_fma_f32 v97, v97, v117, v97
    v_fma_f32 v98, v98, v118, v98
    v_fma_f32 v99, v99, v119, v99
    v_mfma_f32_32x32x16_bf16 v[64:79], v[52:55], a[40:43], v[64:79]
    ds_read_b64_tr_b16 v[44:45], v28 offset:61440
    ds_read_b64_tr_b16 v[46:47], v28 offset:61952
    v_cvt_pk_bf16_f32 v120, v96, v97
    v_cvt_pk_bf16_f32 v121, v98, v99
    v_mul_f32 v100, v100, v33
    v_mul_f32 v101, v101, v33
    s_waitcnt lgkmcnt(4)
    v_mfma_f32_32x32x16_bf16 v[64:79], v[56:59], a[44:47], v[64:79]
    ds_read_b64_tr_b16 v[48:49], v28 offset:63488
    ds_read_b64_tr_b16 v[50:51], v28 offset:64000
    global_load_lds_dwordx4 v7, s[40:41] offset:-1024 sc1
    v_mul_f32 v102, v102, v33
    v_mul_f32 v103, v103, v33
    v_exp_f32 v112, v100
    v_mfma_f32_32x32x16_bf16 v[64:79], v[60:63], a[48:51], v[64:79]
    ds_read_b64_tr_b16 v[52:53], v28 offset:0
    ds_read_b64_tr_b16 v[54:55], v28 offset:512
    v_exp_f32 v113, v101
    v_exp_f32 v114, v102
    s_waitcnt lgkmcnt(4)
    v_mfma_f32_32x32x16_bf16 v[64:79], v[40:43], a[52:55], v[64:79]
    ds_read_b64_tr_b16 v[56:57], v28 offset:2048
    ds_read_b64_tr_b16 v[58:59], v28 offset:2560
    global_load_lds_dwordx4 v7, s[40:41] offset:0 sc1
    v_exp_f32 v115, v103
    v_fma_f32 v116, v112, -0.5, -1.0
    v_mfma_f32_32x32x16_bf16 v[64:79], v[44:47], a[56:59], v[64:79]
    ds_read_b64_tr_b16 v[60:61], v28 offset:4096
    ds_read_b64_tr_b16 v[62:63], v28 offset:4608
    v_fma_f32 v117, v113, -0.5, -1.0
    v_fma_f32 v118, v114, -0.5, -1.0
    v_fma_f32 v119, v115, -0.5, -1.0
    s_waitcnt vmcnt(7)
    v_cmp_ne_u32 vcc, s72, v24
    s_nop 4
    s_cbranch_vccnz Lslow7
Lback7:
    s_waitcnt lgkmcnt(4)
    v_mfma_f32_32x32x16_bf16 v[64:79], v[48:51], a[60:63], v[64:79]
    ds_read_b64_tr_b16 v[40:41], v28 offset:6144
    ds_read_b64_tr_b16 v[42:43], v28 offset:6656
    v_fma_f32 v116, v112, v116, -1.0
    v_fma_f32 v117, v113, v117, -1.0
    v_fma_f32 v118, v114, v118, -1.0
    v_fma_f32 v119, v115, v119, -1.0
    v_mfma_f32_32x32x16_bf16 v[64:79], v[52:55], a[64:67], v[64:79]
    ds_read_b64_tr_b16 v[44:45], v28 offset:8192
    ds_read_b64_tr_b16 v[46:47], v28 offset:8704
    global_load_lds_dwordx4 v7, s[40:41] offset:1024 sc1
    v_rcp_f32 v116, v116
    v_rcp_f32 v117, v117
    buffer_load_dwordx4 v[8:11], v252, s[40:43], s77 offen offset:0 sc1
    s_waitcnt lgkmcnt(4)
    v_mfma_f32_32x32x16_bf16 v[64:79], v[56:59], a[68:71], v[64:79]
    ds_read_b64_tr_b16 v[48:49], v28 offset:10240
    ds_read_b64_tr_b16 v[50:51], v28 offset:10752
    buffer_load_dwordx4 v[12:15], v252, s[40:43], s77 offen offset:256 sc1
    v_rcp_f32 v118, v118
    v_rcp_f32 v119, v119
    v_mfma_f32_32x32x16_bf16 v[64:79], v[60:63], a[72:75], v[64:79]
    ds_read_b64_tr_b16 v[52:53], v28 offset:12288
    ds_read_b64_tr_b16 v[54:55], v28 offset:12800
    global_load_lds_dwordx4 v7, s[40:41] offset:2048 sc1
    v_fma_f32 v100, v100, v116, v100
    v_fma_f32 v101, v101, v117, v101
    v_fma_f32 v102, v102, v118, v102
    s_waitcnt lgkmcnt(4)
    v_mfma_f32_32x32x16_bf16 v[64:79], v[40:43], a[76:79], v[64:79]
    ds_read_b64_tr_b16 v[56:57], v28 offset:14336
    ds_read_b64_tr_b16 v[58:59], v28 offset:14848
    buffer_load_dwordx4 v[16:19], v252, s[40:43], s77 offen offset:512 sc1
    v_fma_f32 v103, v103, v119, v103
    v_cvt_pk_bf16_f32 v122, v100, v101
    v_cvt_pk_bf16_f32 v123, v102, v103
    v_mfma_f32_32x32x16_bf16 v[64:79], v[44:47], a[80:83], v[64:79]
    ds_read_b64_tr_b16 v[60:61], v28 offset:16384
    ds_read_b64_tr_b16 v[62:63], v28 offset:16896
    buffer_store_dwordx4 v[120:123], v31, s[40:43], s86 offen offset:0 sc1
    v_mul_f32 v104, v104, v33
    v_mul_f32 v105, v105, v33
    buffer_load_dword v24, v21, s[40:43], 0 offen sc1
    s_add_u32 m0, s91, 12288
    v_add_u32 v7, 329728, v6
    s_waitcnt lgkmcnt(4)
    v_mfma_f32_32x32x16_bf16 v[64:79], v[48:51], a[84:87], v[64:79]
    ds_read_b64_tr_b16 v[40:41], v28 offset:18432
    ds_read_b64_tr_b16 v[42:43], v28 offset:18944
    global_load_lds_dwordx4 v7, s[40:41] offset:-2048 sc1
    v_mul_f32 v106, v106, v33
    v_mul_f32 v107, v107, v33
    v_exp_f32 v112, v104
    v_mfma_f32_32x32x16_bf16 v[64:79], v[52:55], a[88:91], v[64:79]
    ds_read_b64_tr_b16 v[44:45], v28 offset:20480
    ds_read_b64_tr_b16 v[46:47], v28 offset:20992
    v_exp_f32 v113, v105
    ds_read_b64_tr_b16 a[0:1], v22 offset:0
    s_waitcnt lgkmcnt(5)
    v_mfma_f32_32x32x16_bf16 v[64:79], v[56:59], a[92:95], v[64:79]
    ds_read_b64_tr_b16 v[48:49], v28 offset:22528
    ds_read_b64_tr_b16 v[50:51], v28 offset:23040
    global_load_lds_dwordx4 v7, s[40:41] offset:-1024 sc1
    v_exp_f32 v114, v106
    v_exp_f32 v115, v107
    v_fma_f32 v116, v112, -0.5, -1.0
    ds_read_b64_tr_b16 a[2:3], v22 offset:160
    v_mfma_f32_32x32x16_bf16 v[64:79], v[60:63], a[96:99], v[64:79]
    ds_read_b64_tr_b16 v[52:53], v28 offset:24576
    ds_read_b64_tr_b16 v[54:55], v28 offset:25088
    v_fma_f32 v117, v113, -0.5, -1.0
    v_fma_f32 v118, v114, -0.5, -1.0
    v_fma_f32 v119, v115, -0.5, -1.0
    ds_read_b64_tr_b16 a[4:5], v22 offset:320
    s_waitcnt lgkmcnt(7)
    v_mfma_f32_32x32x16_bf16 v[64:79], v[40:43], a[100:103], v[64:79]
    ds_read_b64_tr_b16 v[56:57], v28 offset:26624
    ds_read_b64_tr_b16 v[58:59], v28 offset:27136
    v_fma_f32 v116, v112, v116, -1.0
    v_fma_f32 v117, v113, v117, -1.0
    v_fma_f32 v118, v114, v118, -1.0
    v_fma_f32 v119, v115, v119, -1.0
    ds_read_b64_tr_b16 a[6:7], v22 offset:480
    v_mfma_f32_32x32x16_bf16 v[64:79], v[44:47], a[104:107], v[64:79]
    ds_read_b64_tr_b16 v[60:61], v28 offset:28672
    ds_read_b64_tr_b16 v[62:63], v28 offset:29184
    global_load_lds_dwordx4 v7, s[40:41] offset:0 sc1
    v_rcp_f32 v116, v116
    v_rcp_f32 v117, v117
    ds_read_b64_tr_b16 a[8:9], v22 offset:640
    s_waitcnt lgkmcnt(7)
    v_mfma_f32_32x32x16_bf16 v[64:79], v[48:51], a[108:111], v[64:79]
    ds_read_b64_tr_b16 v[40:41], v28 offset:30720
    ds_read_b64_tr_b16 v[42:43], v28 offset:31232
    v_rcp_f32 v118, v118
    ds_read_b64_tr_b16 a[10:11], v22 offset:800
    v_mfma_f32_32x32x16_bf16 v[64:79], v[52:55], a[112:115], v[64:79]
    ds_read_b64_tr_b16 v[44:45], v29 offset:0
    ds_read_b64_tr_b16 v[46:47], v29 offset:512
    global_load_lds_dwordx4 v7, s[40:41] offset:1024 sc1
    v_rcp_f32 v119, v119
    v_fma_f32 v104, v104, v116, v104
    v_fma_f32 v105, v105, v117, v105
    v_fma_f32 v106, v106, v118, v106
    ds_read_b64_tr_b16 a[12:13], v23 offset:0
    s_waitcnt lgkmcnt(7)
    v_mfma_f32_32x32x16_bf16 v[64:79], v[56:59], a[116:119], v[64:79]
    ds_read_b64_tr_b16 v[48:49], v29 offset:2048
    ds_read_b64_tr_b16 v[50:51], v29 offset:2560
    v_fma_f32 v107, v107, v119, v107
    v_cvt_pk_bf16_f32 v124, v104, v105
    v_cvt_pk_bf16_f32 v125, v106, v107
    ds_read_b64_tr_b16 a[14:15], v23 offset:160
    v_mfma_f32_32x32x16_bf16 v[64:79], v[60:63], a[120:123], v[64:79]
    ds_read_b64_tr_b16 v[52:53], v29 offset:4096
    ds_read_b64_tr_b16 v[54:55], v29 offset:4608
    v_mul_f32 v108, v108, v33
    v_mul_f32 v109, v109, v33
    v_mul_f32 v110, v110, v33
    v_mul_f32 v111, v111, v33
    ds_read_b64_tr_b16 a[16:17], v23 offset:320
    s_waitcnt lgkmcnt(7)
    v_mfma_f32_32x32x16_bf16 v[64:79], v[40:43], a[124:127], v[64:79]
    ds_read_b64_tr_b16 v[56:57], v29 offset:6144
    ds_read_b64_tr_b16 v[58:59], v29 offset:6656
    global_load_lds_dwordx4 v7, s[40:41] offset:2048 sc1
    v_exp_f32 v112, v108
    v_exp_f32 v113, v109
    ds_read_b64_tr_b16 a[18:19], v23 offset:480
    v_mfma_f32_32x32x16_bf16 v[64:79], v[44:47], a[128:131], v[64:79]
    ds_read_b64_tr_b16 v[60:61], v29 offset:8192
    ds_read_b64_tr_b16 v[62:63], v29 offset:8704
    v_exp_f32 v114, v110
    ds_read_b64_tr_b16 a[20:21], v23 offset:640
    s_waitcnt lgkmcnt(7)
    v_mfma_f32_32x32x16_bf16 v[64:79], v[48:51], a[132:135], v[64:79]
    ds_read_b64_tr_b16 v[40:41], v29 offset:10240
    ds_read_b64_tr_b16 v[42:43], v29 offset:10752
    v_exp_f32 v115, v111
    v_fma_f32 v116, v112, -0.5, -1.0
    v_fma_f32 v117, v113, -0.5, -1.0
    ds_read_b64_tr_b16 a[22:23], v23 offset:800
    v_mfma_f32_32x32x16_bf16 v[64:79], v[52:55], a[136:139], v[64:79]
    ds_read_b64_tr_b16 v[44:45], v29 offset:12288
    ds_read_b64_tr_b16 v[46:47], v29 offset:12800
    v_fma_f32 v118, v114, -0.5, -1.0
    v_fma_f32 v119, v115, -0.5, -1.0
    v_fma_f32 v116, v112, v116, -1.0
    v_fma_f32 v117, v113, v117, -1.0
    s_waitcnt lgkmcnt(6)
    v_mfma_f32_32x32x16_bf16 v[64:79], v[56:59], a[140:143], v[64:79]
    ds_read_b64_tr_b16 v[48:49], v29 offset:14336
    ds_read_b64_tr_b16 v[50:51], v29 offset:14848
    v_fma_f32 v118, v114, v118, -1.0
    v_fma_f32 v119, v115, v119, -1.0
    v_rcp_f32 v116, v116
    v_mfma_f32_32x32x16_bf16 v[64:79], v[60:63], a[144:147], v[64:79]
    ds_read_b128 v[52:55], v30 offset:3584
    v_rcp_f32 v117, v117
    v_rcp_f32 v118, v118
    s_waitcnt lgkmcnt(3)
    v_mfma_f32_32x32x16_bf16 v[64:79], v[40:43], a[148:151], v[64:79]
    v_rcp_f32 v119, v119
    v_fma_f32 v108, v108, v116, v108
    v_mfma_f32_32x32x16_bf16 v[64:79], v[44:47], a[152:155], v[64:79]
    v_fma_f32 v109, v109, v117, v109
    v_fma_f32 v110, v110, v118, v110
    v_fma_f32 v111, v111, v119, v111
    s_waitcnt lgkmcnt(0)
    v_mfma_f32_32x32x16_bf16 v[64:79], v[48:51], a[156:159], v[64:79]
    v_cvt_pk_bf16_f32 v126, v108, v109
    v_cvt_pk_bf16_f32 v127, v110, v111
    v_mfma_f32_32x32x16_bf16 v[64:79], v[52:55], v[36:39], v[64:79]
    buffer_store_dwordx4 v[124:127], v31, s[40:43], s86 offen offset:256 sc1
Ljoin:
    s_waitcnt vmcnt(6)
    v_cmp_ne_u32 vcc, s72, v24
    s_nop 4
    s_cbranch_vccnz Lslow8
Lback8:
    s_cmp_eq_u32 s2, 0
    s_cselect_b32 s73, 0, 0x80000000
    v_or_b32 v80, s73, v32
    v_mov_b32 v81, s72
    buffer_store_dword v81, v80, s[40:43], 0 offen sc1
    s_mov_b32 s73, 0x0
    buffer_load_dwordx4 v[2:5], v25, s[40:43], s73 offen offset:0 sc1
    buffer_load_dwordx4 v[36:39], v25, s[40:43], s73 offen offset:2048 sc1
    s_mov_b32 s73, 0x1000
    buffer_load_dwordx4 v[40:43], v25, s[40:43], s73 offen offset:0 sc1
    buffer_load_dwordx4 v[44:47], v25, s[40:43], s73 offen offset:2048 sc1
    s_mov_b32 s73, 0x2000
    buffer_load_dwordx4 v[48:51], v25, s[40:43], s73 offen offset:0 sc1
    buffer_load_dwordx4 v[52:55], v25, s[40:43], s73 offen offset:2048 sc1
    s_mov_b32 s73, 0x3000
    buffer_load_dwordx4 v[60:63], v25, s[40:43], s73 offen offset:0 sc1
    buffer_load_dwordx4 v[248:251], v25, s[40:43], s73 offen offset:2048 sc1
    s_waitcnt lgkmcnt(10)
    v_mfma_f32_32x32x16_bf16 v[80:95], a[0:3], v[8:11], 0
    s_lshr_b32 s73, s95, 1
    s_lshl_b32 s73, s73, 12
    s_add_u32 s80, s73, 0x1c000
    s_lshr_b32 s73, s68, 1
    s_lshl_b32 s73, s73, 7
    s_add_u32 s80, s80, s73
    s_waitcnt lgkmcnt(4)
    v_mfma_f32_32x32x16_bf16 v[96:111], a[12:15], v[8:11], 0
    v_min_u32 v20, 6, v1
    v_lshl_add_u32 v20, v20, 8, s80
    s_mov_b32 s48, s40
    s_mov_b32 s49, s41
    s_cmp_lt_u32 s68, 2
    s_cselect_b32 s50, 0x1200000, 0
    v_mfma_f32_32x32x16_bf16 v[80:95], a[4:7], v[12:15], v[80:95]
    s_mov_b32 s51, 0x20000
    s_mul_i32 s79, s95, 393216
    s_lshl_b32 s74, s68, 10
    s_add_u32 s79, s79, s74
    s_add_u32 s79, s79, 0x500000
    s_waitcnt lgkmcnt(2)
    v_mfma_f32_32x32x16_bf16 v[96:111], a[16:19], v[12:15], v[96:111]
    v_lshlrev_b32 v21, 4, v1
    v_add_u32 v21, s79, v21
    s_add_u32 s73, s68, 0
    s_and_b32 s73, s73, 3
    s_mul_i32 s83, s73, 98304
    v_add_u32 v28, s83, v21
    v_mfma_f32_32x32x16_bf16 v[80:95], a[8:11], v[16:19], v[80:95]
    s_add_u32 s73, s68, 1
    s_and_b32 s73, s73, 3
    s_mul_i32 s84, s73, 98304
    v_add_u32 v29, s84, v21
    s_add_u32 s73, s68, 2
    s_and_b32 s73, s73, 3
    s_waitcnt lgkmcnt(0)
    v_mfma_f32_32x32x16_bf16 v[96:111], a[20:23], v[16:19], v[96:111]
    s_mul_i32 s85, s73, 98304
    v_add_u32 v30, s85, v21
    s_add_u32 s73, s68, 3
    s_and_b32 s73, s73, 3
    s_mul_i32 s86, s73, 98304
    v_add_u32 v34, s86, v21
    v_mov_b32 v56, v33
    v_mov_b32 v58, -0.5
    v_mov_b32 v26, -1.0
    v_pk_mul_f32 v[64:65], v[64:65], v[56:57] op_sel_hi:[1,0]
    v_pk_mul_f32 v[66:67], v[66:67], v[56:57] op_sel_hi:[1,0]
    v_exp_f32 v112, v64
    v_exp_f32 v113, v65
    v_exp_f32 v114, v66
    v_exp_f32 v115, v67
    v_pk_fma_f32 v[116:117], v[112:113], v[58:59], v[26:27] op_sel_hi:[1,0,0]
    v_pk_fma_f32 v[118:119], v[114:115], v[58:59], v[26:27] op_sel_hi:[1,0,0]
    v_pk_fma_f32 v[116:117], v[112:113], v[116:117], v[26:27] op_sel_hi:[1,1,0]
    v_pk_fma_f32 v[118:119], v[114:115], v[118:119], v[26:27] op_sel_hi:[1,1,0]
    v_rcp_f32 v116, v116
    v_add_u32 v7, 206848, v6
    global_load_dwordx4 a[80:83], v7, s[40:41] offset:-2048 sc1
    v_rcp_f32 v117, v117
    v_rcp_f32 v118, v118
    v_rcp_f32 v119, v119
    v_pk_fma_f32 v[64:65], v[64:65], v[116:117], v[64:65]
    v_pk_fma_f32 v[66:67], v[66:67], v[118:119], v[66:67]
    v_cvt_pk_bf16_f32 v120, v64, v65
    v_cvt_pk_bf16_f32 v121, v66, v67
    v_pk_mul_f32 v[68:69], v[68:69], v[56:57] op_sel_hi:[1,0]
    v_pk_mul_f32 v[70:71], v[70:71], v[56:57] op_sel_hi:[1,0]
    v_exp_f32 v112, v68
    v_exp_f32 v113, v69
    v_exp_f32 v114, v70
    v_exp_f32 v115, v71
    global_load_dwordx4 a[84:87], v7, s[40:41] offset:-1024 sc1
    v_pk_fma_f32 v[116:117], v[112:113], v[58:59], v[26:27] op_sel_hi:[1,0,0]
    v_pk_fma_f32 v[118:119], v[114:115], v[58:59], v[26:27] op_sel_hi:[1,0,0]
    v_pk_fma_f32 v[116:117], v[112:113], v[116:117], v[26:27] op_sel_hi:[1,1,0]
    v_pk_fma_f32 v[118:119], v[114:115], v[118:119], v[26:27] op_sel_hi:[1,1,0]
    v_rcp_f32 v116, v116
    v_rcp_f32 v117, v117
    v_rcp_f32 v118, v118
    v_rcp_f32 v119, v119
    v_pk_fma_f32 v[68:69], v[68:69], v[116:117], v[68:69]
    v_pk_fma_f32 v[70:71], v[70:71], v[118:119], v[70:71]
    v_cvt_pk_bf16_f32 v122, v68, v69
    v_cvt_pk_bf16_f32 v123, v70, v71
    buffer_store_dwordx4 v[120:123], v31, s[40:43], s25 offen offset:1024 sc1
    global_load_dwordx4 a[88:91], v7, s[40:41] offset:0 sc1
    v_pk_mul_f32 v[72:73], v[72:73], v[56:57] op_sel_hi:[1,0]
    v_pk_mul_f32 v[74:75], v[74:75], v[56:57] op_sel_hi:[1,0]
    v_exp_f32 v112, v72
    v_exp_f32 v113, v73
    v_exp_f32 v114, v74
    v_exp_f32 v115, v75
    v_pk_fma_f32 v[116:117], v[112:113], v[58:59], v[26:27] op_sel_hi:[1,0,0]
    v_pk_fma_f32 v[118:119], v[114:115], v[58:59], v[26:27] op_sel_hi:[1,0,0]
    v_pk_fma_f32 v[116:117], v[112:113], v[116:117], v[26:27] op_sel_hi:[1,1,0]
    v_pk_fma_f32 v[118:119], v[114:115], v[118:119], v[26:27] op_sel_hi:[1,1,0]
    v_rcp_f32 v116, v116
    v_rcp_f32 v117, v117
    global_load_dwordx4 a[92:95], v7, s[40:41] offset:1024 sc1
    v_rcp_f32 v118, v118
    v_rcp_f32 v119, v119
    v_pk_fma_f32 v[72:73], v[72:73], v[116:117], v[72:73]
    v_pk_fma_f32 v[74:75], v[74:75], v[118:119], v[74:75]
    v_cvt_pk_bf16_f32 v124, v72, v73
    v_cvt_pk_bf16_f32 v125, v74, v75
    v_pk_mul_f32 v[76:77], v[76:77], v[56:57] op_sel_hi:[1,0]
    v_pk_mul_f32 v[78:79], v[78:79], v[56:57] op_sel_hi:[1,0]
    v_exp_f32 v112, v76
    v_exp_f32 v113, v77
    v_exp_f32 v114, v78
    v_exp_f32 v115, v79
    v_pk_fma_f32 v[116:117], v[112:113], v[58:59], v[26:27] op_sel_hi:[1,0,0]
    global_load_dwordx4 a[96:99], v7, s[40:41] offset:2048 sc1
    v_pk_fma_f32 v[118:119], v[114:115], v[58:59], v[26:27] op_sel_hi:[1,0,0]
    v_pk_fma_f32 v[116:117], v[112:113], v[116:117], v[26:27] op_sel_hi:[1,1,0]
    v_pk_fma_f32 v[118:119], v[114:115], v[118:119], v[26:27] op_sel_hi:[1,1,0]
    v_rcp_f32 v116, v116
    v_rcp_f32 v117, v117
    v_rcp_f32 v118, v118
    v_rcp_f32 v119, v119
    v_pk_fma_f32 v[76:77], v[76:77], v[116:117], v[76:77]
    v_pk_fma_f32 v[78:79], v[78:79], v[118:119], v[78:79]
    v_cvt_pk_bf16_f32 v126, v76, v77
    v_cvt_pk_bf16_f32 v127, v78, v79
    buffer_store_dwordx4 v[124:127], v31, s[40:43], s25 offen offset:1280 sc1
    v_mov_b32 v31, v20
    s_nop 0
    v_max3_f32 v124, v80, v81, v82
    v_min3_f32 v126, v80, v81, v82
    v_max3_f32 v124, v124, v83, v84
    v_min3_f32 v126, v126, v83, v84
    v_max3_f32 v124, v124, v85, v86
    v_min3_f32 v126, v126, v85, v86
    v_max3_f32 v124, v124, v87, v88
    v_min3_f32 v126, v126, v87, v88
    v_max3_f32 v124, v124, v89, v90
    v_min3_f32 v126, v126, v89, v90
    v_max3_f32 v124, v124, v91, v92
    v_min3_f32 v126, v126, v91, v92
    v_max3_f32 v124, v124, v93, v94
    v_min3_f32 v126, v126, v93, v94
    v_max3_f32 v124, v124, v95, v96
    v_min3_f32 v126, v126, v95, v96
    v_max3_f32 v124, v124, v97, v98
    v_add_u32 v7, 227328, v6
    global_load_dwordx4 a[100:103], v7, s[40:41] offset:-2048 sc1
    v_min3_f32 v126, v126, v97, v98
    v_max_f32 v124, v124, v99
    v_min_f32 v126, v126, v99
    v_pk_add_f32 v[100:101], v[80:81], v[126:127] op_sel_hi:[1,0] neg_lo:[1,0] neg_hi:[1,0]
    v_pk_add_f32 v[80:81], v[80:81], v[124:125] op_sel_hi:[1,0] neg_lo:[0,1] neg_hi:[0,1]
    v_pk_add_f32 v[102:103], v[82:83], v[126:127] op_sel_hi:[1,0] neg_lo:[1,0] neg_hi:[1,0]
    v_pk_add_f32 v[82:83], v[82:83], v[124:125] op_sel_hi:[1,0] neg_lo:[0,1] neg_hi:[0,1]
    v_pk_add_f32 v[104:105], v[84:85], v[126:127] op_sel_hi:[1,0] neg_lo:[1,0] neg_hi:[1,0]
    v_pk_add_f32 v[84:85], v[84:85], v[124:125] op_sel_hi:[1,0] neg_lo:[0,1] neg_hi:[0,1]
    v_pk_add_f32 v[106:107], v[86:87], v[126:127] op_sel_hi:[1,0] neg_lo:[1,0] neg_hi:[1,0]
    v_pk_add_f32 v[86:87], v[86:87], v[124:125] op_sel_hi:[1,0] neg_lo:[0,1] neg_hi:[0,1]
    global_load_dwordx4 a[104:107], v7, s[40:41] offset:-1024 sc1
    buffer_load_dword v33, v31, s[40:43], 0 offen sc1
    v_pk_add_f32 v[108:109], v[88:89], v[126:127] op_sel_hi:[1,0] neg_lo:[1,0] neg_hi:[1,0]
    v_pk_add_f32 v[88:89], v[88:89], v[124:125] op_sel_hi:[1,0] neg_lo:[0,1] neg_hi:[0,1]
    v_pk_add_f32 v[110:111], v[90:91], v[126:127] op_sel_hi:[1,0] neg_lo:[1,0] neg_hi:[1,0]
    v_pk_add_f32 v[90:91], v[90:91], v[124:125] op_sel_hi:[1,0] neg_lo:[0,1] neg_hi:[0,1]
    v_pk_add_f32 v[112:113], v[92:93], v[126:127] op_sel_hi:[1,0] neg_lo:[1,0] neg_hi:[1,0]
    v_pk_add_f32 v[92:93], v[92:93], v[124:125] op_sel_hi:[1,0] neg_lo:[0,1] neg_hi:[0,1]
    v_pk_add_f32 v[114:115], v[94:95], v[126:127] op_sel_hi:[1,0] neg_lo:[1,0] neg_hi:[1,0]
    v_pk_add_f32 v[94:95], v[94:95], v[124:125] op_sel_hi:[1,0] neg_lo:[0,1] neg_hi:[0,1]
    v_pk_add_f32 v[116:117], v[96:97], v[126:127] op_sel_hi:[1,0] neg_lo:[1,0] neg_hi:[1,0]
    v_pk_add_f32 v[96:97], v[96:97], v[124:125] op_sel_hi:[1,0] neg_lo:[0,1] neg_hi:[0,1]
    v_pk_add_f32 v[118:119], v[98:99], v[126:127] op_sel_hi:[1,0] neg_lo:[1,0] neg_hi:[1,0]
    v_pk_add_f32 v[98:99], v[98:99], v[124:125] op_sel_hi:[1,0] neg_lo:[0,1] neg_hi:[0,1]
    v_exp_f32 v80, v80
    v_exp_f32 v100, v100
    v_exp_f32 v81, v81
    global_load_dwordx4 a[108:111], v7, s[40:41] offset:0 sc1
    v_exp_f32 v101, v101
    v_exp_f32 v82, v82
    v_exp_f32 v102, v102
    v_exp_f32 v83, v83
    v_exp_f32 v103, v103
    v_exp_f32 v84, v84
    v_exp_f32 v104, v104
    v_exp_f32 v85, v85
    global_load_dwordx4 a[112:115], v7, s[40:41] offset:1024 sc1
    v_exp_f32 v105, v105
    v_exp_f32 v86, v86
    v_exp_f32 v106, v106
    v_exp_f32 v87, v87
    v_exp_f32 v107, v107
    v_exp_f32 v88, v88
    v_exp_f32 v108, v108
    v_exp_f32 v89, v89
    global_load_dwordx4 a[116:119], v7, s[40:41] offset:2048 sc1
    v_exp_f32 v109, v109
    v_exp_f32 v90, v90
    v_exp_f32 v110, v110
    v_exp_f32 v91, v91
    v_exp_f32 v111, v111
    v_exp_f32 v92, v92
    v_exp_f32 v112, v112
    v_exp_f32 v93, v93
    v_add_u32 v7, 247808, v6
    global_load_dwordx4 a[120:123], v7, s[40:41] offset:-2048 sc1
    v_exp_f32 v113, v113
    v_exp_f32 v94, v94
    v_exp_f32 v114, v114
    v_exp_f32 v95, v95
    v_exp_f32 v115, v115
    v_exp_f32 v96, v96
    v_exp_f32 v116, v116
    v_exp_f32 v97, v97
    v_exp_f32 v117, v117
    global_load_dwordx4 a[124:127], v7, s[40:41] offset:-1024 sc1
    v_exp_f32 v98, v98
    v_exp_f32 v118, v118
    v_exp_f32 v99, v99
    v_exp_f32 v119, v119
    v_pk_add_f32 v[124:125], v[80:81], v[82:83]
    v_pk_add_f32 v[126:127], v[100:101], v[102:103]
    v_pk_add_f32 v[124:125], v[124:125], v[84:85]
    v_pk_add_f32 v[126:127], v[126:127], v[104:105]
    v_pk_add_f32 v[124:125], v[124:125], v[86:87]
    v_pk_add_f32 v[126:127], v[126:127], v[106:107]
    v_pk_add_f32 v[124:125], v[124:125], v[88:89]
    global_load_dwordx4 a[128:131], v7, s[40:41] offset:0 sc1
    v_pk_add_f32 v[126:127], v[126:127], v[108:109]
    v_pk_add_f32 v[124:125], v[124:125], v[90:91]
    v_pk_add_f32 v[126:127], v[126:127], v[110:111]
    v_pk_add_f32 v[124:125], v[124:125], v[92:93]
    v_pk_add_f32 v[126:127], v[126:127], v[112:113]
    v_pk_add_f32 v[124:125], v[124:125], v[94:95]
    v_pk_add_f32 v[126:127], v[126:127], v[114:115]
    s_waitcnt vmcnt(9)
    s_barrier
    v_mov_b32 v35, s72
    buffer_store_dword v35, v32, s[40:43], s98 offen sc1
    v_pk_add_f32 v[124:125], v[124:125], v[96:97]
    v_pk_add_f32 v[126:127], v[126:127], v[116:117]
    v_pk_add_f32 v[124:125], v[124:125], v[98:99]
    v_pk_add_f32 v[126:127], v[126:127], v[118:119]
    v_add_f32 v124, v124, v125
    v_add_f32 v126, v126, v127
    v_rcp_f32 v124, v124
    v_rcp_f32 v126, v126
    v_pk_mul_f32 v[80:81], v[80:81], v[124:125] op_sel_hi:[1,0]
    v_pk_mul_f32 v[100:101], v[100:101], v[126:127] op_sel_hi:[1,0]
    v_pk_mul_f32 v[82:83], v[82:83], v[124:125] op_sel_hi:[1,0]
    v_pk_mul_f32 v[102:103], v[102:103], v[126:127] op_sel_hi:[1,0]
    v_pk_mul_f32 v[84:85], v[84:85], v[124:125] op_sel_hi:[1,0]
    v_pk_mul_f32 v[104:105], v[104:105], v[126:127] op_sel_hi:[1,0]
    v_pk_mul_f32 v[86:87], v[86:87], v[124:125] op_sel_hi:[1,0]
    global_load_dwordx4 a[132:135], v7, s[40:41] offset:1024 sc1
    v_pk_mul_f32 v[106:107], v[106:107], v[126:127] op_sel_hi:[1,0]
    v_pk_mul_f32 v[88:89], v[88:89], v[124:125] op_sel_hi:[1,0]
    v_pk_mul_f32 v[108:109], v[108:109], v[126:127] op_sel_hi:[1,0]
    v_pk_mul_f32 v[90:91], v[90:91], v[124:125] op_sel_hi:[1,0]
    v_pk_mul_f32 v[110:111], v[110:111], v[126:127] op_sel_hi:[1,0]
    v_pk_mul_f32 v[92:93], v[92:93], v[124:125] op_sel_hi:[1,0]
    v_pk_mul_f32 v[112:113], v[112:113], v[126:127] op_sel_hi:[1,0]
    v_pk_mul_f32 v[94:95], v[94:95], v[124:125] op_sel_hi:[1,0]
    v_pk_mul_f32 v[114:115], v[114:115], v[126:127] op_sel_hi:[1,0]
    v_pk_mul_f32 v[96:97], v[96:97], v[124:125] op_sel_hi:[1,0]
    v_pk_mul_f32 v[116:117], v[116:117], v[126:127] op_sel_hi:[1,0]
    v_pk_mul_f32 v[98:99], v[98:99], v[124:125] op_sel_hi:[1,0]
    v_pk_mul_f32 v[118:119], v[118:119], v[126:127] op_sel_hi:[1,0]
    v_cvt_pk_bf16_f32 v8, v80, v81
    v_cvt_pk_bf16_f32 v9, v82, v83
    v_cvt_pk_bf16_f32 v10, v84, v85
    global_load_dwordx4 a[136:139], v7, s[40:41] offset:2048 sc1
    v_cvt_pk_bf16_f32 v11, v86, v87
    v_cvt_pk_bf16_f32 v12, v88, v89
    v_cvt_pk_bf16_f32 v13, v90, v91
    v_cvt_pk_bf16_f32 v14, v92, v93
    v_cvt_pk_bf16_f32 v15, v94, v95
    v_cvt_pk_bf16_f32 v16, v96, v97
    v_cvt_pk_bf16_f32 v17, v98, v99
    v_cvt_pk_bf16_f32 v18, v100, v101
    v_cvt_pk_bf16_f32 v19, v102, v103
    v_cvt_pk_bf16_f32 v20, v104, v105
    v_cvt_pk_bf16_f32 v21, v106, v107
    v_cvt_pk_bf16_f32 v22, v108, v109
    v_cvt_pk_bf16_f32 v23, v110, v111
    v_cvt_pk_bf16_f32 v24, v112, v113
    v_cvt_pk_bf16_f32 v25, v114, v115
    v_cvt_pk_bf16_f32 v26, v116, v117
    v_cvt_pk_bf16_f32 v27, v118, v119
    s_mov_b32 s27, 0x41000
    buffer_load_dwordx4 a[140:143], v6, s[48:51], s27 offen offset:0 sc1
    s_waitcnt vmcnt(10)
    v_cmp_ne_u32 vcc, s72, v33
    s_nop 4
    s_cbranch_vccnz Lslow9
Lback9:
    s_mov_b32 s73, 0x3f80
    s_mov_b32 s74, 0x3f800000
    v_dot2_f32_bf16 v100, v2, s73, 0
    v_dot2_f32_bf16 v101, v2, s74, 0
    v_dot2_f32_bf16 v102, v3, s73, 0
    v_dot2_f32_bf16 v103, v3, s74, 0
    v_dot2_f32_bf16 v104, v4, s73, 0
    v_dot2_f32_bf16 v105, v4, s74, 0
    v_dot2_f32_bf16 v106, v5, s73, 0
    s_add_u32 s32, s40, 4096
    s_addc_u32 s33, s41, 0
    global_load_dwordx4 v[64:67], v28, s[32:33] offset:-4096 sc1
    v_dot2_f32_bf16 v107, v5, s74, 0
    v_dot2_f32_bf16 v100, v36, s73, v100
    v_dot2_f32_bf16 v101, v36, s74, v101
    v_dot2_f32_bf16 v102, v37, s73, v102
    v_dot2_f32_bf16 v103, v37, s74, v103
    v_dot2_f32_bf16 v104, v38, s73, v104
    v_dot2_f32_bf16 v105, v38, s74, v105
    v_dot2_f32_bf16 v106, v39, s73, v106
    v_dot2_f32_bf16 v107, v39, s74, v107
    global_load_dwordx4 v[68:71], v29, s[32:33] offset:-4096 sc1
    v_dot2_f32_bf16 v100, v40, s73, v100
    v_dot2_f32_bf16 v101, v40, s74, v101
    v_dot2_f32_bf16 v102, v41, s73, v102
    v_dot2_f32_bf16 v103, v41, s74, v103
    v_dot2_f32_bf16 v104, v42, s73, v104
    v_dot2_f32_bf16 v105, v42, s74, v105
    v_dot2_f32_bf16 v106, v43, s73, v106
    v_dot2_f32_bf16 v107, v43, s74, v107
    v_dot2_f32_bf16 v100, v44, s73, v100
    global_load_dwordx4 v[72:75], v30, s[32:33] offset:-4096 sc1
    v_dot2_f32_bf16 v101, v44, s74, v101
    v_dot2_f32_bf16 v102, v45, s73, v102
    v_dot2_f32_bf16 v103, v45, s74, v103
    v_dot2_f32_bf16 v104, v46, s73, v104
    v_dot2_f32_bf16 v105, v46, s74, v105
    v_dot2_f32_bf16 v106, v47, s73, v106
    v_dot2_f32_bf16 v107, v47, s74, v107
    v_dot2_f32_bf16 v100, v48, s73, v100
    v_dot2_f32_bf16 v101, v48, s74, v101
    global_load_dwordx4 v[76:79], v34, s[32:33] offset:-4096 sc1
    v_dot2_f32_bf16 v102, v49, s73, v102
    v_dot2_f32_bf16 v103, v49, s74, v103
    v_dot2_f32_bf16 v104, v50, s73, v104
    v_dot2_f32_bf16 v105, v50, s74, v105
    v_dot2_f32_bf16 v106, v51, s73, v106
    v_dot2_f32_bf16 v107, v51, s74, v107
    v_dot2_f32_bf16 v100, v52, s73, v100
    v_dot2_f32_bf16 v101, v52, s74, v101
    v_dot2_f32_bf16 v102, v53, s73, v102
    s_add_u32 s36, s40, 20480
    s_addc_u32 s37, s41, 0
    global_load_dwordx4 a[0:3], v28, s[36:37] offset:-4096 sc1
    v_dot2_f32_bf16 v103, v53, s74, v103
    v_dot2_f32_bf16 v104, v54, s73, v104
    v_dot2_f32_bf16 v105, v54, s74, v105
    v_dot2_f32_bf16 v106, v55, s73, v106
    v_dot2_f32_bf16 v107, v55, s74, v107
    v_dot2_f32_bf16 v100, v60, s73, v100
    v_dot2_f32_bf16 v101, v60, s74, v101
    v_dot2_f32_bf16 v102, v61, s73, v102
    v_dot2_f32_bf16 v103, v61, s74, v103
    global_load_dwordx4 a[4:7], v29, s[36:37] offset:-4096 sc1
    v_dot2_f32_bf16 v104, v62, s73, v104
    v_dot2_f32_bf16 v105, v62, s74, v105
    v_dot2_f32_bf16 v106, v63, s73, v106
    v_dot2_f32_bf16 v107, v63, s74, v107
    v_dot2_f32_bf16 v100, v248, s73, v100
    v_dot2_f32_bf16 v101, v248, s74, v101
    v_dot2_f32_bf16 v102, v249, s73, v102
    v_dot2_f32_bf16 v103, v249, s74, v103
    v_dot2_f32_bf16 v104, v250, s73, v104
    global_load_dwordx4 a[8:11], v30, s[36:37] offset:-4096 sc1
    v_dot2_f32_bf16 v105, v250, s74, v105
    v_dot2_f32_bf16 v106, v251, s73, v106
    v_dot2_f32_bf16 v107, v251, s74, v107
    v_bfe_u32 v58, v1, 3, 2
    v_and_b32 v59, 3, v1
    v_lshl_add_u32 v58, v58, 2, v59
    v_permlane32_swap_b32 v100, v104
    v_permlane32_swap_b32 v101, v105
    v_permlane32_swap_b32 v102, v106
    global_load_dwordx4 a[12:15], v34, s[36:37] offset:-4096 sc1
    v_permlane32_swap_b32 v103, v107
    v_mul_u32_u24 v58, 80, v58
    v_bfe_u32 v59, v1, 2, 1
    v_add_f32 v100, v100, v104
    v_add_f32 v101, v101, v105
    v_add_f32 v102, v102, v106
    v_add_f32 v103, v103, v107
    v_cvt_pk_bf16_f32 v100, v100, v101
    v_cvt_pk_bf16_f32 v101, v102, v103
    global_load_dwordx4 v[112:115], v28, s[32:33] offset:0 sc1
    ds_write_b64 v254, v[100:101]
    v_lshrrev_b32 v56, 5, v1
    v_cmp_eq_u32 vcc, v59, v56
    v_add_u32 v58, 0x24000, v58
    v_mov_b32 v57, 0x26400
    v_add_u32 v59, 1280, v58
    v_cndmask_b32 v56, v57, v58, vcc
    v_cndmask_b32 v57, v57, v59, vcc
    s_waitcnt lgkmcnt(0)
    s_barrier
    ds_read_b128 a[24:27], v56 offset:0
    ds_read_b128 a[44:47], v57 offset:0
    ds_read_b128 a[28:31], v56 offset:16
    ds_read_b128 a[48:51], v57 offset:16
    ds_read_b128 a[32:35], v56 offset:32
    ds_read_b128 a[52:55], v57 offset:32
    ds_read_b128 a[36:39], v56 offset:48
    ds_read_b128 a[56:59], v57 offset:48
    ds_read_b128 a[40:43], v56 offset:64
    ds_read_b128 a[60:63], v57 offset:64
    s_waitcnt lgkmcnt(9)
    v_mfma_f32_32x32x16_bf16 v[80:95], a[24:27], v[8:11], 0
    global_load_dwordx4 v[116:119], v29, s[32:33] offset:0 sc1
    s_lshr_b32 s73, s93, 1
    s_add_u32 s73, s73, 56
    s_waitcnt lgkmcnt(8)
    v_mfma_f32_32x32x16_bf16 v[96:111], a[44:47], v[8:11], 0
    s_lshl_b32 s73, s73, 10
    s_and_b32 s74, s93, 1
    s_waitcnt lgkmcnt(7)
    v_mfma_f32_32x32x16_bf16 v[80:95], a[28:31], v[12:15], v[80:95]
    global_load_dwordx4 v[120:123], v30, s[32:33] offset:0 sc1
    s_lshl_b32 s75, s74, 9
    s_add_u32 s81, s73, s75
    s_waitcnt lgkmcnt(6)
    v_mfma_f32_32x32x16_bf16 v[96:111], a[48:51], v[12:15], v[96:111]
    s_lshl_b32 s74, s74, 7
    s_lshr_b32 s75, s93, 1
    s_waitcnt lgkmcnt(5)
    v_mfma_f32_32x32x16_bf16 v[80:95], a[32:35], v[16:19], v[80:95]
    global_load_dwordx4 v[124:127], v34, s[32:33] offset:0 sc1
    s_lshl_b32 s75, s75, 8
    s_add_u32 s74, s74, s75
    s_waitcnt lgkmcnt(4)
    v_mfma_f32_32x32x16_bf16 v[96:111], a[52:55], v[16:19], v[96:111]
    s_add_u32 s82, s74, 73728
    s_lshl_b32 s75, s94, 5
    s_add_u32 s34, s40, 12288
    s_addc_u32 s35, s41, 0
    s_waitcnt lgkmcnt(3)
    v_mfma_f32_32x32x16_bf16 v[80:95], a[36:39], v[20:23], v[80:95]
    global_load_dwordx4 v[40:43], v28, s[34:35] offset:-4096 sc1
    s_add_u32 s75, s75, s93
    s_lshl_b32 s75, s75, 7
    s_waitcnt lgkmcnt(2)
    v_mfma_f32_32x32x16_bf16 v[96:111], a[56:59], v[20:23], v[96:111]
    s_add_u32 s87, s75, 0x38000
    s_lshr_b32 s73, s68, 1
    s_waitcnt lgkmcnt(1)
    v_mfma_f32_32x32x16_bf16 v[80:95], a[40:43], v[24:27], v[80:95]
    global_load_dwordx4 v[44:47], v29, s[34:35] offset:-4096 sc1
    s_sub_u32 s73, 6, s73
    v_min_u32 v36, s73, v1
    s_waitcnt lgkmcnt(0)
    v_mfma_f32_32x32x16_bf16 v[96:111], a[60:63], v[24:27], v[96:111]
    v_add_u32 v36, 7, v36
    v_lshl_add_u32 v36, v36, 8, s80
    global_load_dwordx4 v[48:51], v30, s[34:35] offset:-4096 sc1
    global_load_dwordx4 v[52:55], v34, s[34:35] offset:-4096 sc1
    s_nop 7
    v_add_f32 v100, 0x358637bd, v100
    v_rcp_f32 v100, v100
    s_nop 0
    v_mul_f32 v100, 0x3fb8aa3b, v100
    v_pk_mul_f32 v[80:81], v[80:81], v[100:101] op_sel_hi:[1,0]
    v_pk_mul_f32 v[82:83], v[82:83], v[100:101] op_sel_hi:[1,0]
    v_pk_mul_f32 v[84:85], v[84:85], v[100:101] op_sel_hi:[1,0]
    v_pk_mul_f32 v[86:87], v[86:87], v[100:101] op_sel_hi:[1,0]
    v_pk_mul_f32 v[88:89], v[88:89], v[100:101] op_sel_hi:[1,0]
    v_pk_mul_f32 v[90:91], v[90:91], v[100:101] op_sel_hi:[1,0]
    v_pk_mul_f32 v[92:93], v[92:93], v[100:101] op_sel_hi:[1,0]
    v_pk_mul_f32 v[94:95], v[94:95], v[100:101] op_sel_hi:[1,0]
    v_pk_mul_f32 v[96:97], v[96:97], v[100:101] op_sel_hi:[1,0]
    v_pk_mul_f32 v[98:99], v[98:99], v[100:101] op_sel_hi:[1,0]
    v_cvt_pk_bf16_f32 v8, v80, v81
    v_cvt_pk_bf16_f32 v9, v82, v83
    v_cvt_pk_bf16_f32 v10, v84, v85
    v_cvt_pk_bf16_f32 v11, v86, v87
    v_cvt_pk_bf16_f32 v12, v88, v89
    v_cvt_pk_bf16_f32 v13, v90, v91
    v_cvt_pk_bf16_f32 v14, v92, v93
    v_cvt_pk_bf16_f32 v15, v94, v95
    v_cvt_pk_bf16_f32 v16, v96, v97
    v_cvt_pk_bf16_f32 v17, v98, v99
    buffer_store_dwordx4 v[8:11], v252, s[40:43], s81 offen sc1
    buffer_store_dwordx4 v[12:15], v252, s[40:43], s81 offen offset:256 sc1
    buffer_store_dwordx2 v[16:17], v253, s[40:43], s82 offen sc1
    global_load_dwordx4 v[80:83], v28, s[34:35] offset:0 sc1
    global_load_dwordx4 v[84:87], v29, s[34:35] offset:0 sc1
    global_load_dwordx4 v[88:91], v30, s[34:35] offset:0 sc1
    global_load_dwordx4 v[92:95], v34, s[34:35] offset:0 sc1
    s_waitcnt vmcnt(22)
    v_mfma_f32_16x16x32_bf16 v[8:11], a[160:163], v[64:67], 0
    global_load_dwordx4 v[96:99], v28, s[36:37] offset:0 sc1
    v_mfma_f32_16x16x32_bf16 v[12:15], a[164:167], v[64:67], 0
    buffer_load_dword v38, v36, s[40:43], 0 offen sc1
    v_mfma_f32_16x16x32_bf16 v[16:19], a[168:171], v[64:67], 0
    v_mfma_f32_16x16x32_bf16 v[20:23], a[172:175], v[64:67], 0
    v_mfma_f32_16x16x32_bf16 v[24:27], a[176:179], v[64:67], 0
    global_load_dwordx4 v[100:103], v29, s[36:37] offset:0 sc1
    s_waitcnt vmcnt(24)
    v_mfma_f32_16x16x32_bf16 a[20:23], a[160:163], v[68:71], 0
    v_mfma_f32_16x16x32_bf16 a[24:27], a[164:167], v[68:71], 0
    v_mfma_f32_16x16x32_bf16 a[28:31], a[168:171], v[68:71], 0
    v_mfma_f32_16x16x32_bf16 a[32:35], a[172:175], v[68:71], 0
    global_load_dwordx4 v[104:107], v30, s[36:37] offset:0 sc1
    v_mfma_f32_16x16x32_bf16 a[36:39], a[176:179], v[68:71], 0
    s_waitcnt vmcnt(24)
    v_mfma_f32_16x16x32_bf16 a[40:43], a[160:163], v[72:75], 0
    v_mfma_f32_16x16x32_bf16 a[44:47], a[164:167], v[72:75], 0
    v_mfma_f32_16x16x32_bf16 a[48:51], a[168:171], v[72:75], 0
    global_load_dwordx4 v[108:111], v34, s[36:37] offset:0 sc1
    v_mfma_f32_16x16x32_bf16 a[52:55], a[172:175], v[72:75], 0
    v_mfma_f32_16x16x32_bf16 a[56:59], a[176:179], v[72:75], 0
    s_waitcnt vmcnt(24)
    v_mfma_f32_16x16x32_bf16 a[60:63], a[160:163], v[76:79], 0
    v_mfma_f32_16x16x32_bf16 a[64:67], a[164:167], v[76:79], 0
    v_mfma_f32_16x16x32_bf16 a[68:71], a[168:171], v[76:79], 0
    buffer_load_dwordx4 a[144:147], v6, s[48:51], s27 offen offset:1024 sc1
    v_mfma_f32_16x16x32_bf16 a[72:75], a[172:175], v[76:79], 0
    v_mfma_f32_16x16x32_bf16 a[76:79], a[176:179], v[76:79], 0
    s_waitcnt vmcnt(20)
    v_mfma_f32_16x16x32_bf16 v[8:11], a[180:183], v[112:115], v[8:11]
    v_mfma_f32_16x16x32_bf16 v[12:15], a[184:187], v[112:115], v[12:15]
    buffer_load_dwordx4 a[148:151], v6, s[48:51], s27 offen offset:2048 sc1
    v_mfma_f32_16x16x32_bf16 v[16:19], a[188:191], v[112:115], v[16:19]
    v_mfma_f32_16x16x32_bf16 v[20:23], a[192:195], v[112:115], v[20:23]
    v_mfma_f32_16x16x32_bf16 v[24:27], a[196:199], v[112:115], v[24:27]
    s_waitcnt vmcnt(20)
    v_mfma_f32_16x16x32_bf16 a[20:23], a[180:183], v[116:119], a[20:23]
    buffer_load_dwordx4 a[152:155], v6, s[48:51], s27 offen offset:3072 sc1
    v_mfma_f32_16x16x32_bf16 a[24:27], a[184:187], v[116:119], a[24:27]
    v_mfma_f32_16x16x32_bf16 a[28:31], a[188:191], v[116:119], a[28:31]
    v_mfma_f32_16x16x32_bf16 a[32:35], a[192:195], v[116:119], a[32:35]
    v_mfma_f32_16x16x32_bf16 a[36:39], a[196:199], v[116:119], a[36:39]
    s_mov_b32 s27, 0x42000
    s_waitcnt vmcnt(20)
    v_mfma_f32_16x16x32_bf16 a[40:43], a[180:183], v[120:123], a[40:43]
    buffer_load_dwordx4 a[156:159], v6, s[48:51], s27 offen offset:0 sc1
    s_waitcnt vmcnt(13)
    s_barrier
    v_mov_b32 v35, s72
    buffer_store_dword v35, v32, s[40:43], s87 offen sc1
    v_mfma_f32_16x16x32_bf16 a[44:47], a[184:187], v[120:123], a[44:47]
    v_mfma_f32_16x16x32_bf16 a[48:51], a[188:191], v[120:123], a[48:51]
    v_mfma_f32_16x16x32_bf16 a[52:55], a[192:195], v[120:123], a[52:55]
    s_add_u32 s38, s40, 28672
    s_addc_u32 s39, s41, 0
    v_mfma_f32_16x16x32_bf16 a[56:59], a[196:199], v[120:123], a[56:59]
    global_load_dwordx4 v[64:67], v28, s[38:39] offset:-4096 sc1
    v_mfma_f32_16x16x32_bf16 a[60:63], a[180:183], v[124:127], a[60:63]
    v_mfma_f32_16x16x32_bf16 a[64:67], a[184:187], v[124:127], a[64:67]
    v_mfma_f32_16x16x32_bf16 a[68:71], a[188:191], v[124:127], a[68:71]
    v_mfma_f32_16x16x32_bf16 a[72:75], a[192:195], v[124:127], a[72:75]
    global_load_dwordx4 v[68:71], v29, s[38:39] offset:-4096 sc1
    v_mfma_f32_16x16x32_bf16 a[76:79], a[196:199], v[124:127], a[76:79]
    v_mfma_f32_16x16x32_bf16 v[8:11], a[200:203], v[40:43], v[8:11]
    s_lshr_b32 s73, s95, 2
    v_mfma_f32_16x16x32_bf16 v[12:15], a[204:207], v[40:43], v[12:15]
    s_lshl_b32 s73, s73, 12
    v_mfma_f32_16x16x32_bf16 v[16:19], a[208:211], v[40:43], v[16:19]
    global_load_dwordx4 v[72:75], v30, s[38:39] offset:-4096 sc1
    s_add_u32 s73, s73, 0x38000
    v_mfma_f32_16x16x32_bf16 v[20:23], a[212:215], v[40:43], v[20:23]
    s_lshl_b32 s74, s68, 1
    v_mfma_f32_16x16x32_bf16 v[24:27], a[216:219], v[40:43], v[24:27]
    v_bfe_u32 v37, v1, 1, 2
    v_mfma_f32_16x16x32_bf16 a[20:23], a[200:203], v[44:47], a[20:23]
    v_lshl_add_u32 v37, v37, 3, s74
    v_mfma_f32_16x16x32_bf16 a[24:27], a[204:207], v[44:47], a[24:27]
    v_and_b32 v63, 1, v1
    v_mfma_f32_16x16x32_bf16 a[28:31], a[208:211], v[44:47], a[28:31]
    global_load_dwordx4 v[76:79], v34, s[38:39] offset:-4096 sc1
    v_add_u32 v37, v37, v63
    v_mfma_f32_16x16x32_bf16 a[32:35], a[212:215], v[44:47], a[32:35]
    s_lshl_b32 s74, s68, 3
    v_mfma_f32_16x16x32_bf16 a[36:39], a[216:219], v[44:47], a[36:39]
    v_and_b32 v63, 7, v1
    v_mfma_f32_16x16x32_bf16 a[40:43], a[200:203], v[48:51], a[40:43]
    s_waitcnt vmcnt(12)
    v_cmp_ne_u32 vcc, s72, v38
    s_nop 4
    s_cbranch_vccnz Lslow10
Lback10:
    v_add_u32 v63, s74, v63
    v_mfma_f32_16x16x32_bf16 a[44:47], a[204:207], v[48:51], a[44:47]
    global_load_dwordx4 v[112:115], v28, s[38:39] offset:0 sc1
    v_mfma_f32_16x16x32_bf16 a[48:51], a[208:211], v[48:51], a[48:51]
    v_cmp_gt_u32 vcc, 8, v1
    s_nop 1
    v_cndmask_b32 v37, v63, v37, vcc
    v_mfma_f32_16x16x32_bf16 a[52:55], a[212:215], v[48:51], a[52:55]
    v_mfma_f32_16x16x32_bf16 a[56:59], a[216:219], v[48:51], a[56:59]
    v_lshlrev_b32 v37, 7, v37
    v_mfma_f32_16x16x32_bf16 a[60:63], a[200:203], v[52:55], a[60:63]
    global_load_dwordx4 v[116:119], v29, s[38:39] offset:0 sc1
    v_add_u32 v37, s73, v37
    v_mfma_f32_16x16x32_bf16 a[64:67], a[204:207], v[52:55], a[64:67]
    s_lshl_b32 s73, s95, 6
    v_mfma_f32_16x16x32_bf16 a[68:71], a[208:211], v[52:55], a[68:71]
    s_lshl_b32 s74, s68, 4
    v_mfma_f32_16x16x32_bf16 a[72:75], a[212:215], v[52:55], a[72:75]
    s_add_u32 s73, s73, s74
    v_mfma_f32_16x16x32_bf16 a[76:79], a[216:219], v[52:55], a[76:79]
    s_mul_i32 s73, s73, 1280
    v_mfma_f32_16x16x32_bf16 v[8:11], a[220:223], v[80:83], v[8:11]
    global_load_dwordx4 v[120:123], v30, s[38:39] offset:0 sc1
    s_mul_i32 s89, s96, 160
    v_mfma_f32_16x16x32_bf16 v[12:15], a[224:227], v[80:83], v[12:15]
    s_add_u32 s89, s89, s73
    v_mfma_f32_16x16x32_bf16 v[16:19], a[228:231], v[80:83], v[16:19]
    v_and_b32 v39, 15, v1
    v_mfma_f32_16x16x32_bf16 v[20:23], a[232:235], v[80:83], v[20:23]
    v_mul_u32_u24 v62, 160, v39
    v_mfma_f32_16x16x32_bf16 v[24:27], a[236:239], v[80:83], v[24:27]
    global_load_dwordx4 v[124:127], v34, s[38:39] offset:0 sc1
    v_mul_u32_u24 v39, 1280, v39
    v_mfma_f32_16x16x32_bf16 a[20:23], a[220:223], v[84:87], a[20:23]
    v_lshrrev_b32 v59, 4, v1
    v_mfma_f32_16x16x32_bf16 a[24:27], a[224:227], v[84:87], a[24:27]
    v_lshl_add_u32 v39, v59, 3, v39
    v_mfma_f32_16x16x32_bf16 a[28:31], a[228:231], v[84:87], a[28:31]
    v_lshl_add_u32 v62, v59, 3, v62
    s_add_u32 s52, s40, 36864
    s_addc_u32 s53, s41, 0
    v_mfma_f32_16x16x32_bf16 a[32:35], a[232:235], v[84:87], a[32:35]
    global_load_dwordx4 a[180:183], v28, s[52:53] offset:-4096 sc1
    v_add_u32 v39, s89, v39
    v_mfma_f32_16x16x32_bf16 a[36:39], a[236:239], v[84:87], a[36:39]
    v_mfma_f32_16x16x32_bf16 a[40:43], a[220:223], v[88:91], a[40:43]
    s_mul_i32 s88, s68, 3072
    v_mfma_f32_16x16x32_bf16 a[44:47], a[224:227], v[88:91], a[44:47]
    s_add_u32 s88, s88, 61440
    v_mfma_f32_16x16x32_bf16 a[48:51], a[228:231], v[88:91], a[48:51]
    v_add_u32 v62, s88, v62
    v_mfma_f32_16x16x32_bf16 a[52:55], a[232:235], v[88:91], a[52:55]
    global_load_dwordx4 a[184:187], v29, s[52:53] offset:-4096 sc1
    s_add_u32 s79, s79, 73728
    v_mfma_f32_16x16x32_bf16 a[56:59], a[236:239], v[88:91], a[56:59]
    v_and_b32 v2, 15, v1
    v_mfma_f32_16x16x32_bf16 a[60:63], a[220:223], v[92:95], a[60:63]
    v_lshlrev_b32 v2, 3, v2
    v_mfma_f32_16x16x32_bf16 a[64:67], a[224:227], v[92:95], a[64:67]
    v_lshl_add_u32 v59, v59, 8, v2
    v_mfma_f32_16x16x32_bf16 a[68:71], a[228:231], v[92:95], a[68:71]
    global_load_dwordx4 a[188:191], v30, s[52:53] offset:-4096 sc1
    v_add_u32 v59, s79, v59
    v_mfma_f32_16x16x32_bf16 a[72:75], a[232:235], v[92:95], a[72:75]
    v_add_u32 v2, s83, v59
    v_mfma_f32_16x16x32_bf16 a[76:79], a[236:239], v[92:95], a[76:79]
    v_add_u32 v3, s84, v59
    v_mfma_f32_16x16x32_bf16 v[8:11], v[128:131], a[0:3], v[8:11]
    v_add_u32 v4, s85, v59
    v_mfma_f32_16x16x32_bf16 v[12:15], v[132:135], a[0:3], v[12:15]
    global_load_dwordx4 a[192:195], v34, s[52:53] offset:-4096 sc1
    v_add_u32 v5, s86, v59
    v_mfma_f32_16x16x32_bf16 v[16:19], v[136:139], a[0:3], v[16:19]
    v_add_u32 v31, 0, v1
    v_mfma_f32_16x16x32_bf16 v[20:23], v[140:143], a[0:3], v[20:23]
    v_min_u32 v31, 159, v31
    v_mfma_f32_16x16x32_bf16 v[24:27], v[144:147], a[0:3], v[24:27]
    v_mul_u32_u24 v63, 6554, v31
    v_mfma_f32_16x16x32_bf16 a[20:23], v[128:131], a[4:7], a[20:23]
    global_load_dwordx4 v[40:43], v28, s[52:53] offset:0 sc1
    v_lshrrev_b32 v63, 16, v63
    v_mfma_f32_16x16x32_bf16 a[24:27], v[132:135], a[4:7], a[24:27]
    v_mul_u32_u24 v63, 1120, v63
    v_mfma_f32_16x16x32_bf16 a[28:31], v[136:139], a[4:7], a[28:31]
    v_lshl_add_u32 v31, v31, 4, v63
    v_mfma_f32_16x16x32_bf16 a[32:35], v[140:143], a[4:7], a[32:35]
    v_add_u32 v33, 64, v1
    v_mfma_f32_16x16x32_bf16 a[36:39], v[144:147], a[4:7], a[36:39]
    v_min_u32 v33, 159, v33
    v_mfma_f32_16x16x32_bf16 a[40:43], v[128:131], a[8:11], a[40:43]
    global_load_dwordx4 v[44:47], v29, s[52:53] offset:0 sc1
    v_mul_u32_u24 v63, 6554, v33
    v_mfma_f32_16x16x32_bf16 a[44:47], v[132:135], a[8:11], a[44:47]
    v_lshrrev_b32 v63, 16, v63
    v_mfma_f32_16x16x32_bf16 a[48:51], v[136:139], a[8:11], a[48:51]
    v_mul_u32_u24 v63, 1120, v63
    v_mfma_f32_16x16x32_bf16 a[52:55], v[140:143], a[8:11], a[52:55]
    v_lshl_add_u32 v33, v33, 4, v63
    v_mfma_f32_16x16x32_bf16 a[56:59], v[144:147], a[8:11], a[56:59]
    global_load_dwordx4 v[48:51], v30, s[52:53] offset:0 sc1
    v_add_u32 v61, 128, v1
    v_mfma_f32_16x16x32_bf16 a[60:63], v[128:131], a[12:15], a[60:63]
    v_min_u32 v61, 159, v61
    v_mfma_f32_16x16x32_bf16 a[64:67], v[132:135], a[12:15], a[64:67]
    v_mul_u32_u24 v63, 6554, v61
    v_mfma_f32_16x16x32_bf16 a[68:71], v[136:139], a[12:15], a[68:71]
    v_lshrrev_b32 v63, 16, v63
    v_mfma_f32_16x16x32_bf16 a[72:75], v[140:143], a[12:15], a[72:75]
    global_load_dwordx4 v[52:55], v34, s[52:53] offset:0 sc1
    v_mul_u32_u24 v63, 1120, v63
    v_mfma_f32_16x16x32_bf16 a[76:79], v[144:147], a[12:15], a[76:79]
    v_lshl_add_u32 v61, v61, 4, v63
    v_mfma_f32_16x16x32_bf16 v[8:11], v[148:151], v[96:99], v[8:11]
    v_mfma_f32_16x16x32_bf16 v[12:15], v[152:155], v[96:99], v[12:15]
    v_mfma_f32_16x16x32_bf16 v[16:19], v[156:159], v[96:99], v[16:19]
    s_add_u32 s54, s40, 45056
    s_addc_u32 s55, s41, 0
    v_mfma_f32_16x16x32_bf16 v[20:23], v[160:163], v[96:99], v[20:23]
    global_load_dwordx4 a[200:203], v28, s[54:55] offset:-4096 sc1
    v_mfma_f32_16x16x32_bf16 v[24:27], v[164:167], v[96:99], v[24:27]
    s_waitcnt vmcnt(24)
    v_mfma_f32_16x16x32_bf16 a[20:23], v[148:151], v[100:103], a[20:23]
    v_mfma_f32_16x16x32_bf16 a[24:27], v[152:155], v[100:103], a[24:27]
    v_mfma_f32_16x16x32_bf16 a[28:31], v[156:159], v[100:103], a[28:31]
    global_load_dwordx4 a[204:207], v29, s[54:55] offset:-4096 sc1
    v_mfma_f32_16x16x32_bf16 a[32:35], v[160:163], v[100:103], a[32:35]
    v_mfma_f32_16x16x32_bf16 a[36:39], v[164:167], v[100:103], a[36:39]
    s_waitcnt vmcnt(24)
    v_mfma_f32_16x16x32_bf16 a[40:43], v[148:151], v[104:107], a[40:43]
    v_mfma_f32_16x16x32_bf16 a[44:47], v[152:155], v[104:107], a[44:47]
    global_load_dwordx4 a[208:211], v30, s[54:55] offset:-4096 sc1
    v_mfma_f32_16x16x32_bf16 a[48:51], v[156:159], v[104:107], a[48:51]
    v_mfma_f32_16x16x32_bf16 a[52:55], v[160:163], v[104:107], a[52:55]
    v_mfma_f32_16x16x32_bf16 a[56:59], v[164:167], v[104:107], a[56:59]
    s_waitcnt vmcnt(24)
    v_mfma_f32_16x16x32_bf16 a[60:63], v[148:151], v[108:111], a[60:63]
    v_mfma_f32_16x16x32_bf16 a[64:67], v[152:155], v[108:111], a[64:67]
    global_load_dwordx4 a[212:215], v34, s[54:55] offset:-4096 sc1
    v_mfma_f32_16x16x32_bf16 a[68:71], v[156:159], v[108:111], a[68:71]
    v_mfma_f32_16x16x32_bf16 a[72:75], v[160:163], v[108:111], a[72:75]
    v_mfma_f32_16x16x32_bf16 a[76:79], v[164:167], v[108:111], a[76:79]
    s_waitcnt vmcnt(19)
    v_mfma_f32_16x16x32_bf16 v[8:11], v[168:171], v[64:67], v[8:11]
    global_load_dwordx4 v[80:83], v28, s[54:55] offset:0 sc1
    v_mfma_f32_16x16x32_bf16 v[12:15], v[172:175], v[64:67], v[12:15]
    v_mfma_f32_16x16x32_bf16 v[16:19], v[176:179], v[64:67], v[16:19]
    v_mfma_f32_16x16x32_bf16 v[20:23], v[180:183], v[64:67], v[20:23]
    v_mfma_f32_16x16x32_bf16 v[24:27], v[184:187], v[64:67], v[24:27]
    global_load_dwordx4 v[84:87], v29, s[54:55] offset:0 sc1
    s_waitcnt vmcnt(20)
    v_mfma_f32_16x16x32_bf16 a[20:23], v[168:171], v[68:71], a[20:23]
    v_mfma_f32_16x16x32_bf16 a[24:27], v[172:175], v[68:71], a[24:27]
    v_mfma_f32_16x16x32_bf16 a[28:31], v[176:179], v[68:71], a[28:31]
    v_mfma_f32_16x16x32_bf16 a[32:35], v[180:183], v[68:71], a[32:35]
    global_load_dwordx4 v[88:91], v30, s[54:55] offset:0 sc1
    v_mfma_f32_16x16x32_bf16 a[36:39], v[184:187], v[68:71], a[36:39]
    s_waitcnt vmcnt(20)
    v_mfma_f32_16x16x32_bf16 a[40:43], v[168:171], v[72:75], a[40:43]
    v_mfma_f32_16x16x32_bf16 a[44:47], v[172:175], v[72:75], a[44:47]
    v_mfma_f32_16x16x32_bf16 a[48:51], v[176:179], v[72:75], a[48:51]
    v_mfma_f32_16x16x32_bf16 a[52:55], v[180:183], v[72:75], a[52:55]
    global_load_dwordx4 v[92:95], v34, s[54:55] offset:0 sc1
    v_mfma_f32_16x16x32_bf16 a[56:59], v[184:187], v[72:75], a[56:59]
    s_waitcnt vmcnt(20)
    v_mfma_f32_16x16x32_bf16 a[60:63], v[168:171], v[76:79], a[60:63]
    v_mfma_f32_16x16x32_bf16 a[64:67], v[172:175], v[76:79], a[64:67]
    s_add_u32 s56, s40, 53248
    s_addc_u32 s57, s41, 0
    v_mfma_f32_16x16x32_bf16 a[68:71], v[176:179], v[76:79], a[68:71]
    global_load_dwordx4 a[220:223], v28, s[56:57] offset:-4096 sc1
    v_mfma_f32_16x16x32_bf16 a[72:75], v[180:183], v[76:79], a[72:75]
    v_mfma_f32_16x16x32_bf16 a[76:79], v[184:187], v[76:79], a[76:79]
    s_waitcnt vmcnt(20)
    v_mfma_f32_16x16x32_bf16 v[8:11], v[188:191], v[112:115], v[8:11]
    v_mfma_f32_16x16x32_bf16 v[12:15], v[192:195], v[112:115], v[12:15]
    global_load_dwordx4 a[224:227], v29, s[56:57] offset:-4096 sc1
    v_mfma_f32_16x16x32_bf16 v[16:19], v[196:199], v[112:115], v[16:19]
    v_mfma_f32_16x16x32_bf16 v[20:23], v[200:203], v[112:115], v[20:23]
    v_mfma_f32_16x16x32_bf16 v[24:27], v[204:207], v[112:115], v[24:27]
    s_waitcnt vmcnt(20)
    v_mfma_f32_16x16x32_bf16 a[20:23], v[188:191], v[116:119], a[20:23]
    v_mfma_f32_16x16x32_bf16 a[24:27], v[192:195], v[116:119], a[24:27]
    global_load_dwordx4 a[228:231], v30, s[56:57] offset:-4096 sc1
    v_mfma_f32_16x16x32_bf16 a[28:31], v[196:199], v[116:119], a[28:31]
    v_mfma_f32_16x16x32_bf16 a[32:35], v[200:203], v[116:119], a[32:35]
    v_mfma_f32_16x16x32_bf16 a[36:39], v[204:207], v[116:119], a[36:39]
    s_waitcnt vmcnt(20)
    v_mfma_f32_16x16x32_bf16 a[40:43], v[188:191], v[120:123], a[40:43]
    global_load_dwordx4 a[232:235], v34, s[56:57] offset:-4096 sc1
    v_mfma_f32_16x16x32_bf16 a[44:47], v[192:195], v[120:123], a[44:47]
    v_mfma_f32_16x16x32_bf16 a[48:51], v[196:199], v[120:123], a[48:51]
    v_mfma_f32_16x16x32_bf16 a[52:55], v[200:203], v[120:123], a[52:55]
    s_mov_b32 s26, 0xd000
    v_mfma_f32_16x16x32_bf16 a[56:59], v[204:207], v[120:123], a[56:59]
    buffer_load_dwordx4 a[0:3], v28, s[48:51], s26 offen sc1
    s_waitcnt vmcnt(21)
    v_mfma_f32_16x16x32_bf16 a[60:63], v[188:191], v[124:127], a[60:63]
    v_mfma_f32_16x16x32_bf16 a[64:67], v[192:195], v[124:127], a[64:67]
    v_mfma_f32_16x16x32_bf16 a[68:71], v[196:199], v[124:127], a[68:71]
    v_mfma_f32_16x16x32_bf16 a[72:75], v[200:203], v[124:127], a[72:75]
    v_mfma_f32_16x16x32_bf16 a[76:79], v[204:207], v[124:127], a[76:79]
    buffer_load_dwordx4 a[4:7], v29, s[48:51], s26 offen sc1
    s_waitcnt vmcnt(21)
    v_mfma_f32_16x16x32_bf16 v[8:11], v[208:211], a[180:183], v[8:11]
    v_mfma_f32_16x16x32_bf16 v[12:15], v[212:215], a[180:183], v[12:15]
    v_mfma_f32_16x16x32_bf16 v[16:19], v[216:219], a[180:183], v[16:19]
    v_mfma_f32_16x16x32_bf16 v[20:23], v[220:223], a[180:183], v[20:23]
    buffer_load_dwordx4 a[8:11], v30, s[48:51], s26 offen sc1
    v_mfma_f32_16x16x32_bf16 v[24:27], v[224:227], a[180:183], v[24:27]
    s_waitcnt vmcnt(21)
    v_mfma_f32_16x16x32_bf16 a[20:23], v[208:211], a[184:187], a[20:23]
    buffer_load_dword v38, v37, s[40:43], 0 offen sc1
    v_mfma_f32_16x16x32_bf16 a[24:27], v[212:215], a[184:187], a[24:27]
    v_mfma_f32_16x16x32_bf16 a[28:31], v[216:219], a[184:187], a[28:31]
    buffer_load_dwordx4 a[12:15], v34, s[48:51], s26 offen sc1
    v_mfma_f32_16x16x32_bf16 a[32:35], v[220:223], a[184:187], a[32:35]
    v_mfma_f32_16x16x32_bf16 a[36:39], v[224:227], a[184:187], a[36:39]
    s_waitcnt vmcnt(22)
    v_mfma_f32_16x16x32_bf16 a[40:43], v[208:211], a[188:191], a[40:43]
    v_mfma_f32_16x16x32_bf16 a[44:47], v[212:215], a[188:191], a[44:47]
    v_add_u32 v7, 350208, v6
    v_mfma_f32_16x16x32_bf16 a[48:51], v[216:219], a[188:191], a[48:51]
    global_load_dwordx4 a[160:163], v7, s[40:41] offset:-2048 sc1
    v_mfma_f32_16x16x32_bf16 a[52:55], v[220:223], a[188:191], a[52:55]
    v_mfma_f32_16x16x32_bf16 a[56:59], v[224:227], a[188:191], a[56:59]
    s_waitcnt vmcnt(22)
    v_mfma_f32_16x16x32_bf16 a[60:63], v[208:211], a[192:195], a[60:63]
    v_mfma_f32_16x16x32_bf16 a[64:67], v[212:215], a[192:195], a[64:67]
    global_load_dwordx4 a[164:167], v7, s[40:41] offset:-1024 sc1
    v_mfma_f32_16x16x32_bf16 a[68:71], v[216:219], a[192:195], a[68:71]
    v_mfma_f32_16x16x32_bf16 a[72:75], v[220:223], a[192:195], a[72:75]
    v_mfma_f32_16x16x32_bf16 a[76:79], v[224:227], a[192:195], a[76:79]
    s_waitcnt vmcnt(22)
    v_mfma_f32_16x16x32_bf16 v[8:11], v[228:231], v[40:43], v[8:11]
    global_load_dwordx4 a[168:171], v7, s[40:41] offset:0 sc1
    v_mfma_f32_16x16x32_bf16 v[12:15], v[232:235], v[40:43], v[12:15]
    v_lshlrev_b32 v60, 4, v1
    v_mfma_f32_16x16x32_bf16 v[16:19], v[236:239], v[40:43], v[16:19]
    v_mfma_f32_16x16x32_bf16 v[20:23], v[240:243], v[40:43], v[20:23]
    v_add_u32 v60, s91, v60
    v_mfma_f32_16x16x32_bf16 v[24:27], v[244:247], v[40:43], v[24:27]
    global_load_dwordx4 a[172:175], v7, s[40:41] offset:1024 sc1
    s_waitcnt vmcnt(23)
    v_mfma_f32_16x16x32_bf16 a[20:23], v[228:231], v[44:47], a[20:23]
    v_mfma_f32_16x16x32_bf16 a[24:27], v[232:235], v[44:47], a[24:27]
    v_mfma_f32_16x16x32_bf16 a[28:31], v[236:239], v[44:47], a[28:31]
    v_mfma_f32_16x16x32_bf16 a[32:35], v[240:243], v[44:47], a[32:35]
    v_mfma_f32_16x16x32_bf16 a[36:39], v[244:247], v[44:47], a[36:39]
    global_load_dwordx4 a[176:179], v7, s[40:41] offset:2048 sc1
    s_waitcnt vmcnt(23)
    v_mfma_f32_16x16x32_bf16 a[40:43], v[228:231], v[48:51], a[40:43]
    v_mfma_f32_16x16x32_bf16 a[44:47], v[232:235], v[48:51], a[44:47]
    v_mfma_f32_16x16x32_bf16 a[48:51], v[236:239], v[48:51], a[48:51]
    s_add_u32 m0, s88, 0
    v_mfma_f32_16x16x32_bf16 a[52:55], v[240:243], v[48:51], a[52:55]
    buffer_load_dwordx4 v31, s[28:31], s89 offen lds
    v_mfma_f32_16x16x32_bf16 a[56:59], v[244:247], v[48:51], a[56:59]
    s_waitcnt vmcnt(23)
    v_mfma_f32_16x16x32_bf16 a[60:63], v[228:231], v[52:55], a[60:63]
    v_mfma_f32_16x16x32_bf16 a[64:67], v[232:235], v[52:55], a[64:67]
    v_mfma_f32_16x16x32_bf16 a[68:71], v[236:239], v[52:55], a[68:71]
    v_mfma_f32_16x16x32_bf16 a[72:75], v[240:243], v[52:55], a[72:75]
    v_mfma_f32_16x16x32_bf16 a[76:79], v[244:247], v[52:55], a[76:79]
    s_add_u32 m0, s88, 1024
    s_waitcnt vmcnt(22)
    v_mfma_f32_16x16x32_bf16 v[8:11], a[80:83], a[200:203], v[8:11]
    buffer_load_dwordx4 v33, s[28:31], s89 offen lds
    ds_read_b128 v[168:171], v60 offset:0
    v_mfma_f32_16x16x32_bf16 v[12:15], a[84:87], a[200:203], v[12:15]
    v_mfma_f32_16x16x32_bf16 v[16:19], a[88:91], a[200:203], v[16:19]
    v_mfma_f32_16x16x32_bf16 v[20:23], a[92:95], a[200:203], v[20:23]
    v_mfma_f32_16x16x32_bf16 v[24:27], a[96:99], a[200:203], v[24:27]
    ds_read_b128 v[172:175], v60 offset:1024
    s_waitcnt vmcnt(22)
    v_mfma_f32_16x16x32_bf16 a[20:23], a[80:83], a[204:207], a[20:23]
    v_mfma_f32_16x16x32_bf16 a[24:27], a[84:87], a[204:207], a[24:27]
    v_mfma_f32_16x16x32_bf16 a[28:31], a[88:91], a[204:207], a[28:31]
    s_add_u32 m0, s88, 2048
    v_mfma_f32_16x16x32_bf16 a[32:35], a[92:95], a[204:207], a[32:35]
    buffer_load_dwordx4 v61, s[28:31], s89 offen lds
    ds_read_b128 v[176:179], v60 offset:2048
    v_mfma_f32_16x16x32_bf16 a[36:39], a[96:99], a[204:207], a[36:39]
    s_waitcnt vmcnt(22)
    v_mfma_f32_16x16x32_bf16 a[40:43], a[80:83], a[208:211], a[40:43]
    v_mfma_f32_16x16x32_bf16 a[44:47], a[84:87], a[208:211], a[44:47]
    v_mfma_f32_16x16x32_bf16 a[48:51], a[88:91], a[208:211], a[48:51]
    ds_read_b128 v[180:183], v60 offset:3072
    v_mfma_f32_16x16x32_bf16 a[52:55], a[92:95], a[208:211], a[52:55]
    v_mfma_f32_16x16x32_bf16 a[56:59], a[96:99], a[208:211], a[56:59]
    s_waitcnt vmcnt(9)
    v_cmp_ne_u32 vcc, s72, v38
    s_nop 4
    s_cbranch_vccnz Lslow11
Lback11:
    s_add_u32 s58, s40, 61440
    s_addc_u32 s59, s41, 0
    v_mfma_f32_16x16x32_bf16 a[60:63], a[80:83], a[212:215], a[60:63]
    global_load_dwordx4 v[96:99], v28, s[58:59] offset:-4096 sc1
    v_mfma_f32_16x16x32_bf16 a[64:67], a[84:87], a[212:215], a[64:67]
    ds_read_b128 v[184:187], v60 offset:4096
    v_mfma_f32_16x16x32_bf16 a[68:71], a[88:91], a[212:215], a[68:71]
    v_mfma_f32_16x16x32_bf16 a[72:75], a[92:95], a[212:215], a[72:75]
    v_mfma_f32_16x16x32_bf16 a[76:79], a[96:99], a[212:215], a[76:79]
    global_load_dwordx4 v[100:103], v29, s[58:59] offset:-4096 sc1
    v_mfma_f32_16x16x32_bf16 v[8:11], a[100:103], v[80:83], v[8:11]
    ds_read_b128 v[188:191], v60 offset:5120
    v_mfma_f32_16x16x32_bf16 v[12:15], a[104:107], v[80:83], v[12:15]
    v_mfma_f32_16x16x32_bf16 v[16:19], a[108:111], v[80:83], v[16:19]
    v_mfma_f32_16x16x32_bf16 v[20:23], a[112:115], v[80:83], v[20:23]
    v_mfma_f32_16x16x32_bf16 v[24:27], a[116:119], v[80:83], v[24:27]
    global_load_dwordx4 v[104:107], v30, s[58:59] offset:-4096 sc1
    ds_read_b128 v[192:195], v60 offset:6144
    v_mfma_f32_16x16x32_bf16 a[20:23], a[100:103], v[84:87], a[20:23]
    v_mfma_f32_16x16x32_bf16 a[24:27], a[104:107], v[84:87], a[24:27]
    v_mfma_f32_16x16x32_bf16 a[28:31], a[108:111], v[84:87], a[28:31]
    v_mfma_f32_16x16x32_bf16 a[32:35], a[112:115], v[84:87], a[32:35]
    global_load_dwordx4 v[108:111], v34, s[58:59] offset:-4096 sc1
    ds_read_b128 v[196:199], v60 offset:7168
    v_mfma_f32_16x16x32_bf16 a[36:39], a[116:119], v[84:87], a[36:39]
    v_mfma_f32_16x16x32_bf16 a[40:43], a[100:103], v[88:91], a[40:43]
    v_mfma_f32_16x16x32_bf16 a[44:47], a[104:107], v[88:91], a[44:47]
    v_mfma_f32_16x16x32_bf16 a[48:51], a[108:111], v[88:91], a[48:51]
    global_load_dwordx4 v[76:79], v34, s[58:59] offset:0 sc1
    ds_read_b128 v[200:203], v60 offset:8192
    v_mfma_f32_16x16x32_bf16 a[52:55], a[112:115], v[88:91], a[52:55]
    v_mfma_f32_16x16x32_bf16 a[56:59], a[116:119], v[88:91], a[56:59]
    v_mfma_f32_16x16x32_bf16 a[60:63], a[100:103], v[92:95], a[60:63]
    s_add_u32 s64, s40, 69632
    s_addc_u32 s65, s41, 0
    v_mfma_f32_16x16x32_bf16 a[64:67], a[104:107], v[92:95], a[64:67]
    global_load_dwordx4 v[140:143], v34, s[64:65] offset:-4096 sc1
    ds_read_b128 v[204:207], v60 offset:9216
    v_mfma_f32_16x16x32_bf16 a[68:71], a[108:111], v[92:95], a[68:71]
    v_mfma_f32_16x16x32_bf16 a[72:75], a[112:115], v[92:95], a[72:75]
    v_mfma_f32_16x16x32_bf16 a[76:79], a[116:119], v[92:95], a[76:79]
    v_mfma_f32_16x16x32_bf16 v[8:11], a[120:123], a[220:223], v[8:11]
    ds_read_b128 v[208:211], v60 offset:10240
    s_mul_i32 s73, s68, 15360
    v_mfma_f32_16x16x32_bf16 v[12:15], a[124:127], a[220:223], v[12:15]
    global_load_dwordx4 v[124:127], v34, s[64:65] offset:0 sc1
    v_lshlrev_b32 v56, 4, v1
    v_mfma_f32_16x16x32_bf16 v[16:19], a[128:131], a[220:223], v[16:19]
    v_add_u32 v59, s73, v56
    v_mfma_f32_16x16x32_bf16 v[20:23], a[132:135], a[220:223], v[20:23]
    s_add_u32 s73, s68, 3
    s_and_b32 s73, s73, 3
    v_mfma_f32_16x16x32_bf16 v[24:27], a[136:139], a[220:223], v[24:27]
    ds_read_b128 v[212:215], v60 offset:11264
    s_mul_i32 s73, s73, 15360
    v_mfma_f32_16x16x32_bf16 a[20:23], a[120:123], a[224:227], a[20:23]
    buffer_load_dwordx2 v[52:53], v5, s[40:43], 0 offen sc1
    s_add_u32 s82, s73, 10240
    v_mfma_f32_16x16x32_bf16 a[24:27], a[124:127], a[224:227], a[24:27]
    v_add_u32 v58, s82, v56
    v_mfma_f32_16x16x32_bf16 a[28:31], a[128:131], a[224:227], a[28:31]
    buffer_load_dwordx2 v[54:55], v5, s[40:43], 0 offen offset:128 sc1
    s_add_u32 s73, s68, 2
    v_mfma_f32_16x16x32_bf16 a[32:35], a[132:135], a[224:227], a[32:35]
    ds_read_b128 v[216:219], v60 offset:12288
    s_and_b32 s73, s73, 3
    v_add_u32 v7, 370688, v6
    v_mfma_f32_16x16x32_bf16 a[36:39], a[136:139], a[224:227], a[36:39]
    global_load_dwordx4 v[148:151], v7, s[40:41] offset:-2048 sc1
    s_mul_i32 s73, s73, 15360
    v_mfma_f32_16x16x32_bf16 a[40:43], a[120:123], a[228:231], a[40:43]
    s_add_u32 s81, s73, 5120
    v_add_u32 v57, s81, v56
    v_mfma_f32_16x16x32_bf16 a[44:47], a[124:127], a[228:231], a[44:47]
    s_add_u32 s73, s68, 1
    v_mfma_f32_16x16x32_bf16 a[48:51], a[128:131], a[228:231], a[48:51]
    ds_read_b128 v[220:223], v60 offset:13312
    s_and_b32 s73, s73, 3
    v_mfma_f32_16x16x32_bf16 a[52:55], a[132:135], a[228:231], a[52:55]
    s_mul_i32 s73, s73, 15360
    v_mfma_f32_16x16x32_bf16 a[56:59], a[136:139], a[228:231], a[56:59]
    global_load_dwordx4 v[152:155], v7, s[40:41] offset:-1024 sc1
    s_add_u32 s80, s73, 0
    v_mfma_f32_16x16x32_bf16 a[60:63], a[120:123], a[232:235], a[60:63]
    v_add_u32 v56, s80, v56
    v_mfma_f32_16x16x32_bf16 a[64:67], a[124:127], a[232:235], a[64:67]
    ds_read_b128 v[224:227], v60 offset:14336
    s_mov_b32 s90, 0x3f317218
    v_mfma_f32_16x16x32_bf16 a[68:71], a[128:131], a[232:235], a[68:71]
    v_cmp_gt_u32 vcc, 32, v1
    v_mov_b32 v63, 0x80000000
    s_nop 0
    v_cndmask_b32 v61, v63, v61, vcc
    v_mfma_f32_16x16x32_bf16 a[72:75], a[132:135], a[232:235], a[72:75]
    global_load_dwordx4 v[156:159], v7, s[40:41] offset:0 sc1
    v_mfma_f32_16x16x32_bf16 a[76:79], a[136:139], a[232:235], a[76:79]
    v_lshl_add_u32 v63, v1, 4, s88
    v_mfma_f32_16x16x32_bf16 v[8:11], a[140:143], a[0:3], v[8:11]
    v_mfma_f32_16x16x32_bf16 v[12:15], a[144:147], a[0:3], v[12:15]
    v_mfma_f32_16x16x32_bf16 v[16:19], a[148:151], a[0:3], v[16:19]
    global_load_dwordx4 v[160:163], v7, s[40:41] offset:1024 sc1
    v_mfma_f32_16x16x32_bf16 v[20:23], a[152:155], a[0:3], v[20:23]
    v_mfma_f32_16x16x32_bf16 v[24:27], a[156:159], a[0:3], v[24:27]
    v_mfma_f32_16x16x32_bf16 a[20:23], a[140:143], a[4:7], a[20:23]
    v_mfma_f32_16x16x32_bf16 a[24:27], a[144:147], a[4:7], a[24:27]
    v_mfma_f32_16x16x32_bf16 a[28:31], a[148:151], a[4:7], a[28:31]
    global_load_dwordx4 v[164:167], v7, s[40:41] offset:2048 sc1
    v_mfma_f32_16x16x32_bf16 a[32:35], a[152:155], a[4:7], a[32:35]
    v_mfma_f32_16x16x32_bf16 a[36:39], a[156:159], a[4:7], a[36:39]
    v_mfma_f32_16x16x32_bf16 a[40:43], a[140:143], a[8:11], a[40:43]
    v_mfma_f32_16x16x32_bf16 a[44:47], a[144:147], a[8:11], a[44:47]
    global_load_dwordx4 v[72:75], v30, s[58:59] offset:0 sc1
    v_mfma_f32_16x16x32_bf16 a[48:51], a[148:151], a[8:11], a[48:51]
    v_mfma_f32_16x16x32_bf16 a[52:55], a[152:155], a[8:11], a[52:55]
    v_mfma_f32_16x16x32_bf16 a[56:59], a[156:159], a[8:11], a[56:59]
    s_waitcnt vmcnt(23)
    v_mfma_f32_16x16x32_bf16 a[60:63], a[140:143], a[12:15], a[60:63]
    global_load_dwordx4 v[136:139], v30, s[64:65] offset:-4096 sc1
    v_mfma_f32_16x16x32_bf16 a[64:67], a[144:147], a[12:15], a[64:67]
    v_mfma_f32_16x16x32_bf16 a[68:71], a[148:151], a[12:15], a[68:71]
    v_mfma_f32_16x16x32_bf16 a[72:75], a[152:155], a[12:15], a[72:75]
    v_mfma_f32_16x16x32_bf16 a[76:79], a[156:159], a[12:15], a[76:79]
    global_load_dwordx4 v[120:123], v30, s[64:65] offset:0 sc1
    s_waitcnt vmcnt(16) lgkmcnt(14)
    v_mfma_f32_16x16x32_bf16 v[8:11], v[168:171], v[96:99], v[8:11]
    ds_read_b64 v[228:229], v62 offset:0
    ds_read_b64 v[230:231], v62 offset:32
    ds_read_b64 v[232:233], v62 offset:64
    ds_read_b64 v[234:235], v62 offset:96
    ds_read_b64 v[236:237], v62 offset:128
    s_waitcnt lgkmcnt(15)
    v_mfma_f32_16x16x32_bf16 v[12:15], v[172:175], v[96:99], v[12:15]
    v_mfma_f32_16x16x32_bf16 v[16:19], v[176:179], v[96:99], v[16:19]
    v_mfma_f32_16x16x32_bf16 v[20:23], v[180:183], v[96:99], v[20:23]
    v_mfma_f32_16x16x32_bf16 v[24:27], v[184:187], v[96:99], v[24:27]
    buffer_load_dwordx2 v[48:49], v4, s[40:43], 0 offen sc1
    s_waitcnt vmcnt(16)
    v_mfma_f32_16x16x32_bf16 a[20:23], v[168:171], v[100:103], a[20:23]
    v_mfma_f32_16x16x32_bf16 a[24:27], v[172:175], v[100:103], a[24:27]
    buffer_load_dwordx2 v[50:51], v4, s[40:43], 0 offen offset:128 sc1
    v_mfma_f32_16x16x32_bf16 a[28:31], v[176:179], v[100:103], a[28:31]
    v_mfma_f32_16x16x32_bf16 a[32:35], v[180:183], v[100:103], a[32:35]
    global_load_dwordx4 v[68:71], v29, s[58:59] offset:0 sc1
    v_mfma_f32_16x16x32_bf16 a[36:39], v[184:187], v[100:103], a[36:39]
    s_waitcnt vmcnt(17)
    v_mfma_f32_16x16x32_bf16 a[40:43], v[168:171], v[104:107], a[40:43]
    v_mfma_f32_16x16x32_bf16 a[44:47], v[172:175], v[104:107], a[44:47]
    v_mfma_f32_16x16x32_bf16 a[48:51], v[176:179], v[104:107], a[48:51]
    global_load_dwordx4 v[132:135], v29, s[64:65] offset:-4096 sc1
    v_mfma_f32_16x16x32_bf16 a[52:55], v[180:183], v[104:107], a[52:55]
    v_mfma_f32_16x16x32_bf16 a[56:59], v[184:187], v[104:107], a[56:59]
    s_waitcnt vmcnt(17)
    v_mfma_f32_16x16x32_bf16 a[60:63], v[168:171], v[108:111], a[60:63]
    v_mfma_f32_16x16x32_bf16 a[64:67], v[172:175], v[108:111], a[64:67]
    v_mfma_f32_16x16x32_bf16 a[68:71], v[176:179], v[108:111], a[68:71]
    global_load_dwordx4 v[116:119], v29, s[64:65] offset:0 sc1
    v_mfma_f32_16x16x32_bf16 a[72:75], v[180:183], v[108:111], a[72:75]
    v_mfma_f32_16x16x32_bf16 a[76:79], v[184:187], v[108:111], a[76:79]
    s_waitcnt vmcnt(17) lgkmcnt(14)
    v_mfma_f32_16x16x32_bf16 a[60:63], v[188:191], v[76:79], a[60:63]
    s_waitcnt lgkmcnt(4)
    v_lshlrev_b32 v80, 16, v228
    v_mfma_f32_16x16x32_bf16 a[64:67], v[192:195], v[76:79], a[64:67]
    buffer_load_dwordx2 v[44:45], v3, s[40:43], 0 offen sc1
    v_and_b32 v81, 0xffff0000, v228
    v_mfma_f32_16x16x32_bf16 a[68:71], v[196:199], v[76:79], a[68:71]
    v_lshlrev_b32 v82, 16, v229
    v_mfma_f32_16x16x32_bf16 a[72:75], v[200:203], v[76:79], a[72:75]
    buffer_load_dwordx2 v[46:47], v3, s[40:43], 0 offen offset:128 sc1
    v_and_b32 v83, 0xffff0000, v229
    v_mfma_f32_16x16x32_bf16 a[76:79], v[204:207], v[76:79], a[76:79]
    s_waitcnt lgkmcnt(3)
    v_lshlrev_b32 v84, 16, v230
    s_waitcnt vmcnt(18)
    v_mfma_f32_16x16x32_bf16 a[60:63], v[208:211], v[140:143], a[60:63]
    global_load_dwordx4 v[64:67], v28, s[58:59] offset:0 sc1
    v_and_b32 v85, 0xffff0000, v230
    v_mfma_f32_16x16x32_bf16 a[64:67], v[212:215], v[140:143], a[64:67]
    v_lshlrev_b32 v86, 16, v231
    v_mfma_f32_16x16x32_bf16 a[68:71], v[216:219], v[140:143], a[68:71]
    v_and_b32 v87, 0xffff0000, v231
    v_mfma_f32_16x16x32_bf16 a[72:75], v[220:223], v[140:143], a[72:75]
    s_waitcnt lgkmcnt(2)
    v_lshlrev_b32 v88, 16, v232
    v_mfma_f32_16x16x32_bf16 a[76:79], v[224:227], v[140:143], a[76:79]
    v_and_b32 v89, 0xffff0000, v232
    s_waitcnt vmcnt(18)
    v_mfma_f32_16x16x32_bf16 a[60:63], a[160:163], v[124:127], a[60:63]
    global_load_dwordx4 v[128:131], v28, s[64:65] offset:-4096 sc1
    v_lshlrev_b32 v90, 16, v233
    v_mfma_f32_16x16x32_bf16 a[64:67], a[164:167], v[124:127], a[64:67]
    v_and_b32 v91, 0xffff0000, v233
    v_mfma_f32_16x16x32_bf16 a[68:71], a[168:171], v[124:127], a[68:71]
    s_waitcnt lgkmcnt(1)
    v_lshlrev_b32 v92, 16, v234
    v_mfma_f32_16x16x32_bf16 a[72:75], a[172:175], v[124:127], a[72:75]
    v_and_b32 v93, 0xffff0000, v234
    v_mfma_f32_16x16x32_bf16 a[76:79], a[176:179], v[124:127], a[76:79]
    global_load_dwordx4 v[112:115], v28, s[64:65] offset:0 sc1
    v_lshlrev_b32 v94, 16, v235
    s_waitcnt vmcnt(17)
    v_mfma_f32_16x16x32_bf16 a[60:63], v[148:151], v[52:55], a[60:63]
    v_and_b32 v95, 0xffff0000, v235
    s_waitcnt vmcnt(16)
    v_mfma_f32_16x16x32_bf16 a[64:67], v[152:155], v[52:55], a[64:67]
    s_waitcnt lgkmcnt(0)
    v_lshlrev_b32 v238, 16, v236
    s_waitcnt vmcnt(15)
    v_mfma_f32_16x16x32_bf16 a[68:71], v[156:159], v[52:55], a[68:71]
    v_and_b32 v239, 0xffff0000, v236
    s_waitcnt vmcnt(14)
    v_mfma_f32_16x16x32_bf16 a[72:75], v[160:163], v[52:55], a[72:75]
    buffer_load_dwordx2 v[40:41], v2, s[40:43], 0 offen sc1
    v_lshlrev_b32 v240, 16, v237
    s_waitcnt vmcnt(14)
    v_mfma_f32_16x16x32_bf16 a[76:79], v[164:167], v[52:55], a[76:79]
    v_and_b32 v241, 0xffff0000, v237
    s_waitcnt vmcnt(13)
    v_mfma_f32_16x16x32_bf16 a[40:43], v[188:191], v[72:75], a[40:43]
    buffer_load_dwordx2 v[42:43], v2, s[40:43], 0 offen offset:128 sc1
    v_mfma_f32_16x16x32_bf16 a[44:47], v[192:195], v[72:75], a[44:47]
    ds_write_b128 v58, a[60:63] offset:0
    v_mfma_f32_16x16x32_bf16 a[48:51], v[196:199], v[72:75], a[48:51]
    v_mfma_f32_16x16x32_bf16 a[52:55], v[200:203], v[72:75], a[52:55]
    v_mfma_f32_16x16x32_bf16 a[56:59], v[204:207], v[72:75], a[56:59]
    ds_write_b128 v58, a[64:67] offset:1024
    s_waitcnt vmcnt(13)
    v_mfma_f32_16x16x32_bf16 a[40:43], v[208:211], v[136:139], a[40:43]
    v_mfma_f32_16x16x32_bf16 a[44:47], v[212:215], v[136:139], a[44:47]
    v_mfma_f32_16x16x32_bf16 a[48:51], v[216:219], v[136:139], a[48:51]
    ds_write_b128 v58, a[68:71] offset:2048
    v_mfma_f32_16x16x32_bf16 a[52:55], v[220:223], v[136:139], a[52:55]
    v_mfma_f32_16x16x32_bf16 a[56:59], v[224:227], v[136:139], a[56:59]
    s_waitcnt vmcnt(12)
    v_mfma_f32_16x16x32_bf16 a[40:43], a[160:163], v[120:123], a[40:43]
    ds_write_b128 v58, a[72:75] offset:3072
    v_mfma_f32_16x16x32_bf16 a[44:47], a[164:167], v[120:123], a[44:47]
    v_mfma_f32_16x16x32_bf16 a[48:51], a[168:171], v[120:123], a[48:51]
    v_mfma_f32_16x16x32_bf16 a[52:55], a[172:175], v[120:123], a[52:55]
    ds_write_b128 v58, a[76:79] offset:4096
    v_mfma_f32_16x16x32_bf16 a[56:59], a[176:179], v[120:123], a[56:59]
    s_waitcnt vmcnt(10)
    v_mfma_f32_16x16x32_bf16 a[40:43], v[148:151], v[48:51], a[40:43]
    v_mfma_f32_16x16x32_bf16 a[44:47], v[152:155], v[48:51], a[44:47]
    v_mfma_f32_16x16x32_bf16 a[48:51], v[156:159], v[48:51], a[48:51]
    v_mfma_f32_16x16x32_bf16 a[52:55], v[160:163], v[48:51], a[52:55]
    v_mfma_f32_16x16x32_bf16 a[56:59], v[164:167], v[48:51], a[56:59]
    s_waitcnt lgkmcnt(0)
    s_barrier
    s_waitcnt vmcnt(9)
    v_mfma_f32_16x16x32_bf16 a[20:23], v[188:191], v[68:71], a[20:23]
    ds_read_b128 v[168:171], v59 offset:10240
    v_mfma_f32_16x16x32_bf16 a[24:27], v[192:195], v[68:71], a[24:27]
    ds_write_b128 v57, a[40:43] offset:0
    ds_read_b128 v[172:175], v59 offset:11264
    v_mfma_f32_16x16x32_bf16 a[28:31], v[196:199], v[68:71], a[28:31]
    v_mfma_f32_16x16x32_bf16 a[32:35], v[200:203], v[68:71], a[32:35]
    ds_read_b128 v[176:179], v59 offset:12288
    v_mfma_f32_16x16x32_bf16 a[36:39], v[204:207], v[68:71], a[36:39]
    ds_write_b128 v57, a[44:47] offset:1024
    ds_read_b128 v[180:183], v59 offset:13312
    s_waitcnt vmcnt(8)
    v_mfma_f32_16x16x32_bf16 a[20:23], v[208:211], v[132:135], a[20:23]
    v_mfma_f32_16x16x32_bf16 a[24:27], v[212:215], v[132:135], a[24:27]
    ds_read_b128 v[184:187], v59 offset:14336
    v_mfma_f32_16x16x32_bf16 a[28:31], v[216:219], v[132:135], a[28:31]
    ds_write_b128 v57, a[48:51] offset:2048
    v_mfma_f32_16x16x32_bf16 a[32:35], v[220:223], v[132:135], a[32:35]
    v_mfma_f32_16x16x32_bf16 a[36:39], v[224:227], v[132:135], a[36:39]
    s_waitcnt vmcnt(7)
    v_mfma_f32_16x16x32_bf16 a[20:23], a[160:163], v[116:119], a[20:23]
    ds_write_b128 v57, a[52:55] offset:3072
    v_mfma_f32_16x16x32_bf16 a[24:27], a[164:167], v[116:119], a[24:27]
    v_mfma_f32_16x16x32_bf16 a[28:31], a[168:171], v[116:119], a[28:31]
    s_waitcnt lgkmcnt(8)
    v_fma_f32 v80, v168, s90, v80
    v_mfma_f32_16x16x32_bf16 a[32:35], a[172:175], v[116:119], a[32:35]
    ds_write_b128 v57, a[56:59] offset:4096
    v_fma_f32 v81, v169, s90, v81
    v_mfma_f32_16x16x32_bf16 a[36:39], a[176:179], v[116:119], a[36:39]
    v_fma_f32 v82, v170, s90, v82
    s_waitcnt vmcnt(5)
    v_mfma_f32_16x16x32_bf16 a[20:23], v[148:151], v[44:47], a[20:23]
    v_fma_f32 v83, v171, s90, v83
    v_mfma_f32_16x16x32_bf16 a[24:27], v[152:155], v[44:47], a[24:27]
    v_mfma_f32_16x16x32_bf16 a[28:31], v[156:159], v[44:47], a[28:31]
    s_waitcnt lgkmcnt(7)
    v_fma_f32 v84, v172, s90, v84
    v_mfma_f32_16x16x32_bf16 a[32:35], v[160:163], v[44:47], a[32:35]
    v_fma_f32 v85, v173, s90, v85
    v_mfma_f32_16x16x32_bf16 a[36:39], v[164:167], v[44:47], a[36:39]
    s_waitcnt lgkmcnt(0)
    s_barrier
    v_fma_f32 v86, v174, s90, v86
    s_waitcnt vmcnt(4)
    v_mfma_f32_16x16x32_bf16 v[8:11], v[188:191], v[64:67], v[8:11]
    ds_read_b128 v[96:99], v59 offset:5120
    v_mfma_f32_16x16x32_bf16 v[12:15], v[192:195], v[64:67], v[12:15]
    ds_write_b128 v56, a[20:23] offset:0
    ds_read_b128 v[100:103], v59 offset:6144
    v_fma_f32 v87, v175, s90, v87
    v_mfma_f32_16x16x32_bf16 v[16:19], v[196:199], v[64:67], v[16:19]
    v_fma_f32 v88, v176, s90, v88
    v_mfma_f32_16x16x32_bf16 v[20:23], v[200:203], v[64:67], v[20:23]
    ds_read_b128 v[104:107], v59 offset:7168
    v_fma_f32 v89, v177, s90, v89
    v_mfma_f32_16x16x32_bf16 v[24:27], v[204:207], v[64:67], v[24:27]
    ds_write_b128 v56, a[24:27] offset:1024
    ds_read_b128 v[108:111], v59 offset:8192
    s_waitcnt vmcnt(3)
    v_mfma_f32_16x16x32_bf16 v[8:11], v[208:211], v[128:131], v[8:11]
    v_fma_f32 v90, v178, s90, v90
    v_mfma_f32_16x16x32_bf16 v[12:15], v[212:215], v[128:131], v[12:15]
    ds_read_b128 v[242:245], v59 offset:9216
    v_fma_f32 v91, v179, s90, v91
    v_mfma_f32_16x16x32_bf16 v[16:19], v[216:219], v[128:131], v[16:19]
    ds_write_b128 v56, a[28:31] offset:2048
    v_fma_f32 v92, v180, s90, v92
    v_mfma_f32_16x16x32_bf16 v[20:23], v[220:223], v[128:131], v[20:23]
    v_fma_f32 v93, v181, s90, v93
    v_mfma_f32_16x16x32_bf16 v[24:27], v[224:227], v[128:131], v[24:27]
    s_waitcnt vmcnt(2)
    v_mfma_f32_16x16x32_bf16 v[8:11], a[160:163], v[112:115], v[8:11]
    ds_write_b128 v56, a[32:35] offset:3072
    v_fma_f32 v94, v182, s90, v94
    v_mfma_f32_16x16x32_bf16 v[12:15], a[164:167], v[112:115], v[12:15]
    v_fma_f32 v95, v183, s90, v95
    v_mfma_f32_16x16x32_bf16 v[16:19], a[168:171], v[112:115], v[16:19]
    v_fma_f32 v238, v184, s90, v238
    v_mfma_f32_16x16x32_bf16 v[20:23], a[172:175], v[112:115], v[20:23]
    ds_write_b128 v56, a[36:39] offset:4096
    v_mfma_f32_16x16x32_bf16 v[24:27], a[176:179], v[112:115], v[24:27]
    v_fma_f32 v239, v185, s90, v239
    s_waitcnt vmcnt(0)
    v_mfma_f32_16x16x32_bf16 v[8:11], v[148:151], v[40:43], v[8:11]
    v_fma_f32 v240, v186, s90, v240
    v_mfma_f32_16x16x32_bf16 v[12:15], v[152:155], v[40:43], v[12:15]
    v_fma_f32 v241, v187, s90, v241
    v_mfma_f32_16x16x32_bf16 v[16:19], v[156:159], v[40:43], v[16:19]
    v_mfma_f32_16x16x32_bf16 v[20:23], v[160:163], v[40:43], v[20:23]
    v_mfma_f32_16x16x32_bf16 v[24:27], v[164:167], v[40:43], v[24:27]
    v_mov_b32 v60, s90
    s_waitcnt lgkmcnt(0)
    s_barrier
    ds_read_b128 v[128:131], v59 offset:0
    ds_read_b128 v[132:135], v59 offset:1024
    ds_read_b128 v[136:139], v59 offset:2048
    ds_read_b128 v[140:143], v59 offset:3072
    ds_read_b128 v[144:147], v59 offset:4096
    v_pk_fma_f32 v[80:81], v[96:97], v[60:61], v[80:81] op_sel_hi:[1,0,1]
    v_pk_fma_f32 v[82:83], v[98:99], v[60:61], v[82:83] op_sel_hi:[1,0,1]
    v_pk_fma_f32 v[84:85], v[100:101], v[60:61], v[84:85] op_sel_hi:[1,0,1]
    v_pk_fma_f32 v[86:87], v[102:103], v[60:61], v[86:87] op_sel_hi:[1,0,1]
    v_pk_fma_f32 v[88:89], v[104:105], v[60:61], v[88:89] op_sel_hi:[1,0,1]
    v_pk_fma_f32 v[90:91], v[106:107], v[60:61], v[90:91] op_sel_hi:[1,0,1]
    v_pk_fma_f32 v[92:93], v[108:109], v[60:61], v[92:93] op_sel_hi:[1,0,1]
    v_pk_fma_f32 v[94:95], v[110:111], v[60:61], v[94:95] op_sel_hi:[1,0,1]
    v_pk_fma_f32 v[238:239], v[242:243], v[60:61], v[238:239] op_sel_hi:[1,0,1]
    v_pk_fma_f32 v[240:241], v[244:245], v[60:61], v[240:241] op_sel_hi:[1,0,1]
    s_waitcnt lgkmcnt(4)
    v_pk_add_f32 v[8:9], v[8:9], v[128:129]
    v_pk_add_f32 v[10:11], v[10:11], v[130:131]
    v_pk_fma_f32 v[8:9], v[8:9], v[60:61], v[80:81] op_sel_hi:[1,0,1]
    v_pk_fma_f32 v[10:11], v[10:11], v[60:61], v[82:83] op_sel_hi:[1,0,1]
    v_cvt_pk_bf16_f32 v128, v8, v9
    v_cvt_pk_bf16_f32 v129, v10, v11
    ds_write_b64 v62, v[128:129] offset:0
    s_waitcnt lgkmcnt(4)
    v_pk_add_f32 v[12:13], v[12:13], v[132:133]
    v_pk_add_f32 v[14:15], v[14:15], v[134:135]
    v_pk_fma_f32 v[12:13], v[12:13], v[60:61], v[84:85] op_sel_hi:[1,0,1]
    v_pk_fma_f32 v[14:15], v[14:15], v[60:61], v[86:87] op_sel_hi:[1,0,1]
    v_cvt_pk_bf16_f32 v132, v12, v13
    v_cvt_pk_bf16_f32 v133, v14, v15
    ds_write_b64 v62, v[132:133] offset:32
    s_waitcnt lgkmcnt(4)
    v_pk_add_f32 v[16:17], v[16:17], v[136:137]
    v_pk_add_f32 v[18:19], v[18:19], v[138:139]
    v_pk_fma_f32 v[16:17], v[16:17], v[60:61], v[88:89] op_sel_hi:[1,0,1]
    v_pk_fma_f32 v[18:19], v[18:19], v[60:61], v[90:91] op_sel_hi:[1,0,1]
    v_cvt_pk_bf16_f32 v136, v16, v17
    v_cvt_pk_bf16_f32 v137, v18, v19
    ds_write_b64 v62, v[136:137] offset:64
    s_waitcnt lgkmcnt(4)
    v_pk_add_f32 v[20:21], v[20:21], v[140:141]
    v_pk_add_f32 v[22:23], v[22:23], v[142:143]
    v_pk_fma_f32 v[20:21], v[20:21], v[60:61], v[92:93] op_sel_hi:[1,0,1]
    v_pk_fma_f32 v[22:23], v[22:23], v[60:61], v[94:95] op_sel_hi:[1,0,1]
    v_cvt_pk_bf16_f32 v140, v20, v21
    v_cvt_pk_bf16_f32 v141, v22, v23
    ds_write_b64 v62, v[140:141] offset:96
    s_waitcnt lgkmcnt(4)
    v_pk_add_f32 v[24:25], v[24:25], v[144:145]
    v_pk_add_f32 v[26:27], v[26:27], v[146:147]
    v_pk_fma_f32 v[24:25], v[24:25], v[60:61], v[238:239] op_sel_hi:[1,0,1]
    v_pk_fma_f32 v[26:27], v[26:27], v[60:61], v[240:241] op_sel_hi:[1,0,1]
    v_cvt_pk_bf16_f32 v144, v24, v25
    v_cvt_pk_bf16_f32 v145, v26, v27
    ds_write_b64 v62, v[144:145] offset:128
    ds_read_b128 v[64:67], v63 offset:0
    ds_read_b128 v[68:71], v63 offset:1024
    ds_read_b128 v[72:75], v63 offset:2048
    s_waitcnt lgkmcnt(2)
    buffer_store_dwordx4 v[64:67], v31, s[44:47], s89 offen
    s_waitcnt lgkmcnt(1)
    buffer_store_dwordx4 v[68:71], v33, s[44:47], s89 offen
    s_waitcnt lgkmcnt(0)
    buffer_store_dwordx4 v[72:75], v61, s[44:47], s89 offen
Lend:
    s_endpgm
Lslow1:
    s_mov_b32 s97, 0
Lspin1:
    s_add_u32 s97, s97, 1
    s_cmp_gt_u32 s97, 20000
    s_cbranch_scc1 Lout1
    buffer_load_dword v24, v20, s[40:43], 0 offen sc1
    s_waitcnt vmcnt(0)
    v_cmp_ne_u32 vcc, s72, v24
    s_nop 4
    s_cbranch_vccnz Lspin1
Lout1:
    s_nop 7
    s_branch Lback1
Lslow2:
    s_mov_b32 s97, 0
Lspin2:
    s_add_u32 s97, s97, 1
    s_cmp_gt_u32 s97, 20000
    s_cbranch_scc1 Lout2
    buffer_load_dword v115, v125, s[40:43], 0 offen sc1
    s_waitcnt vmcnt(0)
    v_cmp_ne_u32 vcc, s72, v115
    s_nop 4
    s_cbranch_vccnz Lspin2
Lout2:
    s_nop 7
    s_branch Lback2
Lslow3:
    s_mov_b32 s97, 0
Lspin3:
    s_add_u32 s97, s97, 1
    s_cmp_gt_u32 s97, 20000
    s_cbranch_scc1 Lout3
    buffer_load_dword v3, v2, s[40:43], 0 offen sc1
    s_waitcnt vmcnt(0)
    v_cmp_ne_u32 vcc, s72, v3
    s_nop 4
    s_cbranch_vccnz Lspin3
Lout3:
    s_nop 7
    s_branch Lback3
Lslow4:
    s_mov_b32 s97, 0
Lspin4:
    s_add_u32 s97, s97, 1
    s_cmp_gt_u32 s97, 20000
    s_cbranch_scc1 Lout4
    buffer_load_dword v24, v20, s[40:43], 0 offen sc1
    s_waitcnt vmcnt(0)
    v_cmp_ne_u32 vcc, s72, v24
    s_nop 4
    s_cbranch_vccnz Lspin4
Lout4:
    s_nop 7
    s_branch Lback4
Lslow5:
    s_mov_b32 s97, 0
Lspin5:
    s_add_u32 s97, s97, 1
    s_cmp_gt_u32 s97, 20000
    s_cbranch_scc1 Lout5
    buffer_load_dword v115, v125, s[40:43], 0 offen sc1
    s_waitcnt vmcnt(0)
    v_cmp_ne_u32 vcc, s72, v115
    s_nop 4
    s_cbranch_vccnz Lspin5
Lout5:
    s_nop 7
    s_branch Lback5
Lslow6:
    s_mov_b32 s97, 0
Lspin6:
    s_add_u32 s97, s97, 1
    s_cmp_gt_u32 s97, 20000
    s_cbranch_scc1 Lout6
    buffer_load_dword v3, v2, s[40:43], 0 offen sc1
    s_waitcnt vmcnt(0)
    v_cmp_ne_u32 vcc, s72, v3
    s_nop 4
    s_cbranch_vccnz Lspin6
Lout6:
    s_nop 7
    s_branch Lback6
Lslow7:
    s_mov_b32 s97, 0
Lspin7:
    s_add_u32 s97, s97, 1
    s_cmp_gt_u32 s97, 20000
    s_cbranch_scc1 Lout7
    buffer_load_dword v24, v20, s[40:43], 0 offen sc1
    s_waitcnt vmcnt(0)
    v_cmp_ne_u32 vcc, s72, v24
    s_nop 4
    s_cbranch_vccnz Lspin7
Lout7:
    s_nop 7
    s_branch Lback7
Lslow8:
    s_mov_b32 s97, 0
Lspin8:
    s_add_u32 s97, s97, 1
    s_cmp_gt_u32 s97, 20000
    s_cbranch_scc1 Lout8
    buffer_load_dword v24, v21, s[40:43], 0 offen sc1
    s_waitcnt vmcnt(0)
    v_cmp_ne_u32 vcc, s72, v24
    s_nop 4
    s_cbranch_vccnz Lspin8
Lout8:
    s_nop 7
    s_branch Lback8
Lslow9:
    s_mov_b32 s97, 0
Lspin9:
    s_add_u32 s97, s97, 1
    s_cmp_gt_u32 s97, 20000
    s_cbranch_scc1 Lout9
    buffer_load_dword v33, v31, s[40:43], 0 offen sc1
    s_waitcnt vmcnt(0)
    v_cmp_ne_u32 vcc, s72, v33
    s_nop 4
    s_cbranch_vccnz Lspin9
Lout9:
    s_nop 7
    s_branch Lback9
Lslow10:
    s_mov_b32 s97, 0
Lspin10:
    s_add_u32 s97, s97, 1
    s_cmp_gt_u32 s97, 20000
    s_cbranch_scc1 Lout10
    buffer_load_dword v38, v36, s[40:43], 0 offen sc1
    s_waitcnt vmcnt(0)
    v_cmp_ne_u32 vcc, s72, v38
    s_nop 4
    s_cbranch_vccnz Lspin10
Lout10:
    s_nop 7
    s_branch Lback10
Lslow11:
    s_mov_b32 s97, 0
Lspin11:
    s_add_u32 s97, s97, 1
    s_cmp_gt_u32 s97, 20000
    s_cbranch_scc1 Lout11
    buffer_load_dword v38, v37, s[40:43], 0 offen sc1
    s_waitcnt vmcnt(0)
    v_cmp_ne_u32 vcc, s72, v38
    s_nop 4
    s_cbranch_vccnz Lspin11
Lout11:
    s_nop 7
    s_branch Lback11
.section .rodata,"a"
.p2align 6
.amdhsa_kernel parallel_sum__linear_kernel_hedgehog__dense_activation_mish__prompt_kernel
  .amdhsa_next_free_vgpr 512
  .amdhsa_next_free_sgpr 102
  .amdhsa_accum_offset 256
  .amdhsa_group_segment_fixed_size 0
  .amdhsa_kernarg_size 88
  .amdhsa_user_sgpr_count 2
  .amdhsa_user_sgpr_kernarg_segment_ptr 1
  .amdhsa_system_sgpr_workgroup_id_x 1
.end_amdhsa_kernel
```
